```python
import torch

def _softmax(x, axis=-1):
    return torch.softmax(x, dim=axis)
def _gelu(x):
    return torch.nn.functional.gelu(x, approximate="tanh")
def _silu(x):
    return torch.nn.functional.silu(x)
def _sigmoid(x):
    return torch.sigmoid(x)
def _layernorm(x, axis=-1, eps=1e-5):
    m = x.mean(dim=axis, keepdim=True)
    v = x.var(dim=axis, keepdim=True, unbiased=False)
    return (x - m) / torch.sqrt(v + eps)
def _scatter_add(tgt, idx, src, axis=0):
    return tgt.clone().index_add_(axis, idx, src)
def _segment_sum(src, seg, n):
    out = torch.zeros((n,) + src.shape[1:], dtype=src.dtype)
    return out.index_add_(0, seg, src)
def _pad(x, pw):
    flat = tuple(v for pair in reversed(pw) for v in pair)
    return torch.nn.functional.pad(x, flat)

kernel_name = 'concat_heads__sliding_block__mha_block__prompt'

def setup_inputs():

    _w = (lambda a: (lambda t: t.to(torch.bfloat16) if t.is_floating_point() else t)(torch.as_tensor(a)))
    def _A_setup():
        B, S, D = 1, 2048, 1024
        return {
            "x": _w((lambda *s: torch.randn(*s, dtype=torch.bfloat16) * 0.2)(B, S, D)),
            "wqkv": _w((lambda *s: torch.randn(*s, dtype=torch.bfloat16) * 0.8)(D, 3 * D)),
            "wo": _w((lambda *s: torch.randn(*s, dtype=torch.bfloat16) * 0.8)(D, D)),
        }
    _A_in = _A_setup()

    def _B_setup():
        B, S, D, H = 1, 2048, 1024, 32
        return {
            "x": _w((lambda *s: torch.randn(*s, dtype=torch.bfloat16) * 0.2)(B, S, D)),
            "wqkv": _w((lambda *s: torch.randn(*s, dtype=torch.bfloat16) * 0.8)(D, 3 * D)),
            "wo": _w((lambda *s: torch.randn(*s, dtype=torch.bfloat16) * 0.8)(D, D)),
        }
    _B_in = _B_setup()

    return {
        "A_x": _A_in["x"],
        "A_wqkv": _A_in["wqkv"],
        "A_wo": _A_in["wo"],
        "B_x": _B_in["x"],
        "B_wqkv": _B_in["wqkv"],
        "B_wo": _B_in["wo"],
    }

def reference(A_x, A_wqkv, A_wo, B_x, B_wqkv, B_wo):
    def _A_ref(x, wqkv, wo):
        B, S, D = x.shape
        H = 32; Dh = D // H; W = 256
        qkv = (lambda x, *d: x.permute(*d))((x @ wqkv).reshape(B, S, 3, H, Dh), 2, 0, 3, 1, 4)
        q, k, v = qkv[0], qkv[1], qkv[2]
        scores = torch.einsum("bhqd,bhkd->bhqk", q, k) * (Dh ** -0.5)
        idx = torch.arange(S)
        mask = (idx[:, None] - idx[None, :] >= 0) & (idx[:, None] - idx[None, :] < W)
        scores = torch.where(mask[None, None], scores, -1e9)
        p = _softmax(scores, axis=-1)
        o = torch.einsum("bhqk,bhkd->bhqd", p, v)
        return (lambda x, *d: x.permute(*d))(o, 0, 2, 1, 3).reshape(B, S, D) @ wo

    def _B_ref(x, wqkv, wo):
        B, S, D = x.shape
        H = 32
        Dh = D // H
        qkv = (lambda x, *d: x.permute(*d))((x @ wqkv).reshape(B, S, 3, H, Dh), 2, 0, 3, 1, 4)
        q, k, v = qkv[0], qkv[1], qkv[2]
        scores = torch.einsum("bhqd,bhkd->bhqk", q, k) * (Dh ** -0.5)
        p = _softmax(scores, axis=-1)
        o = torch.einsum("bhqk,bhkd->bhqd", p, v)
        return (lambda x, *d: x.permute(*d))(o, 0, 2, 1, 3).reshape(B, S, D) @ wo

    a = _A_ref(A_x, A_wqkv, A_wo)
    b = _B_ref(B_x, B_wqkv, B_wo)
    return torch.concatenate([a, b], axis=-1)
```

```asm
; @launch kernel=mega_kernel grid=(256,1,1) block=(512,1,1) lds=163840
.amdgcn_target "amdgcn-amd-amdhsa--gfx950"
.text
.globl mega_kernel
.p2align 8
.type mega_kernel,@function
mega_kernel:
    s_cmp_ge_u32 s2, 256
    s_cbranch_scc1 mega_kernel_end
    s_load_dwordx4 s[24:27], s[0:1], 24
    s_load_dwordx4 s[52:55], s[0:1], 0
    s_load_dwordx4 s[28:31], s[0:1], 56
    s_and_b32 s3, s2, 7
    s_lshr_b32 s4, s2, 3
    v_lshrrev_b32 v1, 6, v0
    v_and_b32 v0, 63, v0
    s_and_b32 s5, s3, 1
    s_lshl_b32 s5, s5, 3
    s_and_b32 s6, s4, 7
    s_add_u32 s22, s5, s6
    v_readfirstlane_b32 s20, v1
    s_lshr_b32 s5, s3, 1
    s_lshl_b32 s5, s5, 2
    s_lshr_b32 s6, s4, 3
    s_add_u32 s23, s5, s6
    s_mov_b32 s18, 34603008
    s_mov_b32 s19, 0x20000
    v_mov_b32 v248, 0
    v_lshlrev_b32 v249, 3, v0
    v_mov_b32 v251, 1
    v_mov_b32 v252, 0
    s_cmp_lt_u32 s20, 4
    s_cbranch_scc1 mega_kernel_q_compute
    s_sub_u32 s39, s20, 4
    v_lshrrev_b32 v1, 3, v0
    s_lshl_b32 s3, s39, 3
    v_add_u32 v1, s3, v1
    v_lshlrev_b32 v1, 11, v1
    v_lshrrev_b32 v2, 4, v0
    s_and_b32 s4, s39, 2
    s_lshl_b32 s4, s4, 1
    v_add_u32 v2, s4, v2
    v_and_b32 v3, 7, v0
    v_xor_b32 v2, v2, v3
    v_lshl_add_u32 v1, v2, 4, v1
    v_lshrrev_b32 v2, 5, v0
    v_lshlrev_b32 v2, 2, v2
    v_bfe_u32 v3, v0, 2, 2
    v_add3_u32 v2, v2, v3, s3
    v_mul_u32_u24 v2, 6144, v2
    v_bfe_u32 v3, v0, 4, 1
    v_lshl_add_u32 v2, v3, 6, v2
    s_and_b32 s4, s39, 1
    s_lshl_b32 s4, s4, 1
    v_and_b32 v3, 3, v0
    v_xor_b32 v3, s4, v3
    v_lshl_add_u32 v2, v3, 4, v2
    s_lshl_b32 s5, s22, 18
    s_lshl_b32 s56, s23, 7
    s_xor_b32 s57, s56, 128
    s_add_u32 s57, s57, 2048
    s_xor_b32 s58, s56, 256
    s_add_u32 s58, s58, 4096
    s_lshl_b32 s40, s39, 10
    s_mul_i32 s41, s39, 3072
    s_add_u32 s41, s41, 16384
    s_mul_i32 s32, s22, 0
    s_and_b32 s32, s32, 15
    s_mul_i32 s33, s32, 393216
    s_lshl_b32 s32, s32, 7
    s_mov_b32 s34, 40960
    s_mov_b32 s10, 0x40000
    s_mov_b32 s11, 0x20000
    s_mov_b32 s14, 0x600000
    s_mov_b32 s15, 0x20000
    v_lshrrev_b32 v3, 3, v0
    v_lshlrev_b32 v3, 11, v3
    v_and_b32 v4, 7, v0
    v_lshl_add_u32 v3, v4, 7, v3
    s_sub_u32 s3, s39, 1
    s_lshl_b32 s3, s3, 6
    v_add_u32 v4, s3, v0
    v_cmp_gt_u32 vcc, 96, v4
    v_lshlrev_b32 v4, 7, v4
    v_mov_b32 v5, 0x7f000000
    s_mov_b32 s70, 3145728
    s_lshl_b32 s71, s2, 14
    v_cndmask_b32 v4, v5, v4, vcc
    s_mul_i32 s72, s2, 12288
    s_cmp_eq_u32 s39, 0
    s_cselect_b64 vcc, -1, 0
    s_nop 1
    v_cndmask_b32 v3, v4, v3, vcc
    s_waitcnt lgkmcnt(0)
    s_add_u32 s8, s24, s5
    s_addc_u32 s9, s25, 0
    s_mov_b32 s12, s26
    s_mov_b32 s13, s27
    s_mov_b32 s16, s30
    s_mov_b32 s17, s31
    s_mov_b32 s63, 0x20000
    s_cmp_eq_u32 s39, 0
    s_cselect_b32 s60, s24, s26
    s_cselect_b32 s61, s25, s27
    s_cselect_b32 s68, s52, s54
    s_cselect_b32 s69, s53, s55
    s_cselect_b32 s62, 0x400000, s14
    s_cselect_b32 s65, 1024, s70
    s_cselect_b32 s64, s71, s72
    s_lshr_b32 s3, s2, 5
    s_sub_u32 s3, s3, 1
    s_cmp_lt_u32 s3, 4
    s_cselect_b32 s76, -1, 0
    s_cmp_eq_u32 s39, 0
    s_cselect_b32 s76, 505290270, s76
    s_mov_b32 s77, s76
    s_mov_b64 exec, s[76:77]
    s_cbranch_execz mega_kernel_t0a
    buffer_load_dword v4, v3, s[60:63], s64 offen
mega_kernel_t0a:
    s_mov_b64 exec, -1
    s_add_u32 m0, s34, s40
    s_add_u32 s36, s32, 65536
    buffer_load_dwordx4 v1, s[8:11], s32 offen lds
    s_add_u32 m0, m0, 4096
    s_add_u32 s37, s32, 131072
    buffer_load_dwordx4 v1, s[8:11], s36 offen lds
    s_add_u32 m0, m0, 4096
    s_add_u32 s36, s32, 196608
    buffer_load_dwordx4 v1, s[8:11], s37 offen lds
    s_add_u32 m0, m0, 4096
    s_add_u32 s35, s34, s41
    buffer_load_dwordx4 v1, s[8:11], s36 offen lds
    s_mov_b32 m0, s35
    s_add_u32 s37, s33, s56
    buffer_load_dwordx4 v2, s[12:15], s37 offen lds
    s_add_u32 m0, s35, 1024
    s_add_u32 s37, s33, s57
    buffer_load_dwordx4 v2, s[12:15], s37 offen lds
    s_add_u32 m0, s35, 2048
    s_add_u32 s37, s33, s58
    buffer_load_dwordx4 v2, s[12:15], s37 offen lds
    s_add_u32 s33, s33, 196608
    s_add_u32 m0, s35, 12288
    s_add_u32 s37, s33, s56
    buffer_load_dwordx4 v2, s[12:15], s37 offen lds
    s_add_u32 m0, s35, 13312
    s_add_u32 s37, s33, s57
    buffer_load_dwordx4 v2, s[12:15], s37 offen lds
    s_add_u32 m0, s35, 14336
    s_add_u32 s37, s33, s58
    buffer_load_dwordx4 v2, s[12:15], s37 offen lds
    s_add_u32 s32, s32, 128
    s_and_b32 s32, s32, 2047
    s_add_u32 s33, s33, 196608
    s_cmp_eq_u32 s33, 6291456
    s_cselect_b32 s33, 0, s33
    s_add_u32 s34, s34, 40960
    s_cmp_eq_u32 s34, 163840
    s_cselect_b32 s34, 40960, s34
    s_add_u32 m0, s34, s40
    s_add_u32 s36, s32, 65536
    buffer_load_dwordx4 v1, s[8:11], s32 offen lds
    s_add_u32 m0, m0, 4096
    s_add_u32 s37, s32, 131072
    buffer_load_dwordx4 v1, s[8:11], s36 offen lds
    s_add_u32 m0, m0, 4096
    s_add_u32 s36, s32, 196608
    buffer_load_dwordx4 v1, s[8:11], s37 offen lds
    s_add_u32 m0, m0, 4096
    s_add_u32 s35, s34, s41
    buffer_load_dwordx4 v1, s[8:11], s36 offen lds
    s_mov_b32 m0, s35
    s_add_u32 s37, s33, s56
    buffer_load_dwordx4 v2, s[12:15], s37 offen lds
    s_add_u32 m0, s35, 1024
    s_add_u32 s37, s33, s57
    buffer_load_dwordx4 v2, s[12:15], s37 offen lds
    s_add_u32 m0, s35, 2048
    s_add_u32 s37, s33, s58
    buffer_load_dwordx4 v2, s[12:15], s37 offen lds
    s_add_u32 s33, s33, 196608
    s_add_u32 m0, s35, 12288
    s_add_u32 s37, s33, s56
    buffer_load_dwordx4 v2, s[12:15], s37 offen lds
    s_add_u32 m0, s35, 13312
    s_add_u32 s37, s33, s57
    buffer_load_dwordx4 v2, s[12:15], s37 offen lds
    s_add_u32 m0, s35, 14336
    s_add_u32 s37, s33, s58
    buffer_load_dwordx4 v2, s[12:15], s37 offen lds
    s_add_u32 s32, s32, 128
    s_and_b32 s32, s32, 2047
    s_add_u32 s33, s33, 196608
    s_cmp_eq_u32 s33, 6291456
    s_cselect_b32 s33, 0, s33
    s_add_u32 s34, s34, 40960
    s_cmp_eq_u32 s34, 163840
    s_cselect_b32 s34, 40960, s34
    s_waitcnt vmcnt(10)
    s_barrier
    s_lshr_b32 s3, s2, 5
    s_sub_u32 s3, s3, 5
    s_cmp_lt_u32 s3, 3
    s_cselect_b32 s76, -1, 0
    s_cmp_eq_u32 s39, 0
    s_cselect_b32 s76, 3772834016, s76
    s_mov_b32 s77, s76
    s_mov_b64 exec, s[76:77]
    s_cbranch_execz mega_kernel_t0b
    buffer_load_dword v4, v3, s[60:63], s64 offen
mega_kernel_t0b:
    s_mov_b64 exec, -1
    s_mov_b32 s73, s64
    s_add_u32 s64, s64, s65
    s_bfe_u32 s66, s2, 0x20003
    s_add_u32 s66, s66, 3
    s_mov_b32 s67, 1
    s_cmp_eq_u32 s39, 0
    s_cselect_b32 s75, 25, 99
    s_add_u32 s52, s52, s5
    s_addc_u32 s53, s53, 0
    s_mov_b32 s38, 2
    s_branch mega_kernel_q_pf_ret
mega_kernel_q_lloop:
    s_waitcnt vmcnt(10)
mega_kernel_q_lbar:
    s_barrier
    s_cmp_eq_u32 s38, 16
    s_cselect_b32 s8, s52, s8
    s_cselect_b32 s9, s53, s9
    s_cselect_b32 s12, s54, s12
    s_cselect_b32 s13, s55, s13
    s_sub_u32 s3, s38, 1
    s_cmp_eq_u32 s3, s66
    s_cbranch_scc1 mega_kernel_q_pf
mega_kernel_q_pf_ret:
    s_add_u32 m0, s34, s40
    s_add_u32 s36, s32, 65536
    buffer_load_dwordx4 v1, s[8:11], s32 offen lds
    s_add_u32 m0, m0, 4096
    s_add_u32 s37, s32, 131072
    buffer_load_dwordx4 v1, s[8:11], s36 offen lds
    s_add_u32 m0, m0, 4096
    s_add_u32 s36, s32, 196608
    buffer_load_dwordx4 v1, s[8:11], s37 offen lds
    s_add_u32 m0, m0, 4096
    s_add_u32 s35, s34, s41
    buffer_load_dwordx4 v1, s[8:11], s36 offen lds
    s_mov_b32 m0, s35
    s_add_u32 s37, s33, s56
    buffer_load_dwordx4 v2, s[12:15], s37 offen lds
    s_add_u32 m0, s35, 1024
    s_add_u32 s37, s33, s57
    buffer_load_dwordx4 v2, s[12:15], s37 offen lds
    s_add_u32 m0, s35, 2048
    s_add_u32 s37, s33, s58
    buffer_load_dwordx4 v2, s[12:15], s37 offen lds
    s_add_u32 s33, s33, 196608
    s_add_u32 m0, s35, 12288
    s_add_u32 s37, s33, s56
    buffer_load_dwordx4 v2, s[12:15], s37 offen lds
    s_add_u32 m0, s35, 13312
    s_add_u32 s37, s33, s57
    buffer_load_dwordx4 v2, s[12:15], s37 offen lds
    s_add_u32 m0, s35, 14336
    s_add_u32 s37, s33, s58
    buffer_load_dwordx4 v2, s[12:15], s37 offen lds
    s_add_u32 s32, s32, 128
    s_and_b32 s32, s32, 2047
    s_add_u32 s33, s33, 196608
    s_cmp_eq_u32 s33, 6291456
    s_cselect_b32 s33, 0, s33
    s_add_u32 s34, s34, 40960
    s_cmp_eq_u32 s34, 163840
    s_cselect_b32 s34, 40960, s34
    s_add_u32 s38, s38, 1
    s_cmp_lt_u32 s38, 32
    s_cbranch_scc1 mega_kernel_q_lloop
    s_waitcnt vmcnt(10)
    s_barrier
    v_mov_b64 v[18:19], 0
    v_mov_b64 v[240:241], 0
    s_call_b64 s[40:41], mega_kernel_a_ssetup
    s_branch mega_kernel_a_setup
mega_kernel_q_pf:
    s_cmp_ge_u32 s38, 26
    s_cbranch_scc1 mega_kernel_q_lev
    buffer_load_dword v4, v3, s[60:63], s64 offen
    s_add_u32 s64, s64, s65
    s_add_u32 s66, s66, 4
    s_add_u32 s67, s67, 1
    s_cmp_eq_u32 s67, 2
    s_cselect_b32 s60, s68, s60
    s_cselect_b32 s61, s69, s61
    s_cselect_b32 s64, s73, s64
    s_cmp_eq_u32 s67, 4
    s_cselect_b32 s66, s75, s66
    s_branch mega_kernel_q_pf_ret
mega_kernel_q_compute:
    s_getpc_b64 s[44:45]
    s_lshr_b32 s3, s2, 3
    s_and_b32 s3, s3, 7
    s_lshl_b32 s3, s3, 13
    s_cmp_eq_u32 s20, 0
    s_cselect_b32 s3, s3, 0x100000
    v_lshlrev_b32 v8, 7, v0
    v_add_u32 v8, s3, v8
    v_cmp_gt_u32 vcc, mega_kernel_codeend-mega_kernel_q_compute-128, v8
    s_and_saveexec_b64 s[46:47], vcc
    s_cbranch_execz mega_kernel_nopf
    global_load_dword v7, v8, s[44:45]
mega_kernel_nopf:
    s_mov_b64 exec, -1
    s_setprio 1
    s_lshr_b32 s3, s20, 1
    s_and_b32 s4, s20, 1
    v_bfe_u32 v8, v0, 3, 1
    v_and_b32 v9, 7, v0
    v_lshl_add_u32 v9, v8, 4, v9
    v_lshrrev_b32 v10, 4, v0
    v_bfe_u32 v11, v0, 1, 3
    v_xor_b32 v11, v11, v10
    s_lshl_b32 s5, s3, 13
    s_add_u32 s5, s5, 40960
    v_lshlrev_b32 v12, 7, v9
    v_add_u32 v12, s5, v12
    v_lshl_add_u32 v2, v11, 4, v12
    v_xor_b32 v11, 4, v11
    v_lshl_add_u32 v3, v11, 4, v12
    v_mul_u32_u24 v12, 3072, v10
    s_lshl_b32 s5, s4, 8
    s_add_u32 s5, s5, 57344
    v_add_u32 v12, s5, v12
    v_bfe_u32 v11, v0, 2, 2
    v_lshl_add_u32 v12, v11, 6, v12
    v_and_b32 v11, 3, v0
    v_lshl_add_u32 v12, v11, 3, v12
    v_bfe_u32 v11, v0, 4, 1
    v_lshl_add_u32 v4, v11, 5, v12
    v_xor_b32 v11, 1, v11
    v_lshl_add_u32 v5, v11, 5, v12
    v_lshlrev_b32 v10, 9, v10
    v_lshl_add_u32 v240, v9, 4, v10
    v_and_b32 v9, 15, v0
    v_lshl_add_u32 v241, v9, 4, v10
    s_mov_b32 s58, 40960
    s_mov_b32 s59, 4294885376
    s_mov_b32 s62, 0
    s_lshl_b32 s5, s23, 1
    s_add_u32 s5, s5, s4
    s_lshl_b32 s6, s22, 2
    s_lshl_b32 s7, s3, 1
    s_add_u32 s6, s6, s7
    s_lshl_b32 s64, s5, 17
    s_lshl_b32 s7, s6, 11
    s_add_u32 s64, s64, s7
    s_add_u32 s64, s64, 4194304
    s_lshl_b32 s65, s64, 1
    s_xor_b32 s60, s65, 1048576
    s_xor_b32 s65, s65, 524288
    s_add_u32 s65, s65, 8388608
    s_add_u32 s63, s65, 4096
    s_add_u32 s60, s60, 8388608
    s_add_u32 s61, s60, 4096
    s_mov_b32 s66, 1048744942
    s_mov_b32 s67, 1048744942
    v_lshrrev_b32 v8, 1, v0
    v_lshlrev_b32 v9, 2, v8
    v_lshrrev_b32 v9, v9, 33
    v_and_b32 v9, 15, v9
    v_xor_b32 v9, s23, v9
    v_lshlrev_b32 v9, 9, v9
    v_lshl_add_u32 v9, v8, 6, v9
    v_and_b32 v8, 1, v0
    v_lshl_add_u32 v9, v8, 8, v9
    s_lshl_b32 s7, s22, 2
    v_add_u32 v252, s7, v9
    s_and_b32 s5, s2, 7
    s_lshl_b32 s5, s5, 2
    s_lshr_b32 s6, s2, 3
    s_and_b32 s7, s6, 3
    s_add_u32 s21, s5, s7
    s_lshr_b32 s6, s6, 2
    s_lshl_b32 s4, s6, 7
    s_lshl_b32 s6, s6, 3
    s_add_u32 s6, s6, s20
    s_lshl_b32 s69, s21, 17
    s_lshl_b32 s7, s6, 11
    s_add_u32 s69, s69, s7
    s_add_u32 s69, s69, 4194304
    s_lshl_b32 s6, s6, 5
    s_add_u32 s6, s6, s21
    s_lshl_b32 s6, s6, 2
    s_add_u32 s6, s6, 32768
    v_and_b32 v8, 7, v0
    v_lshlrev_b32 v8, 7, v8
    v_bfe_u32 v9, v0, 3, 1
    v_lshl_add_u32 v8, v9, 13, v8
    v_add_u32 v8, s6, v8
    s_lshl_b32 s7, s21, 2
    s_add_u32 s4, s4, s7
    s_add_u32 s4, s4, 49152
    s_add_u32 s7, s4, 1024
    v_writelane_b32 v8, s4, 16
    v_writelane_b32 v8, s7, 17
    s_mov_b32 s5, 33554432
    s_mov_b32 s6, 33562624
    s_waitcnt lgkmcnt(0)
    s_mov_b32 s16, s30
    s_mov_b32 s17, s31
    s_mov_b64 s[70:71], s[28:29]
    s_cmp_lg_u32 s20, 0
    s_cbranch_scc1 mega_kernel_noclr
    s_mov_b64 exec, 0x3ffff
    buffer_store_dword v248, v8, s[16:19], s5 offen sc1
    s_mov_b64 exec, 63
    buffer_store_dword v248, v252, s[16:19], s5 offen sc1
    buffer_store_dword v248, v252, s[16:19], s6 offen sc1
    s_mov_b64 exec, -1
    mega_kernel_noclr:
    s_call_b64 s[40:41], mega_kernel_a_ssetup
    s_barrier
    ds_read_b64_tr_b16 v[24:25], v4 offset:0
    ds_read_b64_tr_b16 v[26:27], v4 offset:512
    ds_read_b128 v[8:11], v2 offset:0
    ds_read_b128 v[12:15], v2 offset:1024
    ds_read_b128 v[16:19], v2 offset:4096
    ds_read_b128 v[20:23], v2 offset:5120
    ds_read_b64_tr_b16 v[28:29], v5 offset:0
    ds_read_b64_tr_b16 v[30:31], v5 offset:512
    ds_read_b64_tr_b16 v[32:33], v4 offset:1024
    ds_read_b64_tr_b16 v[34:35], v4 offset:1536
    ds_read_b64_tr_b16 v[36:37], v5 offset:1024
    ds_read_b64_tr_b16 v[38:39], v5 offset:1536
    ds_read_b64_tr_b16 v[40:41], v4 offset:2048
    ds_read_b64_tr_b16 v[42:43], v4 offset:2560
    ds_read_b64_tr_b16 v[44:45], v5 offset:2048
    ds_read_b64_tr_b16 v[46:47], v5 offset:2560
    s_mov_b32 s56, 1
    s_bfe_u32 s3, s2, 0x20003
    s_mul_i32 s3, s3, 3
    s_add_u32 s3, s3, 4
    s_cmp_eq_u32 s20, 0
    s_cselect_b32 s57, s3, 16
    s_mov_b32 s5, 0x7f000000
    s_cselect_b32 s68, 33562624, s5
    s_add_u32 s62, s62, 1
    s_cmp_eq_u32 s62, 3
    s_cselect_b32 s3, s59, s58
    s_cselect_b32 s62, 0, s62
    s_waitcnt lgkmcnt(0)
mega_kernel_q_first:
    v_mul_f32 v88, s66, v88
    v_mul_f32 v89, s66, v89
    v_mul_f32 v90, s66, v90
    v_mul_f32 v91, s66, v91
    v_cvt_pk_bf16_f32 v184, v88, v89
    v_cvt_pk_bf16_f32 v185, v90, v91
    v_mfma_f32_16x16x32_bf16 v[88:91], v[24:27], v[8:11], 0
    ds_read_b64_tr_b16 v[64:65], v4 offset:12288
    v_mul_f32 v92, s66, v92
    v_mul_f32 v93, s66, v93
    v_mul_f32 v94, s66, v94
    v_mul_f32 v95, s66, v95
    v_cvt_pk_bf16_f32 v188, v92, v93
    v_cvt_pk_bf16_f32 v189, v94, v95
    v_mfma_f32_16x16x32_bf16 v[92:95], v[24:27], v[12:15], 0
    ds_read_b64_tr_b16 v[66:67], v4 offset:12800
    v_mul_f32 v96, s66, v96
    v_mul_f32 v97, s66, v97
    v_mul_f32 v98, s66, v98
    v_mul_f32 v99, s66, v99
    v_cvt_pk_bf16_f32 v192, v96, v97
    v_cvt_pk_bf16_f32 v193, v98, v99
    v_mfma_f32_16x16x32_bf16 v[96:99], v[24:27], v[16:19], 0
    ds_read_b128 v[48:51], v3 offset:0
    v_mul_f32 v100, s66, v100
    v_mul_f32 v101, s66, v101
    v_mul_f32 v102, s66, v102
    v_mul_f32 v103, s66, v103
    v_cvt_pk_bf16_f32 v196, v100, v101
    v_cvt_pk_bf16_f32 v197, v102, v103
    v_mfma_f32_16x16x32_bf16 v[100:103], v[24:27], v[20:23], 0
    ds_read_b128 v[52:55], v3 offset:1024
    v_mul_f32 v116, s66, v116
    v_mul_f32 v117, s66, v117
    v_mul_f32 v118, s66, v118
    v_mul_f32 v119, s66, v119
    v_cvt_pk_bf16_f32 v198, v116, v117
    v_cvt_pk_bf16_f32 v199, v118, v119
    v_mfma_f32_16x16x32_bf16 v[116:119], v[28:31], v[20:23], 0
    ds_read_b128 v[56:59], v3 offset:4096
    v_mul_f32 v112, s66, v112
    v_mul_f32 v113, s66, v113
    v_mul_f32 v114, s66, v114
    v_mul_f32 v115, s66, v115
    v_cvt_pk_bf16_f32 v194, v112, v113
    v_cvt_pk_bf16_f32 v195, v114, v115
    v_mfma_f32_16x16x32_bf16 v[112:115], v[28:31], v[16:19], 0
    ds_read_b128 v[60:63], v3 offset:5120
    v_mul_f32 v108, s66, v108
    v_mul_f32 v109, s66, v109
    v_mul_f32 v110, s66, v110
    v_mul_f32 v111, s66, v111
    v_cvt_pk_bf16_f32 v190, v108, v109
    v_cvt_pk_bf16_f32 v191, v110, v111
    v_mfma_f32_16x16x32_bf16 v[108:111], v[28:31], v[12:15], 0
    ds_read_b64_tr_b16 v[68:69], v5 offset:12288
    v_mul_f32 v104, s66, v104
    v_mul_f32 v105, s66, v105
    v_mul_f32 v106, s66, v106
    v_mul_f32 v107, s66, v107
    v_cvt_pk_bf16_f32 v186, v104, v105
    v_cvt_pk_bf16_f32 v187, v106, v107
    v_mfma_f32_16x16x32_bf16 v[104:107], v[28:31], v[8:11], 0
    ds_read_b64_tr_b16 v[70:71], v5 offset:12800
    v_cvt_pk_bf16_f32 v200, v120, v121
    v_cvt_pk_bf16_f32 v201, v122, v123
    v_mfma_f32_16x16x32_bf16 v[120:123], v[32:35], v[8:11], 0
    ds_read_b64_tr_b16 v[72:73], v4 offset:13312
    v_cvt_pk_bf16_f32 v204, v124, v125
    v_cvt_pk_bf16_f32 v205, v126, v127
    v_mfma_f32_16x16x32_bf16 v[124:127], v[32:35], v[12:15], 0
    ds_read_b64_tr_b16 v[74:75], v4 offset:13824
    v_cvt_pk_bf16_f32 v208, v128, v129
    v_cvt_pk_bf16_f32 v209, v130, v131
    v_mfma_f32_16x16x32_bf16 v[128:131], v[32:35], v[16:19], 0
    ds_read_b64_tr_b16 v[76:77], v5 offset:13312
    v_cvt_pk_bf16_f32 v212, v132, v133
    v_cvt_pk_bf16_f32 v213, v134, v135
    v_mfma_f32_16x16x32_bf16 v[132:135], v[32:35], v[20:23], 0
    ds_read_b64_tr_b16 v[78:79], v5 offset:13824
    v_cvt_pk_bf16_f32 v214, v148, v149
    v_cvt_pk_bf16_f32 v215, v150, v151
    v_mfma_f32_16x16x32_bf16 v[148:151], v[36:39], v[20:23], 0
    ds_read_b64_tr_b16 v[80:81], v4 offset:14336
    v_cvt_pk_bf16_f32 v210, v144, v145
    v_cvt_pk_bf16_f32 v211, v146, v147
    v_mfma_f32_16x16x32_bf16 v[144:147], v[36:39], v[16:19], 0
    ds_read_b64_tr_b16 v[82:83], v4 offset:14848
    v_cvt_pk_bf16_f32 v206, v140, v141
    v_cvt_pk_bf16_f32 v207, v142, v143
    v_mfma_f32_16x16x32_bf16 v[140:143], v[36:39], v[12:15], 0
    ds_read_b64_tr_b16 v[84:85], v5 offset:14336
    v_cvt_pk_bf16_f32 v202, v136, v137
    v_cvt_pk_bf16_f32 v203, v138, v139
    v_mfma_f32_16x16x32_bf16 v[136:139], v[36:39], v[8:11], 0
    ds_read_b64_tr_b16 v[86:87], v5 offset:14848
    v_cvt_pk_bf16_f32 v216, v152, v153
    v_cvt_pk_bf16_f32 v217, v154, v155
    v_mfma_f32_16x16x32_bf16 v[152:155], v[8:11], v[40:43], 0
    v_add_u32 v2, s3, v2
    v_cvt_pk_bf16_f32 v218, v156, v157
    v_cvt_pk_bf16_f32 v219, v158, v159
    v_mfma_f32_16x16x32_bf16 v[156:159], v[12:15], v[40:43], 0
    v_add_u32 v3, s3, v3
    v_cvt_pk_bf16_f32 v224, v160, v161
    v_cvt_pk_bf16_f32 v225, v162, v163
    v_mfma_f32_16x16x32_bf16 v[160:163], v[16:19], v[40:43], 0
    v_add_u32 v4, s3, v4
    v_cvt_pk_bf16_f32 v226, v164, v165
    v_cvt_pk_bf16_f32 v227, v166, v167
    v_mfma_f32_16x16x32_bf16 v[164:167], v[20:23], v[40:43], 0
    v_add_u32 v5, s3, v5
    v_cvt_pk_bf16_f32 v230, v180, v181
    v_cvt_pk_bf16_f32 v231, v182, v183
    v_mfma_f32_16x16x32_bf16 v[180:183], v[20:23], v[44:47], 0
    s_cmp_eq_u32 s56, 1
    v_cvt_pk_bf16_f32 v228, v176, v177
    v_cvt_pk_bf16_f32 v229, v178, v179
    v_mfma_f32_16x16x32_bf16 v[176:179], v[16:19], v[44:47], 0
    v_cvt_pk_bf16_f32 v222, v172, v173
    v_cvt_pk_bf16_f32 v223, v174, v175
    v_mfma_f32_16x16x32_bf16 v[172:175], v[12:15], v[44:47], 0
    v_cvt_pk_bf16_f32 v220, v168, v169
    v_cvt_pk_bf16_f32 v221, v170, v171
    v_mfma_f32_16x16x32_bf16 v[168:171], v[8:11], v[44:47], 0
    s_cbranch_scc1 mega_kernel_q_cloop
    s_waitcnt lgkmcnt(0)
    s_barrier
    v_mfma_f32_16x16x32_bf16 v[88:91], v[64:67], v[48:51], v[88:91]
    ds_read_b64_tr_b16 v[24:25], v4 offset:0
    v_mfma_f32_16x16x32_bf16 v[92:95], v[64:67], v[52:55], v[92:95]
    ds_read_b64_tr_b16 v[26:27], v4 offset:512
    v_mfma_f32_16x16x32_bf16 v[96:99], v[64:67], v[56:59], v[96:99]
    ds_read_b128 v[8:11], v2 offset:0
    v_mfma_f32_16x16x32_bf16 v[100:103], v[64:67], v[60:63], v[100:103]
    ds_read_b128 v[12:15], v2 offset:1024
    v_mfma_f32_16x16x32_bf16 v[116:119], v[68:71], v[60:63], v[116:119]
    ds_read_b128 v[16:19], v2 offset:4096
    v_mfma_f32_16x16x32_bf16 v[112:115], v[68:71], v[56:59], v[112:115]
    ds_read_b128 v[20:23], v2 offset:5120
    v_mfma_f32_16x16x32_bf16 v[108:111], v[68:71], v[52:55], v[108:111]
    ds_read_b64_tr_b16 v[28:29], v5 offset:0
    v_mfma_f32_16x16x32_bf16 v[104:107], v[68:71], v[48:51], v[104:107]
    ds_read_b64_tr_b16 v[30:31], v5 offset:512
    v_mfma_f32_16x16x32_bf16 v[120:123], v[72:75], v[48:51], v[120:123]
    ds_read_b64_tr_b16 v[32:33], v4 offset:1024
    v_mfma_f32_16x16x32_bf16 v[124:127], v[72:75], v[52:55], v[124:127]
    ds_read_b64_tr_b16 v[34:35], v4 offset:1536
    v_mfma_f32_16x16x32_bf16 v[128:131], v[72:75], v[56:59], v[128:131]
    ds_read_b64_tr_b16 v[36:37], v5 offset:1024
    v_mfma_f32_16x16x32_bf16 v[132:135], v[72:75], v[60:63], v[132:135]
    ds_read_b64_tr_b16 v[38:39], v5 offset:1536
    buffer_store_dwordx4 v[200:203], v240, s[16:19], s65 offen offset:0 sc1
    v_mfma_f32_16x16x32_bf16 v[148:151], v[76:79], v[60:63], v[148:151]
    ds_read_b64_tr_b16 v[40:41], v4 offset:2048
    v_mfma_f32_16x16x32_bf16 v[144:147], v[76:79], v[56:59], v[144:147]
    ds_read_b64_tr_b16 v[42:43], v4 offset:2560
    v_mfma_f32_16x16x32_bf16 v[140:143], v[76:79], v[52:55], v[140:143]
    ds_read_b64_tr_b16 v[44:45], v5 offset:2048
    v_mfma_f32_16x16x32_bf16 v[136:139], v[76:79], v[48:51], v[136:139]
    ds_read_b64_tr_b16 v[46:47], v5 offset:2560
    v_mfma_f32_16x16x32_bf16 v[152:155], v[48:51], v[80:83], v[152:155]
    s_add_u32 s62, s62, 1
    v_mfma_f32_16x16x32_bf16 v[156:159], v[52:55], v[80:83], v[156:159]
    s_cmp_eq_u32 s62, 3
    v_mfma_f32_16x16x32_bf16 v[160:163], v[56:59], v[80:83], v[160:163]
    s_cselect_b32 s3, s59, s58
    v_mfma_f32_16x16x32_bf16 v[164:167], v[60:63], v[80:83], v[164:167]
    s_cselect_b32 s62, 0, s62
    v_mfma_f32_16x16x32_bf16 v[180:183], v[60:63], v[84:87], v[180:183]
    v_mfma_f32_16x16x32_bf16 v[176:179], v[56:59], v[84:87], v[176:179]
    v_mfma_f32_16x16x32_bf16 v[172:175], v[52:55], v[84:87], v[172:175]
    v_mfma_f32_16x16x32_bf16 v[168:171], v[48:51], v[84:87], v[168:171]
    buffer_store_dwordx4 v[204:207], v240, s[16:19], s65 offen offset:128 sc1
    s_waitcnt lgkmcnt(0)
    v_mfma_f32_16x16x32_bf16 v[88:91], v[24:27], v[8:11], v[88:91]
    ds_read_b64_tr_b16 v[64:65], v4 offset:12288
    v_mfma_f32_16x16x32_bf16 v[92:95], v[24:27], v[12:15], v[92:95]
    ds_read_b64_tr_b16 v[66:67], v4 offset:12800
    v_mfma_f32_16x16x32_bf16 v[96:99], v[24:27], v[16:19], v[96:99]
    ds_read_b128 v[48:51], v3 offset:0
    v_mfma_f32_16x16x32_bf16 v[100:103], v[24:27], v[20:23], v[100:103]
    ds_read_b128 v[52:55], v3 offset:1024
    v_mfma_f32_16x16x32_bf16 v[116:119], v[28:31], v[20:23], v[116:119]
    ds_read_b128 v[56:59], v3 offset:4096
    v_mfma_f32_16x16x32_bf16 v[112:115], v[28:31], v[16:19], v[112:115]
    ds_read_b128 v[60:63], v3 offset:5120
    v_mfma_f32_16x16x32_bf16 v[108:111], v[28:31], v[12:15], v[108:111]
    ds_read_b64_tr_b16 v[68:69], v5 offset:12288
    v_mfma_f32_16x16x32_bf16 v[104:107], v[28:31], v[8:11], v[104:107]
    ds_read_b64_tr_b16 v[70:71], v5 offset:12800
    v_mfma_f32_16x16x32_bf16 v[120:123], v[32:35], v[8:11], v[120:123]
    ds_read_b64_tr_b16 v[72:73], v4 offset:13312
    v_mfma_f32_16x16x32_bf16 v[124:127], v[32:35], v[12:15], v[124:127]
    ds_read_b64_tr_b16 v[74:75], v4 offset:13824
    v_mfma_f32_16x16x32_bf16 v[128:131], v[32:35], v[16:19], v[128:131]
    ds_read_b64_tr_b16 v[76:77], v5 offset:13312
    v_mfma_f32_16x16x32_bf16 v[132:135], v[32:35], v[20:23], v[132:135]
    ds_read_b64_tr_b16 v[78:79], v5 offset:13824
    buffer_store_dwordx4 v[208:211], v240, s[16:19], s63 offen offset:0 sc1
    v_mfma_f32_16x16x32_bf16 v[148:151], v[36:39], v[20:23], v[148:151]
    ds_read_b64_tr_b16 v[80:81], v4 offset:14336
    v_mfma_f32_16x16x32_bf16 v[144:147], v[36:39], v[16:19], v[144:147]
    ds_read_b64_tr_b16 v[82:83], v4 offset:14848
    v_mfma_f32_16x16x32_bf16 v[140:143], v[36:39], v[12:15], v[140:143]
    ds_read_b64_tr_b16 v[84:85], v5 offset:14336
    v_mfma_f32_16x16x32_bf16 v[136:139], v[36:39], v[8:11], v[136:139]
    ds_read_b64_tr_b16 v[86:87], v5 offset:14848
    v_mfma_f32_16x16x32_bf16 v[152:155], v[8:11], v[40:43], v[152:155]
    v_add_u32 v2, s3, v2
    v_mfma_f32_16x16x32_bf16 v[156:159], v[12:15], v[40:43], v[156:159]
    v_add_u32 v3, s3, v3
    v_mfma_f32_16x16x32_bf16 v[160:163], v[16:19], v[40:43], v[160:163]
    v_add_u32 v4, s3, v4
    v_mfma_f32_16x16x32_bf16 v[164:167], v[20:23], v[40:43], v[164:167]
    v_add_u32 v5, s3, v5
    v_mfma_f32_16x16x32_bf16 v[180:183], v[20:23], v[44:47], v[180:183]
    v_mfma_f32_16x16x32_bf16 v[176:179], v[16:19], v[44:47], v[176:179]
    v_mfma_f32_16x16x32_bf16 v[172:175], v[12:15], v[44:47], v[172:175]
    v_mfma_f32_16x16x32_bf16 v[168:171], v[8:11], v[44:47], v[168:171]
    buffer_store_dwordx4 v[212:215], v240, s[16:19], s63 offen offset:128 sc1
    s_waitcnt lgkmcnt(0)
    s_barrier
    v_mfma_f32_16x16x32_bf16 v[88:91], v[64:67], v[48:51], v[88:91]
    ds_read_b64_tr_b16 v[24:25], v4 offset:0
    v_mfma_f32_16x16x32_bf16 v[92:95], v[64:67], v[52:55], v[92:95]
    ds_read_b64_tr_b16 v[26:27], v4 offset:512
    v_mfma_f32_16x16x32_bf16 v[96:99], v[64:67], v[56:59], v[96:99]
    ds_read_b128 v[8:11], v2 offset:0
    v_mfma_f32_16x16x32_bf16 v[100:103], v[64:67], v[60:63], v[100:103]
    ds_read_b128 v[12:15], v2 offset:1024
    v_mfma_f32_16x16x32_bf16 v[116:119], v[68:71], v[60:63], v[116:119]
    ds_read_b128 v[16:19], v2 offset:4096
    v_mfma_f32_16x16x32_bf16 v[112:115], v[68:71], v[56:59], v[112:115]
    ds_read_b128 v[20:23], v2 offset:5120
    v_mfma_f32_16x16x32_bf16 v[108:111], v[68:71], v[52:55], v[108:111]
    ds_read_b64_tr_b16 v[28:29], v5 offset:0
    v_mfma_f32_16x16x32_bf16 v[104:107], v[68:71], v[48:51], v[104:107]
    ds_read_b64_tr_b16 v[30:31], v5 offset:512
    v_mfma_f32_16x16x32_bf16 v[120:123], v[72:75], v[48:51], v[120:123]
    ds_read_b64_tr_b16 v[32:33], v4 offset:1024
    v_mfma_f32_16x16x32_bf16 v[124:127], v[72:75], v[52:55], v[124:127]
    ds_read_b64_tr_b16 v[34:35], v4 offset:1536
    v_mfma_f32_16x16x32_bf16 v[128:131], v[72:75], v[56:59], v[128:131]
    ds_read_b64_tr_b16 v[36:37], v5 offset:1024
    v_mfma_f32_16x16x32_bf16 v[132:135], v[72:75], v[60:63], v[132:135]
    ds_read_b64_tr_b16 v[38:39], v5 offset:1536
    buffer_store_dwordx4 v[216:219], v241, s[16:19], s60 offen offset:2048 sc1
    v_mfma_f32_16x16x32_bf16 v[148:151], v[76:79], v[60:63], v[148:151]
    ds_read_b64_tr_b16 v[40:41], v4 offset:2048
    v_mfma_f32_16x16x32_bf16 v[144:147], v[76:79], v[56:59], v[144:147]
    ds_read_b64_tr_b16 v[42:43], v4 offset:2560
    v_mfma_f32_16x16x32_bf16 v[140:143], v[76:79], v[52:55], v[140:143]
    ds_read_b64_tr_b16 v[44:45], v5 offset:2048
    v_mfma_f32_16x16x32_bf16 v[136:139], v[76:79], v[48:51], v[136:139]
    ds_read_b64_tr_b16 v[46:47], v5 offset:2560
    v_mfma_f32_16x16x32_bf16 v[152:155], v[48:51], v[80:83], v[152:155]
    s_add_u32 s62, s62, 1
    v_mfma_f32_16x16x32_bf16 v[156:159], v[52:55], v[80:83], v[156:159]
    s_cmp_eq_u32 s62, 3
    v_mfma_f32_16x16x32_bf16 v[160:163], v[56:59], v[80:83], v[160:163]
    s_cselect_b32 s3, s59, s58
    v_mfma_f32_16x16x32_bf16 v[164:167], v[60:63], v[80:83], v[164:167]
    s_cselect_b32 s62, 0, s62
    v_mfma_f32_16x16x32_bf16 v[180:183], v[60:63], v[84:87], v[180:183]
    v_mfma_f32_16x16x32_bf16 v[176:179], v[56:59], v[84:87], v[176:179]
    v_mfma_f32_16x16x32_bf16 v[172:175], v[52:55], v[84:87], v[172:175]
    v_mfma_f32_16x16x32_bf16 v[168:171], v[48:51], v[84:87], v[168:171]
    buffer_store_dwordx4 v[220:223], v241, s[16:19], s60 offen offset:2304 sc1
    s_waitcnt lgkmcnt(0)
    v_mfma_f32_16x16x32_bf16 v[88:91], v[24:27], v[8:11], v[88:91]
    ds_read_b64_tr_b16 v[64:65], v4 offset:12288
    v_mfma_f32_16x16x32_bf16 v[92:95], v[24:27], v[12:15], v[92:95]
    ds_read_b64_tr_b16 v[66:67], v4 offset:12800
    v_mfma_f32_16x16x32_bf16 v[96:99], v[24:27], v[16:19], v[96:99]
    ds_read_b128 v[48:51], v3 offset:0
    v_mfma_f32_16x16x32_bf16 v[100:103], v[24:27], v[20:23], v[100:103]
    ds_read_b128 v[52:55], v3 offset:1024
    v_mfma_f32_16x16x32_bf16 v[116:119], v[28:31], v[20:23], v[116:119]
    ds_read_b128 v[56:59], v3 offset:4096
    v_mfma_f32_16x16x32_bf16 v[112:115], v[28:31], v[16:19], v[112:115]
    ds_read_b128 v[60:63], v3 offset:5120
    v_mfma_f32_16x16x32_bf16 v[108:111], v[28:31], v[12:15], v[108:111]
    ds_read_b64_tr_b16 v[68:69], v5 offset:12288
    v_mfma_f32_16x16x32_bf16 v[104:107], v[28:31], v[8:11], v[104:107]
    ds_read_b64_tr_b16 v[70:71], v5 offset:12800
    v_mfma_f32_16x16x32_bf16 v[120:123], v[32:35], v[8:11], v[120:123]
    ds_read_b64_tr_b16 v[72:73], v4 offset:13312
    v_mfma_f32_16x16x32_bf16 v[124:127], v[32:35], v[12:15], v[124:127]
    ds_read_b64_tr_b16 v[74:75], v4 offset:13824
    v_mfma_f32_16x16x32_bf16 v[128:131], v[32:35], v[16:19], v[128:131]
    ds_read_b64_tr_b16 v[76:77], v5 offset:13312
    v_mfma_f32_16x16x32_bf16 v[132:135], v[32:35], v[20:23], v[132:135]
    ds_read_b64_tr_b16 v[78:79], v5 offset:13824
    buffer_store_dwordx4 v[224:227], v241, s[16:19], s61 offen offset:2048 sc1
    v_mfma_f32_16x16x32_bf16 v[148:151], v[36:39], v[20:23], v[148:151]
    ds_read_b64_tr_b16 v[80:81], v4 offset:14336
    v_mfma_f32_16x16x32_bf16 v[144:147], v[36:39], v[16:19], v[144:147]
    ds_read_b64_tr_b16 v[82:83], v4 offset:14848
    v_mfma_f32_16x16x32_bf16 v[140:143], v[36:39], v[12:15], v[140:143]
    ds_read_b64_tr_b16 v[84:85], v5 offset:14336
    v_mfma_f32_16x16x32_bf16 v[136:139], v[36:39], v[8:11], v[136:139]
    ds_read_b64_tr_b16 v[86:87], v5 offset:14848
    v_mfma_f32_16x16x32_bf16 v[152:155], v[8:11], v[40:43], v[152:155]
    v_add_u32 v2, s3, v2
    v_mfma_f32_16x16x32_bf16 v[156:159], v[12:15], v[40:43], v[156:159]
    v_add_u32 v3, s3, v3
    v_mfma_f32_16x16x32_bf16 v[160:163], v[16:19], v[40:43], v[160:163]
    v_add_u32 v4, s3, v4
    v_mfma_f32_16x16x32_bf16 v[164:167], v[20:23], v[40:43], v[164:167]
    v_add_u32 v5, s3, v5
    v_mfma_f32_16x16x32_bf16 v[180:183], v[20:23], v[44:47], v[180:183]
    v_mfma_f32_16x16x32_bf16 v[176:179], v[16:19], v[44:47], v[176:179]
    v_mfma_f32_16x16x32_bf16 v[172:175], v[12:15], v[44:47], v[172:175]
    v_mfma_f32_16x16x32_bf16 v[168:171], v[8:11], v[44:47], v[168:171]
    buffer_store_dwordx4 v[228:231], v241, s[16:19], s61 offen offset:2304 sc1
    s_waitcnt lgkmcnt(0)
    s_barrier
    v_mfma_f32_16x16x32_bf16 v[88:91], v[64:67], v[48:51], v[88:91]
    ds_read_b64_tr_b16 v[24:25], v4 offset:0
    v_mfma_f32_16x16x32_bf16 v[92:95], v[64:67], v[52:55], v[92:95]
    ds_read_b64_tr_b16 v[26:27], v4 offset:512
    v_mfma_f32_16x16x32_bf16 v[96:99], v[64:67], v[56:59], v[96:99]
    ds_read_b128 v[8:11], v2 offset:0
    v_mfma_f32_16x16x32_bf16 v[100:103], v[64:67], v[60:63], v[100:103]
    ds_read_b128 v[12:15], v2 offset:1024
    v_mfma_f32_16x16x32_bf16 v[116:119], v[68:71], v[60:63], v[116:119]
    ds_read_b128 v[16:19], v2 offset:4096
    v_mfma_f32_16x16x32_bf16 v[112:115], v[68:71], v[56:59], v[112:115]
    ds_read_b128 v[20:23], v2 offset:5120
    v_mfma_f32_16x16x32_bf16 v[108:111], v[68:71], v[52:55], v[108:111]
    ds_read_b64_tr_b16 v[28:29], v5 offset:0
    v_mfma_f32_16x16x32_bf16 v[104:107], v[68:71], v[48:51], v[104:107]
    ds_read_b64_tr_b16 v[30:31], v5 offset:512
    v_mfma_f32_16x16x32_bf16 v[120:123], v[72:75], v[48:51], v[120:123]
    ds_read_b64_tr_b16 v[32:33], v4 offset:1024
    v_mfma_f32_16x16x32_bf16 v[124:127], v[72:75], v[52:55], v[124:127]
    ds_read_b64_tr_b16 v[34:35], v4 offset:1536
    v_mfma_f32_16x16x32_bf16 v[128:131], v[72:75], v[56:59], v[128:131]
    ds_read_b64_tr_b16 v[36:37], v5 offset:1024
    v_mfma_f32_16x16x32_bf16 v[132:135], v[72:75], v[60:63], v[132:135]
    ds_read_b64_tr_b16 v[38:39], v5 offset:1536
    buffer_store_dwordx4 v[184:187], v240, s[16:19], s64 offen offset:0 sc1
    v_mfma_f32_16x16x32_bf16 v[148:151], v[76:79], v[60:63], v[148:151]
    ds_read_b64_tr_b16 v[40:41], v4 offset:2048
    v_mfma_f32_16x16x32_bf16 v[144:147], v[76:79], v[56:59], v[144:147]
    ds_read_b64_tr_b16 v[42:43], v4 offset:2560
    v_mfma_f32_16x16x32_bf16 v[140:143], v[76:79], v[52:55], v[140:143]
    ds_read_b64_tr_b16 v[44:45], v5 offset:2048
    v_mfma_f32_16x16x32_bf16 v[136:139], v[76:79], v[48:51], v[136:139]
    ds_read_b64_tr_b16 v[46:47], v5 offset:2560
    v_mfma_f32_16x16x32_bf16 v[152:155], v[48:51], v[80:83], v[152:155]
    s_add_u32 s62, s62, 1
    v_mfma_f32_16x16x32_bf16 v[156:159], v[52:55], v[80:83], v[156:159]
    s_cmp_eq_u32 s62, 3
    v_mfma_f32_16x16x32_bf16 v[160:163], v[56:59], v[80:83], v[160:163]
    s_cselect_b32 s3, s59, s58
    v_mfma_f32_16x16x32_bf16 v[164:167], v[60:63], v[80:83], v[164:167]
    s_cselect_b32 s62, 0, s62
    v_mfma_f32_16x16x32_bf16 v[180:183], v[60:63], v[84:87], v[180:183]
    v_mfma_f32_16x16x32_bf16 v[176:179], v[56:59], v[84:87], v[176:179]
    v_mfma_f32_16x16x32_bf16 v[172:175], v[52:55], v[84:87], v[172:175]
    v_mfma_f32_16x16x32_bf16 v[168:171], v[48:51], v[84:87], v[168:171]
    buffer_store_dwordx4 v[188:191], v240, s[16:19], s64 offen offset:128 sc1
    s_waitcnt lgkmcnt(0)
    v_mfma_f32_16x16x32_bf16 v[88:91], v[24:27], v[8:11], v[88:91]
    ds_read_b64_tr_b16 v[64:65], v4 offset:12288
    v_mfma_f32_16x16x32_bf16 v[92:95], v[24:27], v[12:15], v[92:95]
    ds_read_b64_tr_b16 v[66:67], v4 offset:12800
    v_mfma_f32_16x16x32_bf16 v[96:99], v[24:27], v[16:19], v[96:99]
    ds_read_b128 v[48:51], v3 offset:0
    v_mfma_f32_16x16x32_bf16 v[100:103], v[24:27], v[20:23], v[100:103]
    ds_read_b128 v[52:55], v3 offset:1024
    v_mfma_f32_16x16x32_bf16 v[116:119], v[28:31], v[20:23], v[116:119]
    ds_read_b128 v[56:59], v3 offset:4096
    v_mfma_f32_16x16x32_bf16 v[112:115], v[28:31], v[16:19], v[112:115]
    ds_read_b128 v[60:63], v3 offset:5120
    v_mfma_f32_16x16x32_bf16 v[108:111], v[28:31], v[12:15], v[108:111]
    ds_read_b64_tr_b16 v[68:69], v5 offset:12288
    v_mfma_f32_16x16x32_bf16 v[104:107], v[28:31], v[8:11], v[104:107]
    ds_read_b64_tr_b16 v[70:71], v5 offset:12800
    v_mfma_f32_16x16x32_bf16 v[120:123], v[32:35], v[8:11], v[120:123]
    ds_read_b64_tr_b16 v[72:73], v4 offset:13312
    v_mfma_f32_16x16x32_bf16 v[124:127], v[32:35], v[12:15], v[124:127]
    ds_read_b64_tr_b16 v[74:75], v4 offset:13824
    v_mfma_f32_16x16x32_bf16 v[128:131], v[32:35], v[16:19], v[128:131]
    ds_read_b64_tr_b16 v[76:77], v5 offset:13312
    v_mfma_f32_16x16x32_bf16 v[132:135], v[32:35], v[20:23], v[132:135]
    ds_read_b64_tr_b16 v[78:79], v5 offset:13824
    buffer_store_dwordx4 v[192:195], v240, s[16:19], s64 offen offset:2048 sc1
    v_mfma_f32_16x16x32_bf16 v[148:151], v[36:39], v[20:23], v[148:151]
    ds_read_b64_tr_b16 v[80:81], v4 offset:14336
    v_mfma_f32_16x16x32_bf16 v[144:147], v[36:39], v[16:19], v[144:147]
    ds_read_b64_tr_b16 v[82:83], v4 offset:14848
    v_mfma_f32_16x16x32_bf16 v[140:143], v[36:39], v[12:15], v[140:143]
    ds_read_b64_tr_b16 v[84:85], v5 offset:14336
    v_mfma_f32_16x16x32_bf16 v[136:139], v[36:39], v[8:11], v[136:139]
    ds_read_b64_tr_b16 v[86:87], v5 offset:14848
    v_mfma_f32_16x16x32_bf16 v[152:155], v[8:11], v[40:43], v[152:155]
    v_add_u32 v2, s3, v2
    v_mfma_f32_16x16x32_bf16 v[156:159], v[12:15], v[40:43], v[156:159]
    v_add_u32 v3, s3, v3
    v_mfma_f32_16x16x32_bf16 v[160:163], v[16:19], v[40:43], v[160:163]
    v_add_u32 v4, s3, v4
    v_mfma_f32_16x16x32_bf16 v[164:167], v[20:23], v[40:43], v[164:167]
    v_add_u32 v5, s3, v5
    v_mfma_f32_16x16x32_bf16 v[180:183], v[20:23], v[44:47], v[180:183]
    v_mfma_f32_16x16x32_bf16 v[176:179], v[16:19], v[44:47], v[176:179]
    v_mfma_f32_16x16x32_bf16 v[172:175], v[12:15], v[44:47], v[172:175]
    v_mfma_f32_16x16x32_bf16 v[168:171], v[8:11], v[44:47], v[168:171]
    buffer_store_dwordx4 v[196:199], v240, s[16:19], s64 offen offset:2176 sc1
    s_waitcnt lgkmcnt(0)
    s_barrier
    v_mfma_f32_16x16x32_bf16 v[88:91], v[64:67], v[48:51], v[88:91]
    ds_read_b64_tr_b16 v[24:25], v4 offset:0
    v_mfma_f32_16x16x32_bf16 v[92:95], v[64:67], v[52:55], v[92:95]
    ds_read_b64_tr_b16 v[26:27], v4 offset:512
    v_mfma_f32_16x16x32_bf16 v[96:99], v[64:67], v[56:59], v[96:99]
    ds_read_b128 v[8:11], v2 offset:0
    v_mfma_f32_16x16x32_bf16 v[100:103], v[64:67], v[60:63], v[100:103]
    ds_read_b128 v[12:15], v2 offset:1024
    v_mfma_f32_16x16x32_bf16 v[116:119], v[68:71], v[60:63], v[116:119]
    ds_read_b128 v[16:19], v2 offset:4096
    v_mfma_f32_16x16x32_bf16 v[112:115], v[68:71], v[56:59], v[112:115]
    ds_read_b128 v[20:23], v2 offset:5120
    v_mfma_f32_16x16x32_bf16 v[108:111], v[68:71], v[52:55], v[108:111]
    ds_read_b64_tr_b16 v[28:29], v5 offset:0
    v_mfma_f32_16x16x32_bf16 v[104:107], v[68:71], v[48:51], v[104:107]
    ds_read_b64_tr_b16 v[30:31], v5 offset:512
    v_mfma_f32_16x16x32_bf16 v[120:123], v[72:75], v[48:51], v[120:123]
    ds_read_b64_tr_b16 v[32:33], v4 offset:1024
    v_mfma_f32_16x16x32_bf16 v[124:127], v[72:75], v[52:55], v[124:127]
    ds_read_b64_tr_b16 v[34:35], v4 offset:1536
    v_mfma_f32_16x16x32_bf16 v[128:131], v[72:75], v[56:59], v[128:131]
    ds_read_b64_tr_b16 v[36:37], v5 offset:1024
    v_mfma_f32_16x16x32_bf16 v[132:135], v[72:75], v[60:63], v[132:135]
    ds_read_b64_tr_b16 v[38:39], v5 offset:1536
    v_mfma_f32_16x16x32_bf16 v[148:151], v[76:79], v[60:63], v[148:151]
    ds_read_b64_tr_b16 v[40:41], v4 offset:2048
    v_mfma_f32_16x16x32_bf16 v[144:147], v[76:79], v[56:59], v[144:147]
    ds_read_b64_tr_b16 v[42:43], v4 offset:2560
    v_mfma_f32_16x16x32_bf16 v[140:143], v[76:79], v[52:55], v[140:143]
    ds_read_b64_tr_b16 v[44:45], v5 offset:2048
    v_mfma_f32_16x16x32_bf16 v[136:139], v[76:79], v[48:51], v[136:139]
    ds_read_b64_tr_b16 v[46:47], v5 offset:2560
    v_mfma_f32_16x16x32_bf16 v[152:155], v[48:51], v[80:83], v[152:155]
    s_add_u32 s62, s62, 1
    v_mfma_f32_16x16x32_bf16 v[156:159], v[52:55], v[80:83], v[156:159]
    s_cmp_eq_u32 s62, 3
    v_mfma_f32_16x16x32_bf16 v[160:163], v[56:59], v[80:83], v[160:163]
    s_cselect_b32 s3, s59, s58
    v_mfma_f32_16x16x32_bf16 v[164:167], v[60:63], v[80:83], v[164:167]
    s_cselect_b32 s62, 0, s62
    v_mfma_f32_16x16x32_bf16 v[180:183], v[60:63], v[84:87], v[180:183]
    v_mfma_f32_16x16x32_bf16 v[176:179], v[56:59], v[84:87], v[176:179]
    v_mfma_f32_16x16x32_bf16 v[172:175], v[52:55], v[84:87], v[172:175]
    v_mfma_f32_16x16x32_bf16 v[168:171], v[48:51], v[84:87], v[168:171]
    s_waitcnt lgkmcnt(0)
    v_mfma_f32_16x16x32_bf16 v[88:91], v[24:27], v[8:11], v[88:91]
    ds_read_b64_tr_b16 v[64:65], v4 offset:12288
    v_mfma_f32_16x16x32_bf16 v[92:95], v[24:27], v[12:15], v[92:95]
    ds_read_b64_tr_b16 v[66:67], v4 offset:12800
    v_mfma_f32_16x16x32_bf16 v[96:99], v[24:27], v[16:19], v[96:99]
    ds_read_b128 v[48:51], v3 offset:0
    v_mfma_f32_16x16x32_bf16 v[100:103], v[24:27], v[20:23], v[100:103]
    ds_read_b128 v[52:55], v3 offset:1024
    v_mfma_f32_16x16x32_bf16 v[116:119], v[28:31], v[20:23], v[116:119]
    ds_read_b128 v[56:59], v3 offset:4096
    v_mfma_f32_16x16x32_bf16 v[112:115], v[28:31], v[16:19], v[112:115]
    ds_read_b128 v[60:63], v3 offset:5120
    v_mfma_f32_16x16x32_bf16 v[108:111], v[28:31], v[12:15], v[108:111]
    ds_read_b64_tr_b16 v[68:69], v5 offset:12288
    v_mfma_f32_16x16x32_bf16 v[104:107], v[28:31], v[8:11], v[104:107]
    ds_read_b64_tr_b16 v[70:71], v5 offset:12800
    v_mfma_f32_16x16x32_bf16 v[120:123], v[32:35], v[8:11], v[120:123]
    ds_read_b64_tr_b16 v[72:73], v4 offset:13312
    v_mfma_f32_16x16x32_bf16 v[124:127], v[32:35], v[12:15], v[124:127]
    ds_read_b64_tr_b16 v[74:75], v4 offset:13824
    v_mfma_f32_16x16x32_bf16 v[128:131], v[32:35], v[16:19], v[128:131]
    ds_read_b64_tr_b16 v[76:77], v5 offset:13312
    v_mfma_f32_16x16x32_bf16 v[132:135], v[32:35], v[20:23], v[132:135]
    ds_read_b64_tr_b16 v[78:79], v5 offset:13824
    v_mfma_f32_16x16x32_bf16 v[148:151], v[36:39], v[20:23], v[148:151]
    ds_read_b64_tr_b16 v[80:81], v4 offset:14336
    v_mfma_f32_16x16x32_bf16 v[144:147], v[36:39], v[16:19], v[144:147]
    ds_read_b64_tr_b16 v[82:83], v4 offset:14848
    v_mfma_f32_16x16x32_bf16 v[140:143], v[36:39], v[12:15], v[140:143]
    ds_read_b64_tr_b16 v[84:85], v5 offset:14336
    v_mfma_f32_16x16x32_bf16 v[136:139], v[36:39], v[8:11], v[136:139]
    ds_read_b64_tr_b16 v[86:87], v5 offset:14848
    v_mfma_f32_16x16x32_bf16 v[152:155], v[8:11], v[40:43], v[152:155]
    v_add_u32 v2, s3, v2
    v_mfma_f32_16x16x32_bf16 v[156:159], v[12:15], v[40:43], v[156:159]
    v_add_u32 v3, s3, v3
    v_mfma_f32_16x16x32_bf16 v[160:163], v[16:19], v[40:43], v[160:163]
    v_add_u32 v4, s3, v4
    v_mfma_f32_16x16x32_bf16 v[164:167], v[20:23], v[40:43], v[164:167]
    v_add_u32 v5, s3, v5
    v_mfma_f32_16x16x32_bf16 v[180:183], v[20:23], v[44:47], v[180:183]
    v_mfma_f32_16x16x32_bf16 v[176:179], v[16:19], v[44:47], v[176:179]
    v_mfma_f32_16x16x32_bf16 v[172:175], v[12:15], v[44:47], v[172:175]
    v_mfma_f32_16x16x32_bf16 v[168:171], v[8:11], v[44:47], v[168:171]
    s_waitcnt lgkmcnt(0)
    s_barrier
    v_mfma_f32_16x16x32_bf16 v[88:91], v[64:67], v[48:51], v[88:91]
    ds_read_b64_tr_b16 v[24:25], v4 offset:0
    v_mfma_f32_16x16x32_bf16 v[92:95], v[64:67], v[52:55], v[92:95]
    ds_read_b64_tr_b16 v[26:27], v4 offset:512
    v_mfma_f32_16x16x32_bf16 v[96:99], v[64:67], v[56:59], v[96:99]
    ds_read_b128 v[8:11], v2 offset:0
    v_mfma_f32_16x16x32_bf16 v[100:103], v[64:67], v[60:63], v[100:103]
    ds_read_b128 v[12:15], v2 offset:1024
    v_mfma_f32_16x16x32_bf16 v[116:119], v[68:71], v[60:63], v[116:119]
    ds_read_b128 v[16:19], v2 offset:4096
    v_mfma_f32_16x16x32_bf16 v[112:115], v[68:71], v[56:59], v[112:115]
    ds_read_b128 v[20:23], v2 offset:5120
    v_mfma_f32_16x16x32_bf16 v[108:111], v[68:71], v[52:55], v[108:111]
    ds_read_b64_tr_b16 v[28:29], v5 offset:0
    v_mfma_f32_16x16x32_bf16 v[104:107], v[68:71], v[48:51], v[104:107]
    ds_read_b64_tr_b16 v[30:31], v5 offset:512
    v_mfma_f32_16x16x32_bf16 v[120:123], v[72:75], v[48:51], v[120:123]
    ds_read_b64_tr_b16 v[32:33], v4 offset:1024
    v_mfma_f32_16x16x32_bf16 v[124:127], v[72:75], v[52:55], v[124:127]
    ds_read_b64_tr_b16 v[34:35], v4 offset:1536
    v_mfma_f32_16x16x32_bf16 v[128:131], v[72:75], v[56:59], v[128:131]
    ds_read_b64_tr_b16 v[36:37], v5 offset:1024
    v_mfma_f32_16x16x32_bf16 v[132:135], v[72:75], v[60:63], v[132:135]
    ds_read_b64_tr_b16 v[38:39], v5 offset:1536
    v_mfma_f32_16x16x32_bf16 v[148:151], v[76:79], v[60:63], v[148:151]
    ds_read_b64_tr_b16 v[40:41], v4 offset:2048
    v_mfma_f32_16x16x32_bf16 v[144:147], v[76:79], v[56:59], v[144:147]
    ds_read_b64_tr_b16 v[42:43], v4 offset:2560
    v_mfma_f32_16x16x32_bf16 v[140:143], v[76:79], v[52:55], v[140:143]
    ds_read_b64_tr_b16 v[44:45], v5 offset:2048
    v_mfma_f32_16x16x32_bf16 v[136:139], v[76:79], v[48:51], v[136:139]
    ds_read_b64_tr_b16 v[46:47], v5 offset:2560
    v_mfma_f32_16x16x32_bf16 v[152:155], v[48:51], v[80:83], v[152:155]
    s_add_u32 s62, s62, 1
    v_mfma_f32_16x16x32_bf16 v[156:159], v[52:55], v[80:83], v[156:159]
    s_cmp_eq_u32 s62, 3
    v_mfma_f32_16x16x32_bf16 v[160:163], v[56:59], v[80:83], v[160:163]
    s_cselect_b32 s3, s59, s58
    v_mfma_f32_16x16x32_bf16 v[164:167], v[60:63], v[80:83], v[164:167]
    s_cselect_b32 s62, 0, s62
    v_mfma_f32_16x16x32_bf16 v[180:183], v[60:63], v[84:87], v[180:183]
    v_mfma_f32_16x16x32_bf16 v[176:179], v[56:59], v[84:87], v[176:179]
    v_mfma_f32_16x16x32_bf16 v[172:175], v[52:55], v[84:87], v[172:175]
    v_mfma_f32_16x16x32_bf16 v[168:171], v[48:51], v[84:87], v[168:171]
    s_waitcnt lgkmcnt(0)
    v_mfma_f32_16x16x32_bf16 v[88:91], v[24:27], v[8:11], v[88:91]
    ds_read_b64_tr_b16 v[64:65], v4 offset:12288
    v_mfma_f32_16x16x32_bf16 v[92:95], v[24:27], v[12:15], v[92:95]
    ds_read_b64_tr_b16 v[66:67], v4 offset:12800
    v_mfma_f32_16x16x32_bf16 v[96:99], v[24:27], v[16:19], v[96:99]
    ds_read_b128 v[48:51], v3 offset:0
    v_mfma_f32_16x16x32_bf16 v[100:103], v[24:27], v[20:23], v[100:103]
    ds_read_b128 v[52:55], v3 offset:1024
    v_mfma_f32_16x16x32_bf16 v[116:119], v[28:31], v[20:23], v[116:119]
    ds_read_b128 v[56:59], v3 offset:4096
    v_mfma_f32_16x16x32_bf16 v[112:115], v[28:31], v[16:19], v[112:115]
    ds_read_b128 v[60:63], v3 offset:5120
    v_mfma_f32_16x16x32_bf16 v[108:111], v[28:31], v[12:15], v[108:111]
    ds_read_b64_tr_b16 v[68:69], v5 offset:12288
    v_mfma_f32_16x16x32_bf16 v[104:107], v[28:31], v[8:11], v[104:107]
    ds_read_b64_tr_b16 v[70:71], v5 offset:12800
    v_mfma_f32_16x16x32_bf16 v[120:123], v[32:35], v[8:11], v[120:123]
    ds_read_b64_tr_b16 v[72:73], v4 offset:13312
    v_mfma_f32_16x16x32_bf16 v[124:127], v[32:35], v[12:15], v[124:127]
    ds_read_b64_tr_b16 v[74:75], v4 offset:13824
    v_mfma_f32_16x16x32_bf16 v[128:131], v[32:35], v[16:19], v[128:131]
    ds_read_b64_tr_b16 v[76:77], v5 offset:13312
    v_mfma_f32_16x16x32_bf16 v[132:135], v[32:35], v[20:23], v[132:135]
    ds_read_b64_tr_b16 v[78:79], v5 offset:13824
    v_mfma_f32_16x16x32_bf16 v[148:151], v[36:39], v[20:23], v[148:151]
    ds_read_b64_tr_b16 v[80:81], v4 offset:14336
    v_mfma_f32_16x16x32_bf16 v[144:147], v[36:39], v[16:19], v[144:147]
    ds_read_b64_tr_b16 v[82:83], v4 offset:14848
    v_mfma_f32_16x16x32_bf16 v[140:143], v[36:39], v[12:15], v[140:143]
    ds_read_b64_tr_b16 v[84:85], v5 offset:14336
    v_mfma_f32_16x16x32_bf16 v[136:139], v[36:39], v[8:11], v[136:139]
    ds_read_b64_tr_b16 v[86:87], v5 offset:14848
    v_mfma_f32_16x16x32_bf16 v[152:155], v[8:11], v[40:43], v[152:155]
    v_add_u32 v2, s3, v2
    v_mfma_f32_16x16x32_bf16 v[156:159], v[12:15], v[40:43], v[156:159]
    v_add_u32 v3, s3, v3
    v_mfma_f32_16x16x32_bf16 v[160:163], v[16:19], v[40:43], v[160:163]
    v_add_u32 v4, s3, v4
    v_mfma_f32_16x16x32_bf16 v[164:167], v[20:23], v[40:43], v[164:167]
    v_add_u32 v5, s3, v5
    v_mfma_f32_16x16x32_bf16 v[180:183], v[20:23], v[44:47], v[180:183]
    s_waitcnt vmcnt(0)
    v_mfma_f32_16x16x32_bf16 v[176:179], v[16:19], v[44:47], v[176:179]
    v_mfma_f32_16x16x32_bf16 v[172:175], v[12:15], v[44:47], v[172:175]
    v_mfma_f32_16x16x32_bf16 v[168:171], v[8:11], v[44:47], v[168:171]
    s_waitcnt lgkmcnt(0)
    s_barrier
    v_mfma_f32_16x16x32_bf16 v[88:91], v[64:67], v[48:51], v[88:91]
    ds_read_b64_tr_b16 v[24:25], v4 offset:0
    v_mfma_f32_16x16x32_bf16 v[92:95], v[64:67], v[52:55], v[92:95]
    ds_read_b64_tr_b16 v[26:27], v4 offset:512
    v_mfma_f32_16x16x32_bf16 v[96:99], v[64:67], v[56:59], v[96:99]
    ds_read_b128 v[8:11], v2 offset:0
    v_mfma_f32_16x16x32_bf16 v[100:103], v[64:67], v[60:63], v[100:103]
    ds_read_b128 v[12:15], v2 offset:1024
    v_mfma_f32_16x16x32_bf16 v[116:119], v[68:71], v[60:63], v[116:119]
    ds_read_b128 v[16:19], v2 offset:4096
    v_mfma_f32_16x16x32_bf16 v[112:115], v[68:71], v[56:59], v[112:115]
    ds_read_b128 v[20:23], v2 offset:5120
    v_mfma_f32_16x16x32_bf16 v[108:111], v[68:71], v[52:55], v[108:111]
    ds_read_b64_tr_b16 v[28:29], v5 offset:0
    v_mfma_f32_16x16x32_bf16 v[104:107], v[68:71], v[48:51], v[104:107]
    ds_read_b64_tr_b16 v[30:31], v5 offset:512
    v_mfma_f32_16x16x32_bf16 v[120:123], v[72:75], v[48:51], v[120:123]
    ds_read_b64_tr_b16 v[32:33], v4 offset:1024
    v_mfma_f32_16x16x32_bf16 v[124:127], v[72:75], v[52:55], v[124:127]
    ds_read_b64_tr_b16 v[34:35], v4 offset:1536
    v_mfma_f32_16x16x32_bf16 v[128:131], v[72:75], v[56:59], v[128:131]
    ds_read_b64_tr_b16 v[36:37], v5 offset:1024
    v_mfma_f32_16x16x32_bf16 v[132:135], v[72:75], v[60:63], v[132:135]
    ds_read_b64_tr_b16 v[38:39], v5 offset:1536
    v_mfma_f32_16x16x32_bf16 v[148:151], v[76:79], v[60:63], v[148:151]
    ds_read_b64_tr_b16 v[40:41], v4 offset:2048
    v_mfma_f32_16x16x32_bf16 v[144:147], v[76:79], v[56:59], v[144:147]
    ds_read_b64_tr_b16 v[42:43], v4 offset:2560
    v_mfma_f32_16x16x32_bf16 v[140:143], v[76:79], v[52:55], v[140:143]
    ds_read_b64_tr_b16 v[44:45], v5 offset:2048
    v_mfma_f32_16x16x32_bf16 v[136:139], v[76:79], v[48:51], v[136:139]
    ds_read_b64_tr_b16 v[46:47], v5 offset:2560
    v_mfma_f32_16x16x32_bf16 v[152:155], v[48:51], v[80:83], v[152:155]
    s_add_u32 s62, s62, 1
    v_mfma_f32_16x16x32_bf16 v[156:159], v[52:55], v[80:83], v[156:159]
    s_cmp_eq_u32 s62, 3
    v_mfma_f32_16x16x32_bf16 v[160:163], v[56:59], v[80:83], v[160:163]
    s_cselect_b32 s3, s59, s58
    v_mfma_f32_16x16x32_bf16 v[164:167], v[60:63], v[80:83], v[164:167]
    s_cselect_b32 s62, 0, s62
    v_mfma_f32_16x16x32_bf16 v[180:183], v[60:63], v[84:87], v[180:183]
    s_mov_b64 exec, 63
    buffer_store_dword v251, v252, s[16:19], s68 offen sc1
    s_mov_b64 exec, -1
    v_mfma_f32_16x16x32_bf16 v[176:179], v[56:59], v[84:87], v[176:179]
    v_mfma_f32_16x16x32_bf16 v[172:175], v[52:55], v[84:87], v[172:175]
    v_mfma_f32_16x16x32_bf16 v[168:171], v[48:51], v[84:87], v[168:171]
    s_waitcnt lgkmcnt(0)
    v_mfma_f32_16x16x32_bf16 v[88:91], v[24:27], v[8:11], v[88:91]
    ds_read_b64_tr_b16 v[64:65], v4 offset:12288
    v_mfma_f32_16x16x32_bf16 v[92:95], v[24:27], v[12:15], v[92:95]
    ds_read_b64_tr_b16 v[66:67], v4 offset:12800
    v_mfma_f32_16x16x32_bf16 v[96:99], v[24:27], v[16:19], v[96:99]
    ds_read_b128 v[48:51], v3 offset:0
    v_mfma_f32_16x16x32_bf16 v[100:103], v[24:27], v[20:23], v[100:103]
    ds_read_b128 v[52:55], v3 offset:1024
    v_mfma_f32_16x16x32_bf16 v[116:119], v[28:31], v[20:23], v[116:119]
    ds_read_b128 v[56:59], v3 offset:4096
    v_mfma_f32_16x16x32_bf16 v[112:115], v[28:31], v[16:19], v[112:115]
    ds_read_b128 v[60:63], v3 offset:5120
    v_mfma_f32_16x16x32_bf16 v[108:111], v[28:31], v[12:15], v[108:111]
    ds_read_b64_tr_b16 v[68:69], v5 offset:12288
    v_mfma_f32_16x16x32_bf16 v[104:107], v[28:31], v[8:11], v[104:107]
    ds_read_b64_tr_b16 v[70:71], v5 offset:12800
    v_mfma_f32_16x16x32_bf16 v[120:123], v[32:35], v[8:11], v[120:123]
    ds_read_b64_tr_b16 v[72:73], v4 offset:13312
    v_mfma_f32_16x16x32_bf16 v[124:127], v[32:35], v[12:15], v[124:127]
    ds_read_b64_tr_b16 v[74:75], v4 offset:13824
    v_mfma_f32_16x16x32_bf16 v[128:131], v[32:35], v[16:19], v[128:131]
    ds_read_b64_tr_b16 v[76:77], v5 offset:13312
    v_mfma_f32_16x16x32_bf16 v[132:135], v[32:35], v[20:23], v[132:135]
    ds_read_b64_tr_b16 v[78:79], v5 offset:13824
    v_mfma_f32_16x16x32_bf16 v[148:151], v[36:39], v[20:23], v[148:151]
    ds_read_b64_tr_b16 v[80:81], v4 offset:14336
    v_mfma_f32_16x16x32_bf16 v[144:147], v[36:39], v[16:19], v[144:147]
    ds_read_b64_tr_b16 v[82:83], v4 offset:14848
    v_mfma_f32_16x16x32_bf16 v[140:143], v[36:39], v[12:15], v[140:143]
    ds_read_b64_tr_b16 v[84:85], v5 offset:14336
    v_mfma_f32_16x16x32_bf16 v[136:139], v[36:39], v[8:11], v[136:139]
    ds_read_b64_tr_b16 v[86:87], v5 offset:14848
    v_mfma_f32_16x16x32_bf16 v[152:155], v[8:11], v[40:43], v[152:155]
    v_add_u32 v2, s3, v2
    v_mfma_f32_16x16x32_bf16 v[156:159], v[12:15], v[40:43], v[156:159]
    v_add_u32 v3, s3, v3
    v_mfma_f32_16x16x32_bf16 v[160:163], v[16:19], v[40:43], v[160:163]
    v_add_u32 v4, s3, v4
    v_mfma_f32_16x16x32_bf16 v[164:167], v[20:23], v[40:43], v[164:167]
    v_add_u32 v5, s3, v5
    v_mfma_f32_16x16x32_bf16 v[180:183], v[20:23], v[44:47], v[180:183]
    s_mov_b32 s56, 23
    v_mfma_f32_16x16x32_bf16 v[176:179], v[16:19], v[44:47], v[176:179]
    s_mov_b32 s57, 32
    v_mfma_f32_16x16x32_bf16 v[172:175], v[12:15], v[44:47], v[172:175]
    v_mfma_f32_16x16x32_bf16 v[168:171], v[8:11], v[44:47], v[168:171]
.p2align 3
mega_kernel_q_cloop:
    s_waitcnt lgkmcnt(0)
    s_barrier
    v_mfma_f32_16x16x32_bf16 v[88:91], v[64:67], v[48:51], v[88:91]
    ds_read_b64_tr_b16 v[24:25], v4 offset:0
    v_mfma_f32_16x16x32_bf16 v[92:95], v[64:67], v[52:55], v[92:95]
    ds_read_b64_tr_b16 v[26:27], v4 offset:512
    v_mfma_f32_16x16x32_bf16 v[96:99], v[64:67], v[56:59], v[96:99]
    ds_read_b128 v[8:11], v2 offset:0
    v_mfma_f32_16x16x32_bf16 v[100:103], v[64:67], v[60:63], v[100:103]
    ds_read_b128 v[12:15], v2 offset:1024
    v_mfma_f32_16x16x32_bf16 v[116:119], v[68:71], v[60:63], v[116:119]
    ds_read_b128 v[16:19], v2 offset:4096
    v_mfma_f32_16x16x32_bf16 v[112:115], v[68:71], v[56:59], v[112:115]
    ds_read_b128 v[20:23], v2 offset:5120
    v_mfma_f32_16x16x32_bf16 v[108:111], v[68:71], v[52:55], v[108:111]
    ds_read_b64_tr_b16 v[28:29], v5 offset:0
    v_mfma_f32_16x16x32_bf16 v[104:107], v[68:71], v[48:51], v[104:107]
    ds_read_b64_tr_b16 v[30:31], v5 offset:512
    v_mfma_f32_16x16x32_bf16 v[120:123], v[72:75], v[48:51], v[120:123]
    ds_read_b64_tr_b16 v[32:33], v4 offset:1024
    v_mfma_f32_16x16x32_bf16 v[124:127], v[72:75], v[52:55], v[124:127]
    ds_read_b64_tr_b16 v[34:35], v4 offset:1536
    v_mfma_f32_16x16x32_bf16 v[128:131], v[72:75], v[56:59], v[128:131]
    ds_read_b64_tr_b16 v[36:37], v5 offset:1024
    v_mfma_f32_16x16x32_bf16 v[132:135], v[72:75], v[60:63], v[132:135]
    ds_read_b64_tr_b16 v[38:39], v5 offset:1536
    v_mfma_f32_16x16x32_bf16 v[148:151], v[76:79], v[60:63], v[148:151]
    ds_read_b64_tr_b16 v[40:41], v4 offset:2048
    v_mfma_f32_16x16x32_bf16 v[144:147], v[76:79], v[56:59], v[144:147]
    ds_read_b64_tr_b16 v[42:43], v4 offset:2560
    v_mfma_f32_16x16x32_bf16 v[140:143], v[76:79], v[52:55], v[140:143]
    ds_read_b64_tr_b16 v[44:45], v5 offset:2048
    v_mfma_f32_16x16x32_bf16 v[136:139], v[76:79], v[48:51], v[136:139]
    ds_read_b64_tr_b16 v[46:47], v5 offset:2560
    v_mfma_f32_16x16x32_bf16 v[152:155], v[48:51], v[80:83], v[152:155]
    s_add_u32 s62, s62, 1
    v_mfma_f32_16x16x32_bf16 v[156:159], v[52:55], v[80:83], v[156:159]
    s_cmp_eq_u32 s62, 3
    v_mfma_f32_16x16x32_bf16 v[160:163], v[56:59], v[80:83], v[160:163]
    s_cselect_b32 s3, s59, s58
    v_mfma_f32_16x16x32_bf16 v[164:167], v[60:63], v[80:83], v[164:167]
    s_cselect_b32 s62, 0, s62
    v_mfma_f32_16x16x32_bf16 v[180:183], v[60:63], v[84:87], v[180:183]
    v_mfma_f32_16x16x32_bf16 v[176:179], v[56:59], v[84:87], v[176:179]
    v_mfma_f32_16x16x32_bf16 v[172:175], v[52:55], v[84:87], v[172:175]
    v_mfma_f32_16x16x32_bf16 v[168:171], v[48:51], v[84:87], v[168:171]
    s_waitcnt lgkmcnt(0)
    v_mfma_f32_16x16x32_bf16 v[88:91], v[24:27], v[8:11], v[88:91]
    ds_read_b64_tr_b16 v[64:65], v4 offset:12288
    v_mfma_f32_16x16x32_bf16 v[92:95], v[24:27], v[12:15], v[92:95]
    ds_read_b64_tr_b16 v[66:67], v4 offset:12800
    v_mfma_f32_16x16x32_bf16 v[96:99], v[24:27], v[16:19], v[96:99]
    ds_read_b128 v[48:51], v3 offset:0
    v_mfma_f32_16x16x32_bf16 v[100:103], v[24:27], v[20:23], v[100:103]
    ds_read_b128 v[52:55], v3 offset:1024
    v_mfma_f32_16x16x32_bf16 v[116:119], v[28:31], v[20:23], v[116:119]
    ds_read_b128 v[56:59], v3 offset:4096
    v_mfma_f32_16x16x32_bf16 v[112:115], v[28:31], v[16:19], v[112:115]
    ds_read_b128 v[60:63], v3 offset:5120
    v_mfma_f32_16x16x32_bf16 v[108:111], v[28:31], v[12:15], v[108:111]
    ds_read_b64_tr_b16 v[68:69], v5 offset:12288
    v_mfma_f32_16x16x32_bf16 v[104:107], v[28:31], v[8:11], v[104:107]
    ds_read_b64_tr_b16 v[70:71], v5 offset:12800
    v_mfma_f32_16x16x32_bf16 v[120:123], v[32:35], v[8:11], v[120:123]
    ds_read_b64_tr_b16 v[72:73], v4 offset:13312
    v_mfma_f32_16x16x32_bf16 v[124:127], v[32:35], v[12:15], v[124:127]
    ds_read_b64_tr_b16 v[74:75], v4 offset:13824
    v_mfma_f32_16x16x32_bf16 v[128:131], v[32:35], v[16:19], v[128:131]
    ds_read_b64_tr_b16 v[76:77], v5 offset:13312
    v_mfma_f32_16x16x32_bf16 v[132:135], v[32:35], v[20:23], v[132:135]
    ds_read_b64_tr_b16 v[78:79], v5 offset:13824
    v_mfma_f32_16x16x32_bf16 v[148:151], v[36:39], v[20:23], v[148:151]
    ds_read_b64_tr_b16 v[80:81], v4 offset:14336
    v_mfma_f32_16x16x32_bf16 v[144:147], v[36:39], v[16:19], v[144:147]
    ds_read_b64_tr_b16 v[82:83], v4 offset:14848
    v_mfma_f32_16x16x32_bf16 v[140:143], v[36:39], v[12:15], v[140:143]
    ds_read_b64_tr_b16 v[84:85], v5 offset:14336
    v_mfma_f32_16x16x32_bf16 v[136:139], v[36:39], v[8:11], v[136:139]
    ds_read_b64_tr_b16 v[86:87], v5 offset:14848
    v_mfma_f32_16x16x32_bf16 v[152:155], v[8:11], v[40:43], v[152:155]
    v_add_u32 v2, s3, v2
    v_mfma_f32_16x16x32_bf16 v[156:159], v[12:15], v[40:43], v[156:159]
    v_add_u32 v3, s3, v3
    v_mfma_f32_16x16x32_bf16 v[160:163], v[16:19], v[40:43], v[160:163]
    v_add_u32 v4, s3, v4
    v_mfma_f32_16x16x32_bf16 v[164:167], v[20:23], v[40:43], v[164:167]
    v_add_u32 v5, s3, v5
    v_mfma_f32_16x16x32_bf16 v[180:183], v[20:23], v[44:47], v[180:183]
    v_mfma_f32_16x16x32_bf16 v[176:179], v[16:19], v[44:47], v[176:179]
    v_mfma_f32_16x16x32_bf16 v[172:175], v[12:15], v[44:47], v[172:175]
    v_mfma_f32_16x16x32_bf16 v[168:171], v[8:11], v[44:47], v[168:171]
    s_waitcnt lgkmcnt(0)
    s_barrier
    v_mfma_f32_16x16x32_bf16 v[88:91], v[64:67], v[48:51], v[88:91]
    ds_read_b64_tr_b16 v[24:25], v4 offset:0
    v_mfma_f32_16x16x32_bf16 v[92:95], v[64:67], v[52:55], v[92:95]
    ds_read_b64_tr_b16 v[26:27], v4 offset:512
    v_mfma_f32_16x16x32_bf16 v[96:99], v[64:67], v[56:59], v[96:99]
    ds_read_b128 v[8:11], v2 offset:0
    v_mfma_f32_16x16x32_bf16 v[100:103], v[64:67], v[60:63], v[100:103]
    ds_read_b128 v[12:15], v2 offset:1024
    v_mfma_f32_16x16x32_bf16 v[116:119], v[68:71], v[60:63], v[116:119]
    ds_read_b128 v[16:19], v2 offset:4096
    v_mfma_f32_16x16x32_bf16 v[112:115], v[68:71], v[56:59], v[112:115]
    ds_read_b128 v[20:23], v2 offset:5120
    v_mfma_f32_16x16x32_bf16 v[108:111], v[68:71], v[52:55], v[108:111]
    ds_read_b64_tr_b16 v[28:29], v5 offset:0
    v_mfma_f32_16x16x32_bf16 v[104:107], v[68:71], v[48:51], v[104:107]
    ds_read_b64_tr_b16 v[30:31], v5 offset:512
    v_mfma_f32_16x16x32_bf16 v[120:123], v[72:75], v[48:51], v[120:123]
    ds_read_b64_tr_b16 v[32:33], v4 offset:1024
    v_mfma_f32_16x16x32_bf16 v[124:127], v[72:75], v[52:55], v[124:127]
    ds_read_b64_tr_b16 v[34:35], v4 offset:1536
    v_mfma_f32_16x16x32_bf16 v[128:131], v[72:75], v[56:59], v[128:131]
    ds_read_b64_tr_b16 v[36:37], v5 offset:1024
    v_mfma_f32_16x16x32_bf16 v[132:135], v[72:75], v[60:63], v[132:135]
    ds_read_b64_tr_b16 v[38:39], v5 offset:1536
    v_mfma_f32_16x16x32_bf16 v[148:151], v[76:79], v[60:63], v[148:151]
    ds_read_b64_tr_b16 v[40:41], v4 offset:2048
    v_mfma_f32_16x16x32_bf16 v[144:147], v[76:79], v[56:59], v[144:147]
    ds_read_b64_tr_b16 v[42:43], v4 offset:2560
    v_mfma_f32_16x16x32_bf16 v[140:143], v[76:79], v[52:55], v[140:143]
    ds_read_b64_tr_b16 v[44:45], v5 offset:2048
    v_mfma_f32_16x16x32_bf16 v[136:139], v[76:79], v[48:51], v[136:139]
    ds_read_b64_tr_b16 v[46:47], v5 offset:2560
    v_mfma_f32_16x16x32_bf16 v[152:155], v[48:51], v[80:83], v[152:155]
    s_add_u32 s62, s62, 1
    v_mfma_f32_16x16x32_bf16 v[156:159], v[52:55], v[80:83], v[156:159]
    s_cmp_eq_u32 s62, 3
    v_mfma_f32_16x16x32_bf16 v[160:163], v[56:59], v[80:83], v[160:163]
    s_cselect_b32 s3, s59, s58
    v_mfma_f32_16x16x32_bf16 v[164:167], v[60:63], v[80:83], v[164:167]
    s_cselect_b32 s62, 0, s62
    v_mfma_f32_16x16x32_bf16 v[180:183], v[60:63], v[84:87], v[180:183]
    v_mfma_f32_16x16x32_bf16 v[176:179], v[56:59], v[84:87], v[176:179]
    v_mfma_f32_16x16x32_bf16 v[172:175], v[52:55], v[84:87], v[172:175]
    v_mfma_f32_16x16x32_bf16 v[168:171], v[48:51], v[84:87], v[168:171]
    s_waitcnt lgkmcnt(0)
    v_mfma_f32_16x16x32_bf16 v[88:91], v[24:27], v[8:11], v[88:91]
    ds_read_b64_tr_b16 v[64:65], v4 offset:12288
    v_mfma_f32_16x16x32_bf16 v[92:95], v[24:27], v[12:15], v[92:95]
    ds_read_b64_tr_b16 v[66:67], v4 offset:12800
    v_mfma_f32_16x16x32_bf16 v[96:99], v[24:27], v[16:19], v[96:99]
    ds_read_b128 v[48:51], v3 offset:0
    v_mfma_f32_16x16x32_bf16 v[100:103], v[24:27], v[20:23], v[100:103]
    ds_read_b128 v[52:55], v3 offset:1024
    v_mfma_f32_16x16x32_bf16 v[116:119], v[28:31], v[20:23], v[116:119]
    ds_read_b128 v[56:59], v3 offset:4096
    v_mfma_f32_16x16x32_bf16 v[112:115], v[28:31], v[16:19], v[112:115]
    ds_read_b128 v[60:63], v3 offset:5120
    v_mfma_f32_16x16x32_bf16 v[108:111], v[28:31], v[12:15], v[108:111]
    ds_read_b64_tr_b16 v[68:69], v5 offset:12288
    v_mfma_f32_16x16x32_bf16 v[104:107], v[28:31], v[8:11], v[104:107]
    ds_read_b64_tr_b16 v[70:71], v5 offset:12800
    v_mfma_f32_16x16x32_bf16 v[120:123], v[32:35], v[8:11], v[120:123]
    ds_read_b64_tr_b16 v[72:73], v4 offset:13312
    v_mfma_f32_16x16x32_bf16 v[124:127], v[32:35], v[12:15], v[124:127]
    ds_read_b64_tr_b16 v[74:75], v4 offset:13824
    v_mfma_f32_16x16x32_bf16 v[128:131], v[32:35], v[16:19], v[128:131]
    ds_read_b64_tr_b16 v[76:77], v5 offset:13312
    v_mfma_f32_16x16x32_bf16 v[132:135], v[32:35], v[20:23], v[132:135]
    ds_read_b64_tr_b16 v[78:79], v5 offset:13824
    v_mfma_f32_16x16x32_bf16 v[148:151], v[36:39], v[20:23], v[148:151]
    ds_read_b64_tr_b16 v[80:81], v4 offset:14336
    v_mfma_f32_16x16x32_bf16 v[144:147], v[36:39], v[16:19], v[144:147]
    ds_read_b64_tr_b16 v[82:83], v4 offset:14848
    v_mfma_f32_16x16x32_bf16 v[140:143], v[36:39], v[12:15], v[140:143]
    ds_read_b64_tr_b16 v[84:85], v5 offset:14336
    v_mfma_f32_16x16x32_bf16 v[136:139], v[36:39], v[8:11], v[136:139]
    ds_read_b64_tr_b16 v[86:87], v5 offset:14848
    v_mfma_f32_16x16x32_bf16 v[152:155], v[8:11], v[40:43], v[152:155]
    v_add_u32 v2, s3, v2
    v_mfma_f32_16x16x32_bf16 v[156:159], v[12:15], v[40:43], v[156:159]
    v_add_u32 v3, s3, v3
    v_mfma_f32_16x16x32_bf16 v[160:163], v[16:19], v[40:43], v[160:163]
    v_add_u32 v4, s3, v4
    v_mfma_f32_16x16x32_bf16 v[164:167], v[20:23], v[40:43], v[164:167]
    v_add_u32 v5, s3, v5
    v_mfma_f32_16x16x32_bf16 v[180:183], v[20:23], v[44:47], v[180:183]
    v_mfma_f32_16x16x32_bf16 v[176:179], v[16:19], v[44:47], v[176:179]
    v_mfma_f32_16x16x32_bf16 v[172:175], v[12:15], v[44:47], v[172:175]
    v_mfma_f32_16x16x32_bf16 v[168:171], v[8:11], v[44:47], v[168:171]
    s_waitcnt lgkmcnt(0)
    s_barrier
    v_mfma_f32_16x16x32_bf16 v[88:91], v[64:67], v[48:51], v[88:91]
    ds_read_b64_tr_b16 v[24:25], v4 offset:0
    v_mfma_f32_16x16x32_bf16 v[92:95], v[64:67], v[52:55], v[92:95]
    ds_read_b64_tr_b16 v[26:27], v4 offset:512
    v_mfma_f32_16x16x32_bf16 v[96:99], v[64:67], v[56:59], v[96:99]
    ds_read_b128 v[8:11], v2 offset:0
    v_mfma_f32_16x16x32_bf16 v[100:103], v[64:67], v[60:63], v[100:103]
    ds_read_b128 v[12:15], v2 offset:1024
    v_mfma_f32_16x16x32_bf16 v[116:119], v[68:71], v[60:63], v[116:119]
    ds_read_b128 v[16:19], v2 offset:4096
    v_mfma_f32_16x16x32_bf16 v[112:115], v[68:71], v[56:59], v[112:115]
    ds_read_b128 v[20:23], v2 offset:5120
    v_mfma_f32_16x16x32_bf16 v[108:111], v[68:71], v[52:55], v[108:111]
    ds_read_b64_tr_b16 v[28:29], v5 offset:0
    v_mfma_f32_16x16x32_bf16 v[104:107], v[68:71], v[48:51], v[104:107]
    ds_read_b64_tr_b16 v[30:31], v5 offset:512
    v_mfma_f32_16x16x32_bf16 v[120:123], v[72:75], v[48:51], v[120:123]
    ds_read_b64_tr_b16 v[32:33], v4 offset:1024
    v_mfma_f32_16x16x32_bf16 v[124:127], v[72:75], v[52:55], v[124:127]
    ds_read_b64_tr_b16 v[34:35], v4 offset:1536
    v_mfma_f32_16x16x32_bf16 v[128:131], v[72:75], v[56:59], v[128:131]
    ds_read_b64_tr_b16 v[36:37], v5 offset:1024
    v_mfma_f32_16x16x32_bf16 v[132:135], v[72:75], v[60:63], v[132:135]
    ds_read_b64_tr_b16 v[38:39], v5 offset:1536
    v_mfma_f32_16x16x32_bf16 v[148:151], v[76:79], v[60:63], v[148:151]
    ds_read_b64_tr_b16 v[40:41], v4 offset:2048
    v_mfma_f32_16x16x32_bf16 v[144:147], v[76:79], v[56:59], v[144:147]
    ds_read_b64_tr_b16 v[42:43], v4 offset:2560
    v_mfma_f32_16x16x32_bf16 v[140:143], v[76:79], v[52:55], v[140:143]
    ds_read_b64_tr_b16 v[44:45], v5 offset:2048
    v_mfma_f32_16x16x32_bf16 v[136:139], v[76:79], v[48:51], v[136:139]
    ds_read_b64_tr_b16 v[46:47], v5 offset:2560
    v_mfma_f32_16x16x32_bf16 v[152:155], v[48:51], v[80:83], v[152:155]
    s_add_u32 s62, s62, 1
    v_mfma_f32_16x16x32_bf16 v[156:159], v[52:55], v[80:83], v[156:159]
    s_cmp_eq_u32 s62, 3
    v_mfma_f32_16x16x32_bf16 v[160:163], v[56:59], v[80:83], v[160:163]
    s_cselect_b32 s3, s59, s58
    v_mfma_f32_16x16x32_bf16 v[164:167], v[60:63], v[80:83], v[164:167]
    s_cselect_b32 s62, 0, s62
    v_mfma_f32_16x16x32_bf16 v[180:183], v[60:63], v[84:87], v[180:183]
    v_mfma_f32_16x16x32_bf16 v[176:179], v[56:59], v[84:87], v[176:179]
    v_mfma_f32_16x16x32_bf16 v[172:175], v[52:55], v[84:87], v[172:175]
    v_mfma_f32_16x16x32_bf16 v[168:171], v[48:51], v[84:87], v[168:171]
    s_waitcnt lgkmcnt(0)
    v_mfma_f32_16x16x32_bf16 v[88:91], v[24:27], v[8:11], v[88:91]
    ds_read_b64_tr_b16 v[64:65], v4 offset:12288
    v_mfma_f32_16x16x32_bf16 v[92:95], v[24:27], v[12:15], v[92:95]
    ds_read_b64_tr_b16 v[66:67], v4 offset:12800
    v_mfma_f32_16x16x32_bf16 v[96:99], v[24:27], v[16:19], v[96:99]
    ds_read_b128 v[48:51], v3 offset:0
    v_mfma_f32_16x16x32_bf16 v[100:103], v[24:27], v[20:23], v[100:103]
    ds_read_b128 v[52:55], v3 offset:1024
    v_mfma_f32_16x16x32_bf16 v[116:119], v[28:31], v[20:23], v[116:119]
    ds_read_b128 v[56:59], v3 offset:4096
    v_mfma_f32_16x16x32_bf16 v[112:115], v[28:31], v[16:19], v[112:115]
    ds_read_b128 v[60:63], v3 offset:5120
    v_mfma_f32_16x16x32_bf16 v[108:111], v[28:31], v[12:15], v[108:111]
    ds_read_b64_tr_b16 v[68:69], v5 offset:12288
    v_mfma_f32_16x16x32_bf16 v[104:107], v[28:31], v[8:11], v[104:107]
    ds_read_b64_tr_b16 v[70:71], v5 offset:12800
    v_mfma_f32_16x16x32_bf16 v[120:123], v[32:35], v[8:11], v[120:123]
    ds_read_b64_tr_b16 v[72:73], v4 offset:13312
    v_mfma_f32_16x16x32_bf16 v[124:127], v[32:35], v[12:15], v[124:127]
    ds_read_b64_tr_b16 v[74:75], v4 offset:13824
    v_mfma_f32_16x16x32_bf16 v[128:131], v[32:35], v[16:19], v[128:131]
    ds_read_b64_tr_b16 v[76:77], v5 offset:13312
    v_mfma_f32_16x16x32_bf16 v[132:135], v[32:35], v[20:23], v[132:135]
    ds_read_b64_tr_b16 v[78:79], v5 offset:13824
    v_mfma_f32_16x16x32_bf16 v[148:151], v[36:39], v[20:23], v[148:151]
    ds_read_b64_tr_b16 v[80:81], v4 offset:14336
    v_mfma_f32_16x16x32_bf16 v[144:147], v[36:39], v[16:19], v[144:147]
    ds_read_b64_tr_b16 v[82:83], v4 offset:14848
    v_mfma_f32_16x16x32_bf16 v[140:143], v[36:39], v[12:15], v[140:143]
    ds_read_b64_tr_b16 v[84:85], v5 offset:14336
    v_mfma_f32_16x16x32_bf16 v[136:139], v[36:39], v[8:11], v[136:139]
    ds_read_b64_tr_b16 v[86:87], v5 offset:14848
    v_mfma_f32_16x16x32_bf16 v[152:155], v[8:11], v[40:43], v[152:155]
    v_add_u32 v2, s3, v2
    v_mfma_f32_16x16x32_bf16 v[156:159], v[12:15], v[40:43], v[156:159]
    v_add_u32 v3, s3, v3
    v_mfma_f32_16x16x32_bf16 v[160:163], v[16:19], v[40:43], v[160:163]
    v_add_u32 v4, s3, v4
    v_mfma_f32_16x16x32_bf16 v[164:167], v[20:23], v[40:43], v[164:167]
    v_add_u32 v5, s3, v5
    v_mfma_f32_16x16x32_bf16 v[180:183], v[20:23], v[44:47], v[180:183]
    s_add_u32 s56, s56, 3
    v_mfma_f32_16x16x32_bf16 v[176:179], v[16:19], v[44:47], v[176:179]
    s_cmp_eq_u32 s56, s57
    v_mfma_f32_16x16x32_bf16 v[172:175], v[12:15], v[44:47], v[172:175]
    v_mfma_f32_16x16x32_bf16 v[168:171], v[8:11], v[44:47], v[168:171]
    s_cbranch_scc0 mega_kernel_q_cloop
    s_cmp_lt_u32 s56, 16
    s_cbranch_scc1 mega_kernel_q_evta
    s_cmp_eq_u32 s56, 32
    s_cbranch_scc1 mega_kernel_q_tail
    s_waitcnt lgkmcnt(0)
    s_barrier
    v_mfma_f32_16x16x32_bf16 v[88:91], v[64:67], v[48:51], v[88:91]
    ds_read_b64_tr_b16 v[24:25], v4 offset:0
    v_mfma_f32_16x16x32_bf16 v[92:95], v[64:67], v[52:55], v[92:95]
    ds_read_b64_tr_b16 v[26:27], v4 offset:512
    v_mfma_f32_16x16x32_bf16 v[96:99], v[64:67], v[56:59], v[96:99]
    ds_read_b128 v[8:11], v2 offset:0
    v_mfma_f32_16x16x32_bf16 v[100:103], v[64:67], v[60:63], v[100:103]
    ds_read_b128 v[12:15], v2 offset:1024
    v_mfma_f32_16x16x32_bf16 v[116:119], v[68:71], v[60:63], v[116:119]
    ds_read_b128 v[16:19], v2 offset:4096
    v_mfma_f32_16x16x32_bf16 v[112:115], v[68:71], v[56:59], v[112:115]
    ds_read_b128 v[20:23], v2 offset:5120
    v_mfma_f32_16x16x32_bf16 v[108:111], v[68:71], v[52:55], v[108:111]
    ds_read_b64_tr_b16 v[28:29], v5 offset:0
    v_mfma_f32_16x16x32_bf16 v[104:107], v[68:71], v[48:51], v[104:107]
    ds_read_b64_tr_b16 v[30:31], v5 offset:512
    v_mfma_f32_16x16x32_bf16 v[120:123], v[72:75], v[48:51], v[120:123]
    ds_read_b64_tr_b16 v[32:33], v4 offset:1024
    v_mfma_f32_16x16x32_bf16 v[124:127], v[72:75], v[52:55], v[124:127]
    ds_read_b64_tr_b16 v[34:35], v4 offset:1536
    v_mfma_f32_16x16x32_bf16 v[128:131], v[72:75], v[56:59], v[128:131]
    ds_read_b64_tr_b16 v[36:37], v5 offset:1024
    v_mfma_f32_16x16x32_bf16 v[132:135], v[72:75], v[60:63], v[132:135]
    ds_read_b64_tr_b16 v[38:39], v5 offset:1536
    v_mfma_f32_16x16x32_bf16 v[148:151], v[76:79], v[60:63], v[148:151]
    ds_read_b64_tr_b16 v[40:41], v4 offset:2048
    v_mfma_f32_16x16x32_bf16 v[144:147], v[76:79], v[56:59], v[144:147]
    ds_read_b64_tr_b16 v[42:43], v4 offset:2560
    v_mfma_f32_16x16x32_bf16 v[140:143], v[76:79], v[52:55], v[140:143]
    ds_read_b64_tr_b16 v[44:45], v5 offset:2048
    v_mfma_f32_16x16x32_bf16 v[136:139], v[76:79], v[48:51], v[136:139]
    ds_read_b64_tr_b16 v[46:47], v5 offset:2560
    v_mfma_f32_16x16x32_bf16 v[152:155], v[48:51], v[80:83], v[152:155]
    s_add_u32 s62, s62, 1
    v_mfma_f32_16x16x32_bf16 v[156:159], v[52:55], v[80:83], v[156:159]
    s_cmp_eq_u32 s62, 3
    v_mfma_f32_16x16x32_bf16 v[160:163], v[56:59], v[80:83], v[160:163]
    s_cselect_b32 s3, s59, s58
    v_mfma_f32_16x16x32_bf16 v[164:167], v[60:63], v[80:83], v[164:167]
    s_cselect_b32 s62, 0, s62
    v_mfma_f32_16x16x32_bf16 v[180:183], v[60:63], v[84:87], v[180:183]
    v_mfma_f32_16x16x32_bf16 v[176:179], v[56:59], v[84:87], v[176:179]
    v_mfma_f32_16x16x32_bf16 v[172:175], v[52:55], v[84:87], v[172:175]
    v_mfma_f32_16x16x32_bf16 v[168:171], v[48:51], v[84:87], v[168:171]
    s_waitcnt lgkmcnt(0)
    s_branch mega_kernel_q_first
mega_kernel_q_tail:
    v_lshlrev_b32 v7, 4, v0
    s_sub_u32 s64, s64, 4194304
    s_sub_u32 s65, s65, 8388608
    s_sub_u32 s63, s63, 8388608
    s_sub_u32 s60, s60, 8388608
    s_sub_u32 s61, s61, 8388608
    buffer_load_dwordx4 v[232:235], v7, s[16:19], s69 offen sc1
    buffer_load_dwordx4 v[236:239], v7, s[16:19], s69 offen offset:1024 sc1
    s_waitcnt lgkmcnt(0)
    v_mfma_f32_16x16x32_bf16 v[88:91], v[64:67], v[48:51], v[88:91]
    v_mfma_f32_16x16x32_bf16 v[92:95], v[64:67], v[52:55], v[92:95]
    v_mfma_f32_16x16x32_bf16 v[96:99], v[64:67], v[56:59], v[96:99]
    v_mfma_f32_16x16x32_bf16 v[100:103], v[64:67], v[60:63], v[100:103]
    v_mfma_f32_16x16x32_bf16 v[116:119], v[68:71], v[60:63], v[116:119]
    v_mfma_f32_16x16x32_bf16 v[112:115], v[68:71], v[56:59], v[112:115]
    v_mfma_f32_16x16x32_bf16 v[108:111], v[68:71], v[52:55], v[108:111]
    v_mfma_f32_16x16x32_bf16 v[104:107], v[68:71], v[48:51], v[104:107]
    v_mfma_f32_16x16x32_bf16 v[120:123], v[72:75], v[48:51], v[120:123]
    v_mfma_f32_16x16x32_bf16 v[124:127], v[72:75], v[52:55], v[124:127]
    v_mul_f32 v88, s66, v88
    v_mul_f32 v89, s66, v89
    v_mul_f32 v90, s66, v90
    v_mul_f32 v91, s66, v91
    v_cvt_pk_bf16_f32 v184, v88, v89
    v_cvt_pk_bf16_f32 v185, v90, v91
    v_mfma_f32_16x16x32_bf16 v[128:131], v[72:75], v[56:59], v[128:131]
    v_mul_f32 v92, s66, v92
    v_mul_f32 v93, s66, v93
    v_mul_f32 v94, s66, v94
    v_mul_f32 v95, s66, v95
    v_cvt_pk_bf16_f32 v188, v92, v93
    v_cvt_pk_bf16_f32 v189, v94, v95
    v_mfma_f32_16x16x32_bf16 v[132:135], v[72:75], v[60:63], v[132:135]
    v_mul_f32 v96, s66, v96
    v_mul_f32 v97, s66, v97
    v_mul_f32 v98, s66, v98
    v_mul_f32 v99, s66, v99
    v_cvt_pk_bf16_f32 v192, v96, v97
    v_cvt_pk_bf16_f32 v193, v98, v99
    v_mfma_f32_16x16x32_bf16 v[148:151], v[76:79], v[60:63], v[148:151]
    v_mul_f32 v100, s66, v100
    v_mul_f32 v101, s66, v101
    v_mul_f32 v102, s66, v102
    v_mul_f32 v103, s66, v103
    v_cvt_pk_bf16_f32 v196, v100, v101
    v_cvt_pk_bf16_f32 v197, v102, v103
    v_mfma_f32_16x16x32_bf16 v[144:147], v[76:79], v[56:59], v[144:147]
    v_mul_f32 v116, s66, v116
    v_mul_f32 v117, s66, v117
    v_mul_f32 v118, s66, v118
    v_mul_f32 v119, s66, v119
    v_cvt_pk_bf16_f32 v198, v116, v117
    v_cvt_pk_bf16_f32 v199, v118, v119
    v_mfma_f32_16x16x32_bf16 v[140:143], v[76:79], v[52:55], v[140:143]
    v_mul_f32 v112, s66, v112
    v_mul_f32 v113, s66, v113
    v_mul_f32 v114, s66, v114
    v_mul_f32 v115, s66, v115
    v_cvt_pk_bf16_f32 v194, v112, v113
    v_cvt_pk_bf16_f32 v195, v114, v115
    v_mfma_f32_16x16x32_bf16 v[136:139], v[76:79], v[48:51], v[136:139]
    v_mul_f32 v108, s66, v108
    v_mul_f32 v109, s66, v109
    v_mul_f32 v110, s66, v110
    v_mul_f32 v111, s66, v111
    v_cvt_pk_bf16_f32 v190, v108, v109
    v_cvt_pk_bf16_f32 v191, v110, v111
    v_mfma_f32_16x16x32_bf16 v[152:155], v[48:51], v[80:83], v[152:155]
    v_mul_f32 v104, s66, v104
    v_mul_f32 v105, s66, v105
    v_mul_f32 v106, s66, v106
    v_mul_f32 v107, s66, v107
    v_cvt_pk_bf16_f32 v186, v104, v105
    v_cvt_pk_bf16_f32 v187, v106, v107
    v_mfma_f32_16x16x32_bf16 v[156:159], v[52:55], v[80:83], v[156:159]
    v_cvt_pk_bf16_f32 v200, v120, v121
    v_cvt_pk_bf16_f32 v201, v122, v123
    v_mfma_f32_16x16x32_bf16 v[160:163], v[56:59], v[80:83], v[160:163]
    v_cvt_pk_bf16_f32 v204, v124, v125
    v_cvt_pk_bf16_f32 v205, v126, v127
    v_mfma_f32_16x16x32_bf16 v[164:167], v[60:63], v[80:83], v[164:167]
    v_cvt_pk_bf16_f32 v208, v128, v129
    v_cvt_pk_bf16_f32 v209, v130, v131
    v_mfma_f32_16x16x32_bf16 v[180:183], v[60:63], v[84:87], v[180:183]
    v_cvt_pk_bf16_f32 v212, v132, v133
    v_cvt_pk_bf16_f32 v213, v134, v135
    v_mfma_f32_16x16x32_bf16 v[176:179], v[56:59], v[84:87], v[176:179]
    v_cvt_pk_bf16_f32 v214, v148, v149
    v_cvt_pk_bf16_f32 v215, v150, v151
    v_mfma_f32_16x16x32_bf16 v[172:175], v[52:55], v[84:87], v[172:175]
    v_cvt_pk_bf16_f32 v210, v144, v145
    v_cvt_pk_bf16_f32 v211, v146, v147
    v_mfma_f32_16x16x32_bf16 v[168:171], v[48:51], v[84:87], v[168:171]
    s_nop 1
    v_cvt_pk_bf16_f32 v206, v140, v141
    v_cvt_pk_bf16_f32 v207, v142, v143
    v_cvt_pk_bf16_f32 v202, v136, v137
    v_cvt_pk_bf16_f32 v203, v138, v139
    v_cvt_pk_bf16_f32 v216, v152, v153
    v_cvt_pk_bf16_f32 v217, v154, v155
    v_cvt_pk_bf16_f32 v218, v156, v157
    v_cvt_pk_bf16_f32 v219, v158, v159
    v_cvt_pk_bf16_f32 v224, v160, v161
    v_cvt_pk_bf16_f32 v225, v162, v163
    v_cvt_pk_bf16_f32 v226, v164, v165
    v_cvt_pk_bf16_f32 v227, v166, v167
    v_cvt_pk_bf16_f32 v230, v180, v181
    v_cvt_pk_bf16_f32 v231, v182, v183
    v_cvt_pk_bf16_f32 v228, v176, v177
    v_cvt_pk_bf16_f32 v229, v178, v179
    s_nop 3
    v_cvt_pk_bf16_f32 v222, v172, v173
    v_cvt_pk_bf16_f32 v223, v174, v175
    v_cvt_pk_bf16_f32 v220, v168, v169
    v_cvt_pk_bf16_f32 v221, v170, v171
    s_setprio 0
mega_kernel_a_setup:
    v_lshlrev_b32 v1, 4, v0
    v_and_b32 v5, 4, v0
    v_cmp_eq_u32 vcc, 0, v5
    v_mov_b32 v6, 0x3f803f80
    v_add_u32 v4, s42, v1
    v_add_u32 v2, 65536, v1
    v_add_u32 v3, 131072, v1
    v_cndmask_b32 v10, 0, v6, vcc
    v_and_b32 v5, 1, v0
    v_mov_b32 v11, v10
    v_xor_b32 v12, v6, v10
    v_mov_b32 v13, v12
    v_mul_u32_u24 v5, 0xaaaa, v5
    v_add_u32 v14, 0x4444, v5
    v_lshl_add_u32 v14, v14, 16, v14
    v_mov_b64 v[52:53], 0
    v_mov_b64 v[54:55], 0
    s_cmp_ge_u32 s20, 4
    s_cbranch_scc1 mega_kernel_a_fetch
    s_add_u32 s24, s24, 32768
    s_waitcnt vmcnt(0)
    s_branch mega_kernel_a_x1
mega_kernel_a_fetch:
    s_sub_u32 m0, s42, 16384
    s_sub_u32 s3, s24, 16384
    s_cmp_eq_u32 s20, 4
    s_cbranch_scc1 mega_kernel_q_lchk
    mega_kernel_q_lchk_ret:
    s_add_u32 s4, s46, 4194304
    s_waitcnt vmcnt(0)
    s_barrier
    buffer_load_dwordx4 v4, s[16:19], s3 offen offset:0 sc1 lds
    buffer_load_dwordx4 v4, s[16:19], s3 offen offset:1024 sc1 lds
    buffer_load_dwordx4 v4, s[16:19], s3 offen offset:2048 sc1 lds
    buffer_load_dwordx4 v4, s[16:19], s3 offen offset:3072 sc1 lds
    s_mov_b32 m0, s42
    s_add_u32 s3, s3, 32768
    buffer_load_dwordx4 v4, s[16:19], s24 offen offset:0 sc1 lds
    buffer_load_dwordx4 v4, s[16:19], s24 offen offset:1024 sc1 lds
    buffer_load_dwordx4 v4, s[16:19], s24 offen offset:2048 sc1 lds
    buffer_load_dwordx4 v4, s[16:19], s24 offen offset:3072 sc1 lds
    buffer_load_dwordx4 v[232:235], v1, s[16:19], s4 offen sc1
    buffer_load_dwordx4 v[236:239], v1, s[16:19], s4 offen offset:1024 sc1
    s_add_u32 m0, s42, 16384
    s_add_u32 s24, s24, 32768
    buffer_load_dwordx4 v4, s[16:19], s3 offen offset:0 sc1 lds
    buffer_load_dwordx4 v4, s[16:19], s3 offen offset:1024 sc1 lds
    buffer_load_dwordx4 v4, s[16:19], s3 offen offset:2048 sc1 lds
    buffer_load_dwordx4 v4, s[16:19], s3 offen offset:3072 sc1 lds
    s_add_u32 m0, s42, 32768
    s_nop 0
    buffer_load_dwordx4 v4, s[16:19], s24 offen offset:0 sc1 lds
    buffer_load_dwordx4 v4, s[16:19], s24 offen offset:1024 sc1 lds
    buffer_load_dwordx4 v4, s[16:19], s24 offen offset:2048 sc1 lds
    buffer_load_dwordx4 v4, s[16:19], s24 offen offset:3072 sc1 lds
    s_waitcnt vmcnt(8)
mega_kernel_a_x1:
    s_add_u32 m0, s42, 65536
    s_add_u32 s24, s24, 32768
    s_barrier
    ds_read_b128 v[20:23], v1 offset:0
    ds_read_b128 v[24:27], v1 offset:1024
    s_waitcnt lgkmcnt(1)
    v_mfma_f32_32x32x16_bf16 v[88:103], v[20:23], v[232:235], 0
    s_waitcnt lgkmcnt(0)
    v_mfma_f32_32x32x16_bf16 v[88:103], v[24:27], v[236:239], v[88:103]
    ds_read_b128 v[20:23], v1 offset:4096
    ds_read_b128 v[24:27], v1 offset:5120
    buffer_load_dwordx4 v4, s[16:19], s24 offen offset:0 sc1 lds
    buffer_load_dwordx4 v4, s[16:19], s24 offen offset:1024 sc1 lds
    buffer_load_dwordx4 v4, s[16:19], s24 offen offset:2048 sc1 lds
    buffer_load_dwordx4 v4, s[16:19], s24 offen offset:3072 sc1 lds
    s_add_u32 m0, s42, 98304
    s_add_u32 s24, s24, 32768
    s_nop 4
    v_max3_f32 v5, v88, v89, v90
    v_max3_f32 v5, v5, v91, v92
    v_max3_f32 v5, v5, v93, v94
    v_max3_f32 v5, v5, v95, v96
    v_max3_f32 v5, v5, v97, v98
    v_max3_f32 v5, v5, v99, v100
    v_max3_f32 v5, v5, v101, v102
    v_max_f32 v5, v5, v103
    v_mov_b32 v9, v5
    s_nop 1
    v_permlane32_swap_b32 v5, v9
    s_nop 1
    v_max_f32 v5, v5, v9
    v_sub_f32 v56, 0xc2a00000, v5
    v_mov_b32 v57, v56
    v_add_f32 v88, v88, v56
    v_add_f32 v89, v89, v56
    v_add_f32 v90, v90, v56
    v_add_f32 v91, v91, v56
    v_add_f32 v92, v92, v56
    v_add_f32 v93, v93, v56
    v_add_f32 v94, v94, v56
    v_add_f32 v95, v95, v56
    v_add_f32 v96, v96, v56
    v_add_f32 v97, v97, v56
    v_add_f32 v98, v98, v56
    v_add_f32 v99, v99, v56
    v_add_f32 v100, v100, v56
    v_add_f32 v101, v101, v56
    v_add_f32 v102, v102, v56
    v_add_f32 v103, v103, v56
    v_mov_b32 v58, v56
    v_mov_b32 v59, v56
    v_mov_b32 v60, v56
    v_mov_b32 v61, v56
    v_mov_b32 v62, v56
    v_mov_b32 v63, v56
    v_mov_b32 v64, v56
    v_mov_b32 v65, v56
    v_mov_b32 v66, v56
    v_mov_b32 v67, v56
    v_mov_b32 v68, v56
    v_mov_b32 v69, v56
    v_mov_b32 v70, v56
    v_mov_b32 v71, v56
    s_setprio 1
    s_waitcnt lgkmcnt(0)
    v_mfma_f32_32x32x16_bf16 v[104:119], v[20:23], v[232:235], v[56:71]
    ds_read_b128 v[20:23], v1 offset:8192
    buffer_load_dwordx4 v4, s[16:19], s24 offen offset:0 sc1 lds
    v_mfma_f32_32x32x16_bf16 v[104:119], v[24:27], v[236:239], v[104:119]
    ds_read_b128 v[24:27], v1 offset:9216
    ds_read_b128 v[28:31], v1 offset:2048
    s_cmp_lt_u32 s20, 4
    s_cbranch_scc0 mega_kernel_g_1
    buffer_store_dwordx4 v[200:203], v240, s[16:19], s65 offen offset:0 sc1
    buffer_store_dwordx4 v[204:207], v240, s[16:19], s65 offen offset:128 sc1
mega_kernel_g_1:
    ds_read_b128 v[32:35], v1 offset:3072
    s_setprio 0
    v_exp_f32 v88, v88
    v_exp_f32 v89, v89
    v_exp_f32 v90, v90
    v_cvt_pk_bf16_f32 v36, v88, v89
    v_exp_f32 v91, v91
    s_setprio 1
    v_exp_f32 v92, v92
    v_cvt_pk_bf16_f32 v37, v90, v91
    v_exp_f32 v93, v93
    v_exp_f32 v94, v94
    v_cvt_pk_bf16_f32 v38, v92, v93
    v_exp_f32 v95, v95
    v_exp_f32 v96, v96
    v_cvt_pk_bf16_f32 v39, v94, v95
    v_exp_f32 v97, v97
    v_exp_f32 v98, v98
    v_cvt_pk_bf16_f32 v40, v96, v97
    v_exp_f32 v99, v99
    v_exp_f32 v100, v100
    v_cvt_pk_bf16_f32 v41, v98, v99
    v_exp_f32 v101, v101
    v_exp_f32 v102, v102
    v_cvt_pk_bf16_f32 v42, v100, v101
    v_exp_f32 v103, v103
    s_nop 0
    v_cvt_pk_bf16_f32 v43, v102, v103
    s_waitcnt lgkmcnt(0)
    v_mfma_f32_32x32x16_bf16 v[88:103], v[20:23], v[232:235], v[56:71]
    ds_read_b128 v[20:23], v1 offset:12288
    buffer_load_dwordx4 v4, s[16:19], s24 offen offset:1024 sc1 lds
    v_mfma_f32_32x32x16_bf16 v[88:103], v[24:27], v[236:239], v[88:103]
    ds_read_b128 v[24:27], v1 offset:13312
    v_mfma_f32_32x32x16_bf16 v[72:87], v[28:31], v[36:39], 0
    ds_read_b128 v[28:31], v1 offset:6144
    s_cmp_lt_u32 s20, 4
    s_cbranch_scc0 mega_kernel_g_2
    buffer_store_dwordx4 v[208:211], v240, s[16:19], s63 offen offset:0 sc1
    buffer_store_dwordx4 v[212:215], v240, s[16:19], s63 offen offset:128 sc1
mega_kernel_g_2:
    v_smfmac_f32_16x16x64_bf16 v[52:55], v[10:13], v[36:43], v14
    v_mfma_f32_32x32x16_bf16 v[72:87], v[32:35], v[40:43], v[72:87]
    ds_read_b128 v[32:35], v1 offset:7168
    s_setprio 0
    v_exp_f32 v104, v104
    v_exp_f32 v105, v105
    v_exp_f32 v106, v106
    v_cvt_pk_bf16_f32 v44, v104, v105
    v_exp_f32 v107, v107
    s_setprio 1
    v_exp_f32 v108, v108
    v_cvt_pk_bf16_f32 v45, v106, v107
    v_exp_f32 v109, v109
    v_exp_f32 v110, v110
    v_cvt_pk_bf16_f32 v46, v108, v109
    v_exp_f32 v111, v111
    v_exp_f32 v112, v112
    v_cvt_pk_bf16_f32 v47, v110, v111
    v_exp_f32 v113, v113
    v_exp_f32 v114, v114
    v_cvt_pk_bf16_f32 v48, v112, v113
    v_exp_f32 v115, v115
    v_exp_f32 v116, v116
    v_cvt_pk_bf16_f32 v49, v114, v115
    v_exp_f32 v117, v117
    v_exp_f32 v118, v118
    v_cvt_pk_bf16_f32 v50, v116, v117
    v_exp_f32 v119, v119
    s_nop 0
    v_cvt_pk_bf16_f32 v51, v118, v119
    s_waitcnt lgkmcnt(0)
    v_mfma_f32_32x32x16_bf16 v[104:119], v[20:23], v[232:235], v[56:71]
    ds_read_b128 v[20:23], v1 offset:16384
    buffer_load_dwordx4 v4, s[16:19], s24 offen offset:2048 sc1 lds
    v_mfma_f32_32x32x16_bf16 v[104:119], v[24:27], v[236:239], v[104:119]
    ds_read_b128 v[24:27], v1 offset:17408
    v_mfma_f32_32x32x16_bf16 v[72:87], v[28:31], v[44:47], v[72:87]
    ds_read_b128 v[28:31], v1 offset:10240
    s_cmp_lt_u32 s20, 4
    s_cbranch_scc0 mega_kernel_g_3
    buffer_store_dwordx4 v[216:219], v241, s[16:19], s60 offen offset:2048 sc1
    buffer_store_dwordx4 v[220:223], v241, s[16:19], s60 offen offset:2304 sc1
mega_kernel_g_3:
    v_smfmac_f32_16x16x64_bf16 v[52:55], v[10:13], v[44:51], v14
    v_mfma_f32_32x32x16_bf16 v[72:87], v[32:35], v[48:51], v[72:87]
    ds_read_b128 v[32:35], v1 offset:11264
    s_setprio 0
    v_exp_f32 v88, v88
    v_exp_f32 v89, v89
    v_exp_f32 v90, v90
    v_cvt_pk_bf16_f32 v36, v88, v89
    v_exp_f32 v91, v91
    s_setprio 1
    v_exp_f32 v92, v92
    v_cvt_pk_bf16_f32 v37, v90, v91
    v_exp_f32 v93, v93
    v_exp_f32 v94, v94
    v_cvt_pk_bf16_f32 v38, v92, v93
    v_exp_f32 v95, v95
    v_exp_f32 v96, v96
    v_cvt_pk_bf16_f32 v39, v94, v95
    v_exp_f32 v97, v97
    v_exp_f32 v98, v98
    v_cvt_pk_bf16_f32 v40, v96, v97
    v_exp_f32 v99, v99
    v_exp_f32 v100, v100
    v_cvt_pk_bf16_f32 v41, v98, v99
    v_exp_f32 v101, v101
    v_exp_f32 v102, v102
    v_cvt_pk_bf16_f32 v42, v100, v101
    v_exp_f32 v103, v103
    s_nop 0
    v_cvt_pk_bf16_f32 v43, v102, v103
    s_waitcnt lgkmcnt(0)
    v_mfma_f32_32x32x16_bf16 v[88:103], v[20:23], v[232:235], v[56:71]
    ds_read_b128 v[20:23], v1 offset:20480
    buffer_load_dwordx4 v4, s[16:19], s24 offen offset:3072 sc1 lds
    v_mfma_f32_32x32x16_bf16 v[88:103], v[24:27], v[236:239], v[88:103]
    ds_read_b128 v[24:27], v1 offset:21504
    v_mfma_f32_32x32x16_bf16 v[72:87], v[28:31], v[36:39], v[72:87]
    ds_read_b128 v[28:31], v1 offset:14336
    s_cmp_lt_u32 s20, 4
    s_cbranch_scc0 mega_kernel_g_4
    buffer_store_dwordx4 v[224:227], v241, s[16:19], s61 offen offset:2048 sc1
    buffer_store_dwordx4 v[228:231], v241, s[16:19], s61 offen offset:2304 sc1
mega_kernel_g_4:
    v_smfmac_f32_16x16x64_bf16 v[52:55], v[10:13], v[36:43], v14
    v_mfma_f32_32x32x16_bf16 v[72:87], v[32:35], v[40:43], v[72:87]
    ds_read_b128 v[32:35], v1 offset:15360
    s_setprio 0
    v_exp_f32 v104, v104
    v_exp_f32 v105, v105
    v_exp_f32 v106, v106
    v_cvt_pk_bf16_f32 v44, v104, v105
    v_exp_f32 v107, v107
    s_setprio 1
    v_exp_f32 v108, v108
    v_cvt_pk_bf16_f32 v45, v106, v107
    v_exp_f32 v109, v109
    v_exp_f32 v110, v110
    v_cvt_pk_bf16_f32 v46, v108, v109
    v_exp_f32 v111, v111
    v_exp_f32 v112, v112
    v_cvt_pk_bf16_f32 v47, v110, v111
    v_exp_f32 v113, v113
    v_exp_f32 v114, v114
    v_cvt_pk_bf16_f32 v48, v112, v113
    v_exp_f32 v115, v115
    v_exp_f32 v116, v116
    v_cvt_pk_bf16_f32 v49, v114, v115
    v_exp_f32 v117, v117
    v_exp_f32 v118, v118
    v_cvt_pk_bf16_f32 v50, v116, v117
    v_exp_f32 v119, v119
    s_nop 0
    v_cvt_pk_bf16_f32 v51, v118, v119
    s_waitcnt lgkmcnt(0)
    v_mfma_f32_32x32x16_bf16 v[104:119], v[20:23], v[232:235], v[56:71]
    ds_read_b128 v[20:23], v1 offset:24576
    s_add_u32 s24, s24, 32768
    s_add_u32 m0, s42, 131072
    v_mfma_f32_32x32x16_bf16 v[104:119], v[24:27], v[236:239], v[104:119]
    ds_read_b128 v[24:27], v1 offset:25600
    v_mfma_f32_32x32x16_bf16 v[72:87], v[28:31], v[44:47], v[72:87]
    ds_read_b128 v[28:31], v1 offset:18432
    s_cmp_lt_u32 s20, 4
    s_cbranch_scc0 mega_kernel_g_5
    buffer_store_dwordx4 v[184:187], v240, s[16:19], s64 offen offset:0 sc1
    buffer_store_dwordx4 v[188:191], v240, s[16:19], s64 offen offset:128 sc1
mega_kernel_g_5:
    v_smfmac_f32_16x16x64_bf16 v[52:55], v[10:13], v[44:51], v14
    v_mfma_f32_32x32x16_bf16 v[72:87], v[32:35], v[48:51], v[72:87]
    ds_read_b128 v[32:35], v1 offset:19456
    s_setprio 0
    v_exp_f32 v88, v88
    v_exp_f32 v89, v89
    v_exp_f32 v90, v90
    v_cvt_pk_bf16_f32 v36, v88, v89
    v_exp_f32 v91, v91
    s_setprio 1
    v_exp_f32 v92, v92
    v_cvt_pk_bf16_f32 v37, v90, v91
    v_exp_f32 v93, v93
    v_exp_f32 v94, v94
    v_cvt_pk_bf16_f32 v38, v92, v93
    v_exp_f32 v95, v95
    v_exp_f32 v96, v96
    v_cvt_pk_bf16_f32 v39, v94, v95
    v_exp_f32 v97, v97
    v_exp_f32 v98, v98
    v_cvt_pk_bf16_f32 v40, v96, v97
    v_exp_f32 v99, v99
    v_exp_f32 v100, v100
    v_cvt_pk_bf16_f32 v41, v98, v99
    v_exp_f32 v101, v101
    v_exp_f32 v102, v102
    v_cvt_pk_bf16_f32 v42, v100, v101
    v_exp_f32 v103, v103
    s_nop 0
    v_cvt_pk_bf16_f32 v43, v102, v103
    s_waitcnt lgkmcnt(0)
    v_mfma_f32_32x32x16_bf16 v[88:103], v[20:23], v[232:235], v[56:71]
    ds_read_b128 v[20:23], v1 offset:28672
    v_mfma_f32_32x32x16_bf16 v[88:103], v[24:27], v[236:239], v[88:103]
    ds_read_b128 v[24:27], v1 offset:29696
    s_waitcnt vmcnt(8)
    v_mfma_f32_32x32x16_bf16 v[72:87], v[28:31], v[36:39], v[72:87]
    ds_read_b128 v[28:31], v1 offset:22528
    s_cmp_lt_u32 s20, 4
    s_cbranch_scc0 mega_kernel_g_6
    buffer_store_dwordx4 v[192:195], v240, s[16:19], s64 offen offset:2048 sc1
    buffer_store_dwordx4 v[196:199], v240, s[16:19], s64 offen offset:2176 sc1
mega_kernel_g_6:
    v_smfmac_f32_16x16x64_bf16 v[52:55], v[10:13], v[36:43], v14
    v_mfma_f32_32x32x16_bf16 v[72:87], v[32:35], v[40:43], v[72:87]
    ds_read_b128 v[32:35], v1 offset:23552
    s_cmp_lt_u32 s20, 4
    s_cbranch_scc1 mega_kernel_g_7
    s_barrier
mega_kernel_g_7:
    s_setprio 0
    v_exp_f32 v104, v104
    v_exp_f32 v105, v105
    v_exp_f32 v106, v106
    v_cvt_pk_bf16_f32 v44, v104, v105
    v_exp_f32 v107, v107
    s_setprio 1
    v_exp_f32 v108, v108
    v_cvt_pk_bf16_f32 v45, v106, v107
    v_exp_f32 v109, v109
    v_exp_f32 v110, v110
    v_cvt_pk_bf16_f32 v46, v108, v109
    v_exp_f32 v111, v111
    v_exp_f32 v112, v112
    v_cvt_pk_bf16_f32 v47, v110, v111
    v_exp_f32 v113, v113
    v_exp_f32 v114, v114
    v_cvt_pk_bf16_f32 v48, v112, v113
    v_exp_f32 v115, v115
    v_exp_f32 v116, v116
    v_cvt_pk_bf16_f32 v49, v114, v115
    v_exp_f32 v117, v117
    v_exp_f32 v118, v118
    v_cvt_pk_bf16_f32 v50, v116, v117
    v_exp_f32 v119, v119
    s_nop 0
    v_cvt_pk_bf16_f32 v51, v118, v119
    s_cmp_lt_u32 s20, 4
    s_cbranch_scc0 mega_kernel_g_8
    s_barrier
mega_kernel_g_8:
    s_waitcnt lgkmcnt(0)
    v_mfma_f32_32x32x16_bf16 v[104:119], v[20:23], v[232:235], v[56:71]
    ds_read_b128 v[20:23], v1 offset:32768
    s_cmp_eq_u32 s20, 1
    s_cbranch_scc0 mega_kernel_g_9
mega_kernel_cp6:
    s_getpc_b64 s[4:5]
    s_bfe_u32 s3, s2, 0x20003
    s_lshl_b32 s3, s3, 13
    v_lshlrev_b32 v253, 7, v0
    v_add_u32 v253, s3, v253
    v_min_u32 v253, mega_kernel_codeend-mega_kernel_cp6-8, v253
    global_load_dword v253, v253, s[4:5]
mega_kernel_g_9:
    v_mfma_f32_32x32x16_bf16 v[104:119], v[24:27], v[236:239], v[104:119]
    ds_read_b128 v[24:27], v1 offset:33792
    v_mfma_f32_32x32x16_bf16 v[72:87], v[28:31], v[44:47], v[72:87]
    ds_read_b128 v[28:31], v1 offset:26624
    v_smfmac_f32_16x16x64_bf16 v[52:55], v[10:13], v[44:51], v14
    v_mfma_f32_32x32x16_bf16 v[72:87], v[32:35], v[48:51], v[72:87]
    ds_read_b128 v[32:35], v1 offset:27648
    s_setprio 0
    v_exp_f32 v88, v88
    v_exp_f32 v89, v89
    v_exp_f32 v90, v90
    v_cvt_pk_bf16_f32 v36, v88, v89
    v_exp_f32 v91, v91
    s_setprio 1
    v_exp_f32 v92, v92
    v_cvt_pk_bf16_f32 v37, v90, v91
    v_exp_f32 v93, v93
    v_exp_f32 v94, v94
    v_cvt_pk_bf16_f32 v38, v92, v93
    v_exp_f32 v95, v95
    v_exp_f32 v96, v96
    v_cvt_pk_bf16_f32 v39, v94, v95
    v_exp_f32 v97, v97
    v_exp_f32 v98, v98
    v_cvt_pk_bf16_f32 v40, v96, v97
    v_exp_f32 v99, v99
    v_exp_f32 v100, v100
    v_cvt_pk_bf16_f32 v41, v98, v99
    v_exp_f32 v101, v101
    v_exp_f32 v102, v102
    v_cvt_pk_bf16_f32 v42, v100, v101
    v_exp_f32 v103, v103
    s_nop 0
    v_cvt_pk_bf16_f32 v43, v102, v103
    s_waitcnt lgkmcnt(0)
    v_mfma_f32_32x32x16_bf16 v[88:103], v[20:23], v[232:235], v[56:71]
    ds_read_b128 v[20:23], v1 offset:36864
    v_mfma_f32_32x32x16_bf16 v[88:103], v[24:27], v[236:239], v[88:103]
    ds_read_b128 v[24:27], v1 offset:37888
    v_mfma_f32_32x32x16_bf16 v[72:87], v[28:31], v[36:39], v[72:87]
    ds_read_b128 v[28:31], v1 offset:30720
    v_smfmac_f32_16x16x64_bf16 v[52:55], v[10:13], v[36:43], v14
    v_mfma_f32_32x32x16_bf16 v[72:87], v[32:35], v[40:43], v[72:87]
    ds_read_b128 v[32:35], v1 offset:31744
    s_setprio 0
    v_exp_f32 v104, v104
    v_exp_f32 v105, v105
    v_exp_f32 v106, v106
    v_cvt_pk_bf16_f32 v44, v104, v105
    v_exp_f32 v107, v107
    s_setprio 1
    v_exp_f32 v108, v108
    v_cvt_pk_bf16_f32 v45, v106, v107
    v_exp_f32 v109, v109
    v_exp_f32 v110, v110
    v_cvt_pk_bf16_f32 v46, v108, v109
    v_exp_f32 v111, v111
    v_exp_f32 v112, v112
    v_cvt_pk_bf16_f32 v47, v110, v111
    v_exp_f32 v113, v113
    v_exp_f32 v114, v114
    v_cvt_pk_bf16_f32 v48, v112, v113
    v_exp_f32 v115, v115
    v_exp_f32 v116, v116
    v_cvt_pk_bf16_f32 v49, v114, v115
    v_exp_f32 v117, v117
    v_exp_f32 v118, v118
    v_cvt_pk_bf16_f32 v50, v116, v117
    v_exp_f32 v119, v119
    s_nop 0
    v_cvt_pk_bf16_f32 v51, v118, v119
    s_waitcnt lgkmcnt(0)
    v_mfma_f32_32x32x16_bf16 v[72:87], v[28:31], v[44:47], v[72:87]
    ds_read_b128 v[28:31], v1 offset:34816
    v_smfmac_f32_16x16x64_bf16 v[52:55], v[10:13], v[44:51], v14
    v_mfma_f32_32x32x16_bf16 v[72:87], v[32:35], v[48:51], v[72:87]
    ds_read_b128 v[32:35], v1 offset:35840
    v_mfma_f32_32x32x16_bf16 v[104:119], v[20:23], v[232:235], v[56:71]
    ds_read_b128 v[20:23], v1 offset:40960
    buffer_load_dwordx4 v4, s[16:19], s24 offen offset:0 sc1 lds
    v_mfma_f32_32x32x16_bf16 v[104:119], v[24:27], v[236:239], v[104:119]
    ds_read_b128 v[24:27], v1 offset:41984
    s_setprio 0
    s_nop 3
    v_add_f32 v5, v52, v53
    v_frexp_exp_i32_f32 v5, v5
    v_sub_u32 v7, 4294967216, v5
    v_cvt_f32_i32 v6, v7
    s_setprio 3
    v_add_f32 v88, v88, v6
    v_add_f32 v89, v89, v6
    v_add_f32 v90, v90, v6
    v_add_f32 v91, v91, v6
    v_add_f32 v92, v92, v6
    v_add_f32 v93, v93, v6
    v_add_f32 v94, v94, v6
    v_add_f32 v95, v95, v6
    v_add_f32 v96, v96, v6
    v_add_f32 v97, v97, v6
    v_add_f32 v98, v98, v6
    v_add_f32 v99, v99, v6
    v_add_f32 v100, v100, v6
    v_add_f32 v101, v101, v6
    v_add_f32 v102, v102, v6
    v_add_f32 v103, v103, v6
    v_ldexp_f32 v52, v52, v7
    v_ldexp_f32 v53, v53, v7
    v_ldexp_f32 v72, v72, v7
    v_ldexp_f32 v73, v73, v7
    v_ldexp_f32 v74, v74, v7
    v_ldexp_f32 v75, v75, v7
    v_ldexp_f32 v76, v76, v7
    v_ldexp_f32 v77, v77, v7
    v_ldexp_f32 v78, v78, v7
    v_ldexp_f32 v79, v79, v7
    v_ldexp_f32 v80, v80, v7
    v_ldexp_f32 v81, v81, v7
    v_ldexp_f32 v82, v82, v7
    v_ldexp_f32 v83, v83, v7
    v_ldexp_f32 v84, v84, v7
    v_ldexp_f32 v85, v85, v7
    v_ldexp_f32 v86, v86, v7
    v_ldexp_f32 v87, v87, v7
    v_add_f32 v56, v56, v6
    v_add_f32 v57, v57, v6
    v_add_f32 v58, v58, v6
    v_add_f32 v59, v59, v6
    v_add_f32 v60, v60, v6
    v_add_f32 v61, v61, v6
    v_add_f32 v62, v62, v6
    v_add_f32 v63, v63, v6
    v_add_f32 v64, v64, v6
    v_add_f32 v65, v65, v6
    v_add_f32 v66, v66, v6
    v_add_f32 v67, v67, v6
    v_add_f32 v68, v68, v6
    v_add_f32 v69, v69, v6
    v_add_f32 v70, v70, v6
    v_add_f32 v71, v71, v6
    v_add_f32 v104, v104, v6
    v_add_f32 v105, v105, v6
    v_add_f32 v106, v106, v6
    v_add_f32 v107, v107, v6
    v_add_f32 v108, v108, v6
    v_add_f32 v109, v109, v6
    v_add_f32 v110, v110, v6
    v_add_f32 v111, v111, v6
    v_add_f32 v112, v112, v6
    v_add_f32 v113, v113, v6
    v_add_f32 v114, v114, v6
    v_add_f32 v115, v115, v6
    v_add_f32 v116, v116, v6
    v_add_f32 v117, v117, v6
    v_add_f32 v118, v118, v6
    v_add_f32 v119, v119, v6
    v_exp_f32 v88, v88
    v_exp_f32 v89, v89
    v_exp_f32 v90, v90
    v_cvt_pk_bf16_f32 v36, v88, v89
    v_exp_f32 v91, v91
    v_exp_f32 v92, v92
    v_cvt_pk_bf16_f32 v37, v90, v91
    v_exp_f32 v93, v93
    v_exp_f32 v94, v94
    v_cvt_pk_bf16_f32 v38, v92, v93
    v_exp_f32 v95, v95
    v_exp_f32 v96, v96
    v_cvt_pk_bf16_f32 v39, v94, v95
    v_exp_f32 v97, v97
    v_exp_f32 v98, v98
    v_cvt_pk_bf16_f32 v40, v96, v97
    v_exp_f32 v99, v99
    v_exp_f32 v100, v100
    v_cvt_pk_bf16_f32 v41, v98, v99
    v_exp_f32 v101, v101
    v_exp_f32 v102, v102
    v_cvt_pk_bf16_f32 v42, v100, v101
    v_exp_f32 v103, v103
    s_nop 0
    v_cvt_pk_bf16_f32 v43, v102, v103
    s_waitcnt lgkmcnt(0)
    v_mfma_f32_32x32x16_bf16 v[88:103], v[20:23], v[232:235], v[56:71]
    ds_read_b128 v[20:23], v1 offset:45056
    buffer_load_dwordx4 v4, s[16:19], s24 offen offset:1024 sc1 lds
    v_mfma_f32_32x32x16_bf16 v[88:103], v[24:27], v[236:239], v[88:103]
    ds_read_b128 v[24:27], v1 offset:46080
    v_mfma_f32_32x32x16_bf16 v[72:87], v[28:31], v[36:39], v[72:87]
    ds_read_b128 v[28:31], v1 offset:38912
    v_smfmac_f32_16x16x64_bf16 v[52:55], v[10:13], v[36:43], v14
    v_mfma_f32_32x32x16_bf16 v[72:87], v[32:35], v[40:43], v[72:87]
    ds_read_b128 v[32:35], v1 offset:39936
    s_setprio 0
    v_exp_f32 v104, v104
    v_exp_f32 v105, v105
    v_exp_f32 v106, v106
    v_cvt_pk_bf16_f32 v44, v104, v105
    v_exp_f32 v107, v107
    s_setprio 1
    v_exp_f32 v108, v108
    v_cvt_pk_bf16_f32 v45, v106, v107
    v_exp_f32 v109, v109
    v_exp_f32 v110, v110
    v_cvt_pk_bf16_f32 v46, v108, v109
    v_exp_f32 v111, v111
    v_exp_f32 v112, v112
    v_cvt_pk_bf16_f32 v47, v110, v111
    v_exp_f32 v113, v113
    v_exp_f32 v114, v114
    v_cvt_pk_bf16_f32 v48, v112, v113
    v_exp_f32 v115, v115
    v_exp_f32 v116, v116
    v_cvt_pk_bf16_f32 v49, v114, v115
    v_exp_f32 v117, v117
    v_exp_f32 v118, v118
    v_cvt_pk_bf16_f32 v50, v116, v117
    v_exp_f32 v119, v119
    s_nop 0
    v_cvt_pk_bf16_f32 v51, v118, v119
    s_waitcnt lgkmcnt(0)
    v_mfma_f32_32x32x16_bf16 v[104:119], v[20:23], v[232:235], v[56:71]
    ds_read_b128 v[20:23], v1 offset:49152
    buffer_load_dwordx4 v4, s[16:19], s24 offen offset:2048 sc1 lds
    v_mfma_f32_32x32x16_bf16 v[104:119], v[24:27], v[236:239], v[104:119]
    ds_read_b128 v[24:27], v1 offset:50176
    v_mfma_f32_32x32x16_bf16 v[72:87], v[28:31], v[44:47], v[72:87]
    ds_read_b128 v[28:31], v1 offset:43008
    v_smfmac_f32_16x16x64_bf16 v[52:55], v[10:13], v[44:51], v14
    v_mfma_f32_32x32x16_bf16 v[72:87], v[32:35], v[48:51], v[72:87]
    ds_read_b128 v[32:35], v1 offset:44032
    s_setprio 0
    v_exp_f32 v88, v88
    v_exp_f32 v89, v89
    v_exp_f32 v90, v90
    v_cvt_pk_bf16_f32 v36, v88, v89
    v_exp_f32 v91, v91
    s_setprio 1
    v_exp_f32 v92, v92
    v_cvt_pk_bf16_f32 v37, v90, v91
    v_exp_f32 v93, v93
    v_exp_f32 v94, v94
    v_cvt_pk_bf16_f32 v38, v92, v93
    v_exp_f32 v95, v95
    v_exp_f32 v96, v96
    v_cvt_pk_bf16_f32 v39, v94, v95
    v_exp_f32 v97, v97
    v_exp_f32 v98, v98
    v_cvt_pk_bf16_f32 v40, v96, v97
    v_exp_f32 v99, v99
    v_exp_f32 v100, v100
    v_cvt_pk_bf16_f32 v41, v98, v99
    v_exp_f32 v101, v101
    v_exp_f32 v102, v102
    v_cvt_pk_bf16_f32 v42, v100, v101
    v_exp_f32 v103, v103
    s_nop 0
    v_cvt_pk_bf16_f32 v43, v102, v103
    s_waitcnt lgkmcnt(0)
    v_mfma_f32_32x32x16_bf16 v[88:103], v[20:23], v[232:235], v[56:71]
    ds_read_b128 v[20:23], v1 offset:53248
    buffer_load_dwordx4 v4, s[16:19], s24 offen offset:3072 sc1 lds
    v_mfma_f32_32x32x16_bf16 v[88:103], v[24:27], v[236:239], v[88:103]
    ds_read_b128 v[24:27], v1 offset:54272
    v_mfma_f32_32x32x16_bf16 v[72:87], v[28:31], v[36:39], v[72:87]
    ds_read_b128 v[28:31], v1 offset:47104
    v_smfmac_f32_16x16x64_bf16 v[52:55], v[10:13], v[36:43], v14
    v_mfma_f32_32x32x16_bf16 v[72:87], v[32:35], v[40:43], v[72:87]
    ds_read_b128 v[32:35], v1 offset:48128
    s_setprio 0
    v_exp_f32 v104, v104
    v_exp_f32 v105, v105
    v_exp_f32 v106, v106
    v_cvt_pk_bf16_f32 v44, v104, v105
    v_exp_f32 v107, v107
    s_setprio 1
    v_exp_f32 v108, v108
    v_cvt_pk_bf16_f32 v45, v106, v107
    v_exp_f32 v109, v109
    v_exp_f32 v110, v110
    v_cvt_pk_bf16_f32 v46, v108, v109
    v_exp_f32 v111, v111
    v_exp_f32 v112, v112
    v_cvt_pk_bf16_f32 v47, v110, v111
    v_exp_f32 v113, v113
    v_exp_f32 v114, v114
    v_cvt_pk_bf16_f32 v48, v112, v113
    v_exp_f32 v115, v115
    v_exp_f32 v116, v116
    v_cvt_pk_bf16_f32 v49, v114, v115
    v_exp_f32 v117, v117
    v_exp_f32 v118, v118
    v_cvt_pk_bf16_f32 v50, v116, v117
    v_exp_f32 v119, v119
    s_nop 0
    v_cvt_pk_bf16_f32 v51, v118, v119
    s_waitcnt lgkmcnt(0)
    v_mfma_f32_32x32x16_bf16 v[104:119], v[20:23], v[232:235], v[56:71]
    ds_read_b128 v[20:23], v1 offset:57344
    s_add_u32 s24, s24, 32768
    s_add_u32 m0, s42, 0
    v_mfma_f32_32x32x16_bf16 v[104:119], v[24:27], v[236:239], v[104:119]
    ds_read_b128 v[24:27], v1 offset:58368
    v_mfma_f32_32x32x16_bf16 v[72:87], v[28:31], v[44:47], v[72:87]
    ds_read_b128 v[28:31], v1 offset:51200
    v_smfmac_f32_16x16x64_bf16 v[52:55], v[10:13], v[44:51], v14
    v_mfma_f32_32x32x16_bf16 v[72:87], v[32:35], v[48:51], v[72:87]
    ds_read_b128 v[32:35], v1 offset:52224
    s_setprio 0
    v_exp_f32 v88, v88
    v_exp_f32 v89, v89
    v_exp_f32 v90, v90
    v_cvt_pk_bf16_f32 v36, v88, v89
    v_exp_f32 v91, v91
    s_setprio 1
    v_exp_f32 v92, v92
    v_cvt_pk_bf16_f32 v37, v90, v91
    v_exp_f32 v93, v93
    v_exp_f32 v94, v94
    v_cvt_pk_bf16_f32 v38, v92, v93
    v_exp_f32 v95, v95
    v_exp_f32 v96, v96
    v_cvt_pk_bf16_f32 v39, v94, v95
    v_exp_f32 v97, v97
    v_exp_f32 v98, v98
    v_cvt_pk_bf16_f32 v40, v96, v97
    v_exp_f32 v99, v99
    v_exp_f32 v100, v100
    v_cvt_pk_bf16_f32 v41, v98, v99
    v_exp_f32 v101, v101
    v_exp_f32 v102, v102
    v_cvt_pk_bf16_f32 v42, v100, v101
    v_exp_f32 v103, v103
    s_nop 0
    v_cvt_pk_bf16_f32 v43, v102, v103
    s_waitcnt lgkmcnt(0)
    v_mfma_f32_32x32x16_bf16 v[88:103], v[20:23], v[232:235], v[56:71]
    ds_read_b128 v[20:23], v1 offset:61440
    v_mfma_f32_32x32x16_bf16 v[88:103], v[24:27], v[236:239], v[88:103]
    ds_read_b128 v[24:27], v1 offset:62464
    s_waitcnt vmcnt(4)
    v_mfma_f32_32x32x16_bf16 v[72:87], v[28:31], v[36:39], v[72:87]
    ds_read_b128 v[28:31], v1 offset:55296
    v_smfmac_f32_16x16x64_bf16 v[52:55], v[10:13], v[36:43], v14
    v_mfma_f32_32x32x16_bf16 v[72:87], v[32:35], v[40:43], v[72:87]
    ds_read_b128 v[32:35], v1 offset:56320
    s_cmp_lt_u32 s20, 4
    s_cbranch_scc1 mega_kernel_g_10
    s_barrier
mega_kernel_g_10:
    s_setprio 0
    v_exp_f32 v104, v104
    v_exp_f32 v105, v105
    v_exp_f32 v106, v106
    v_cvt_pk_bf16_f32 v44, v104, v105
    v_exp_f32 v107, v107
    s_setprio 1
    v_exp_f32 v108, v108
    v_cvt_pk_bf16_f32 v45, v106, v107
    v_exp_f32 v109, v109
    v_exp_f32 v110, v110
    v_cvt_pk_bf16_f32 v46, v108, v109
    v_exp_f32 v111, v111
    v_exp_f32 v112, v112
    v_cvt_pk_bf16_f32 v47, v110, v111
    v_exp_f32 v113, v113
    v_exp_f32 v114, v114
    v_cvt_pk_bf16_f32 v48, v112, v113
    v_exp_f32 v115, v115
    v_exp_f32 v116, v116
    v_cvt_pk_bf16_f32 v49, v114, v115
    v_exp_f32 v117, v117
    v_exp_f32 v118, v118
    v_cvt_pk_bf16_f32 v50, v116, v117
    v_exp_f32 v119, v119
    s_nop 0
    v_cvt_pk_bf16_f32 v51, v118, v119
    s_cmp_lt_u32 s20, 4
    s_cbranch_scc0 mega_kernel_g_11
    s_barrier
mega_kernel_g_11:
    s_waitcnt lgkmcnt(0)
    v_mfma_f32_32x32x16_bf16 v[104:119], v[20:23], v[232:235], v[56:71]
    ds_read_b128 v[20:23], v2 offset:0
    v_mfma_f32_32x32x16_bf16 v[104:119], v[24:27], v[236:239], v[104:119]
    ds_read_b128 v[24:27], v2 offset:1024
    v_mfma_f32_32x32x16_bf16 v[72:87], v[28:31], v[44:47], v[72:87]
    ds_read_b128 v[28:31], v1 offset:59392
    v_smfmac_f32_16x16x64_bf16 v[52:55], v[10:13], v[44:51], v14
    v_mfma_f32_32x32x16_bf16 v[72:87], v[32:35], v[48:51], v[72:87]
    ds_read_b128 v[32:35], v1 offset:60416
    s_setprio 0
    v_exp_f32 v88, v88
    v_exp_f32 v89, v89
    v_exp_f32 v90, v90
    v_cvt_pk_bf16_f32 v36, v88, v89
    v_exp_f32 v91, v91
    s_setprio 1
    v_exp_f32 v92, v92
    v_cvt_pk_bf16_f32 v37, v90, v91
    v_exp_f32 v93, v93
    v_exp_f32 v94, v94
    v_cvt_pk_bf16_f32 v38, v92, v93
    v_exp_f32 v95, v95
    v_exp_f32 v96, v96
    v_cvt_pk_bf16_f32 v39, v94, v95
    v_exp_f32 v97, v97
    v_exp_f32 v98, v98
    v_cvt_pk_bf16_f32 v40, v96, v97
    v_exp_f32 v99, v99
    v_exp_f32 v100, v100
    v_cvt_pk_bf16_f32 v41, v98, v99
    v_exp_f32 v101, v101
    v_exp_f32 v102, v102
    v_cvt_pk_bf16_f32 v42, v100, v101
    v_exp_f32 v103, v103
    s_nop 0
    v_cvt_pk_bf16_f32 v43, v102, v103
    s_waitcnt lgkmcnt(0)
    v_mfma_f32_32x32x16_bf16 v[88:103], v[20:23], v[232:235], v[56:71]
    ds_read_b128 v[20:23], v2 offset:4096
    s_lshr_b32 s3, s20, 1
    s_cmp_eq_u32 s3, 0
    s_cbranch_scc0 mega_kernel_g_12
    v_lshlrev_b32 v253, 7, v0
    buffer_load_dword v253, v253, s[12:15], s47 offen
mega_kernel_g_12:
    v_mfma_f32_32x32x16_bf16 v[88:103], v[24:27], v[236:239], v[88:103]
    ds_read_b128 v[24:27], v2 offset:5120
    v_mfma_f32_32x32x16_bf16 v[72:87], v[28:31], v[36:39], v[72:87]
    ds_read_b128 v[28:31], v1 offset:63488
    v_smfmac_f32_16x16x64_bf16 v[52:55], v[10:13], v[36:43], v14
    v_mfma_f32_32x32x16_bf16 v[72:87], v[32:35], v[40:43], v[72:87]
    ds_read_b128 v[32:35], v1 offset:64512
    s_setprio 0
    v_exp_f32 v104, v104
    v_exp_f32 v105, v105
    v_exp_f32 v106, v106
    v_cvt_pk_bf16_f32 v44, v104, v105
    v_exp_f32 v107, v107
    s_setprio 1
    v_exp_f32 v108, v108
    v_cvt_pk_bf16_f32 v45, v106, v107
    v_exp_f32 v109, v109
    v_exp_f32 v110, v110
    v_cvt_pk_bf16_f32 v46, v108, v109
    v_exp_f32 v111, v111
    v_exp_f32 v112, v112
    v_cvt_pk_bf16_f32 v47, v110, v111
    v_exp_f32 v113, v113
    v_exp_f32 v114, v114
    v_cvt_pk_bf16_f32 v48, v112, v113
    v_exp_f32 v115, v115
    v_exp_f32 v116, v116
    v_cvt_pk_bf16_f32 v49, v114, v115
    v_exp_f32 v117, v117
    v_exp_f32 v118, v118
    v_cvt_pk_bf16_f32 v50, v116, v117
    v_exp_f32 v119, v119
    s_nop 0
    v_cvt_pk_bf16_f32 v51, v118, v119
    v_add_f32 v5, v52, v53
    v_cmp_lt_f32 vcc, s43, v5
    s_waitcnt lgkmcnt(0)
    v_mfma_f32_32x32x16_bf16 v[72:87], v[28:31], v[44:47], v[72:87]
    ds_read_b128 v[28:31], v2 offset:2048
    v_smfmac_f32_16x16x64_bf16 v[52:55], v[10:13], v[44:51], v14
    v_mfma_f32_32x32x16_bf16 v[72:87], v[32:35], v[48:51], v[72:87]
    ds_read_b128 v[32:35], v2 offset:3072
    s_cbranch_vccnz mega_kernel_rr_13c
mega_kernel_rr_13:
    v_mfma_f32_32x32x16_bf16 v[104:119], v[20:23], v[232:235], v[56:71]
    ds_read_b128 v[20:23], v2 offset:8192
    buffer_load_dwordx4 v4, s[16:19], s24 offen offset:0 sc1 lds
    v_mfma_f32_32x32x16_bf16 v[104:119], v[24:27], v[236:239], v[104:119]
    ds_read_b128 v[24:27], v2 offset:9216
    s_mov_b64 exec, 63
    buffer_store_dword v251, v252, s[16:19], s31 offen sc1
    s_mov_b64 exec, -1
    s_setprio 0
    v_exp_f32 v88, v88
    v_exp_f32 v89, v89
    v_exp_f32 v90, v90
    v_cvt_pk_bf16_f32 v36, v88, v89
    v_exp_f32 v91, v91
    s_setprio 1
    v_exp_f32 v92, v92
    v_cvt_pk_bf16_f32 v37, v90, v91
    v_exp_f32 v93, v93
    v_exp_f32 v94, v94
    v_cvt_pk_bf16_f32 v38, v92, v93
    v_exp_f32 v95, v95
    v_exp_f32 v96, v96
    v_cvt_pk_bf16_f32 v39, v94, v95
    v_exp_f32 v97, v97
    v_exp_f32 v98, v98
    v_cvt_pk_bf16_f32 v40, v96, v97
    v_exp_f32 v99, v99
    v_exp_f32 v100, v100
    v_cvt_pk_bf16_f32 v41, v98, v99
    v_exp_f32 v101, v101
    v_exp_f32 v102, v102
    v_cvt_pk_bf16_f32 v42, v100, v101
    v_exp_f32 v103, v103
    s_nop 0
    v_cvt_pk_bf16_f32 v43, v102, v103
    s_waitcnt lgkmcnt(0)
    v_mfma_f32_32x32x16_bf16 v[88:103], v[20:23], v[232:235], v[56:71]
    ds_read_b128 v[20:23], v2 offset:12288
    buffer_load_dwordx4 v4, s[16:19], s24 offen offset:1024 sc1 lds
    v_mfma_f32_32x32x16_bf16 v[88:103], v[24:27], v[236:239], v[88:103]
    ds_read_b128 v[24:27], v2 offset:13312
    v_mfma_f32_32x32x16_bf16 v[72:87], v[28:31], v[36:39], v[72:87]
    ds_read_b128 v[28:31], v2 offset:6144
    v_smfmac_f32_16x16x64_bf16 v[52:55], v[10:13], v[36:43], v14
    v_mfma_f32_32x32x16_bf16 v[72:87], v[32:35], v[40:43], v[72:87]
    ds_read_b128 v[32:35], v2 offset:7168
    s_setprio 0
    v_exp_f32 v104, v104
    v_exp_f32 v105, v105
    v_exp_f32 v106, v106
    v_cvt_pk_bf16_f32 v44, v104, v105
    v_exp_f32 v107, v107
    s_setprio 1
    v_exp_f32 v108, v108
    v_cvt_pk_bf16_f32 v45, v106, v107
    v_exp_f32 v109, v109
    v_exp_f32 v110, v110
    v_cvt_pk_bf16_f32 v46, v108, v109
    v_exp_f32 v111, v111
    v_exp_f32 v112, v112
    v_cvt_pk_bf16_f32 v47, v110, v111
    v_exp_f32 v113, v113
    v_exp_f32 v114, v114
    v_cvt_pk_bf16_f32 v48, v112, v113
    v_exp_f32 v115, v115
    v_exp_f32 v116, v116
    v_cvt_pk_bf16_f32 v49, v114, v115
    v_exp_f32 v117, v117
    v_exp_f32 v118, v118
    v_cvt_pk_bf16_f32 v50, v116, v117
    v_exp_f32 v119, v119
    s_nop 0
    v_cvt_pk_bf16_f32 v51, v118, v119
    s_waitcnt lgkmcnt(0)
    v_mfma_f32_32x32x16_bf16 v[104:119], v[20:23], v[232:235], v[56:71]
    ds_read_b128 v[20:23], v2 offset:16384
    buffer_load_dwordx4 v4, s[16:19], s24 offen offset:2048 sc1 lds
    v_mfma_f32_32x32x16_bf16 v[104:119], v[24:27], v[236:239], v[104:119]
    ds_read_b128 v[24:27], v2 offset:17408
    v_mfma_f32_32x32x16_bf16 v[72:87], v[28:31], v[44:47], v[72:87]
    ds_read_b128 v[28:31], v2 offset:10240
    v_smfmac_f32_16x16x64_bf16 v[52:55], v[10:13], v[44:51], v14
    v_mfma_f32_32x32x16_bf16 v[72:87], v[32:35], v[48:51], v[72:87]
    ds_read_b128 v[32:35], v2 offset:11264
    s_setprio 0
    v_exp_f32 v88, v88
    v_exp_f32 v89, v89
    v_exp_f32 v90, v90
    v_cvt_pk_bf16_f32 v36, v88, v89
    v_exp_f32 v91, v91
    s_setprio 1
    v_exp_f32 v92, v92
    v_cvt_pk_bf16_f32 v37, v90, v91
    v_exp_f32 v93, v93
    v_exp_f32 v94, v94
    v_cvt_pk_bf16_f32 v38, v92, v93
    v_exp_f32 v95, v95
    v_exp_f32 v96, v96
    v_cvt_pk_bf16_f32 v39, v94, v95
    v_exp_f32 v97, v97
    v_exp_f32 v98, v98
    v_cvt_pk_bf16_f32 v40, v96, v97
    v_exp_f32 v99, v99
    v_exp_f32 v100, v100
    v_cvt_pk_bf16_f32 v41, v98, v99
    v_exp_f32 v101, v101
    v_exp_f32 v102, v102
    v_cvt_pk_bf16_f32 v42, v100, v101
    v_exp_f32 v103, v103
    s_nop 0
    v_cvt_pk_bf16_f32 v43, v102, v103
    s_waitcnt lgkmcnt(0)
    v_mfma_f32_32x32x16_bf16 v[88:103], v[20:23], v[232:235], v[56:71]
    ds_read_b128 v[20:23], v2 offset:20480
    buffer_load_dwordx4 v4, s[16:19], s24 offen offset:3072 sc1 lds
    v_mfma_f32_32x32x16_bf16 v[88:103], v[24:27], v[236:239], v[88:103]
    ds_read_b128 v[24:27], v2 offset:21504
    v_mfma_f32_32x32x16_bf16 v[72:87], v[28:31], v[36:39], v[72:87]
    ds_read_b128 v[28:31], v2 offset:14336
    v_smfmac_f32_16x16x64_bf16 v[52:55], v[10:13], v[36:43], v14
    v_mfma_f32_32x32x16_bf16 v[72:87], v[32:35], v[40:43], v[72:87]
    ds_read_b128 v[32:35], v2 offset:15360
    s_setprio 0
    v_exp_f32 v104, v104
    v_exp_f32 v105, v105
    v_exp_f32 v106, v106
    v_cvt_pk_bf16_f32 v44, v104, v105
    v_exp_f32 v107, v107
    s_setprio 1
    v_exp_f32 v108, v108
    v_cvt_pk_bf16_f32 v45, v106, v107
    v_exp_f32 v109, v109
    v_exp_f32 v110, v110
    v_cvt_pk_bf16_f32 v46, v108, v109
    v_exp_f32 v111, v111
    v_exp_f32 v112, v112
    v_cvt_pk_bf16_f32 v47, v110, v111
    v_exp_f32 v113, v113
    v_exp_f32 v114, v114
    v_cvt_pk_bf16_f32 v48, v112, v113
    v_exp_f32 v115, v115
    v_exp_f32 v116, v116
    v_cvt_pk_bf16_f32 v49, v114, v115
    v_exp_f32 v117, v117
    v_exp_f32 v118, v118
    v_cvt_pk_bf16_f32 v50, v116, v117
    v_exp_f32 v119, v119
    s_nop 0
    v_cvt_pk_bf16_f32 v51, v118, v119
    s_waitcnt lgkmcnt(0)
    v_mfma_f32_32x32x16_bf16 v[104:119], v[20:23], v[232:235], v[56:71]
    ds_read_b128 v[20:23], v2 offset:24576
    s_add_u32 s24, s24, 32768
    s_add_u32 m0, s42, 32768
    v_mfma_f32_32x32x16_bf16 v[104:119], v[24:27], v[236:239], v[104:119]
    ds_read_b128 v[24:27], v2 offset:25600
    v_mfma_f32_32x32x16_bf16 v[72:87], v[28:31], v[44:47], v[72:87]
    ds_read_b128 v[28:31], v2 offset:18432
    v_smfmac_f32_16x16x64_bf16 v[52:55], v[10:13], v[44:51], v14
    v_mfma_f32_32x32x16_bf16 v[72:87], v[32:35], v[48:51], v[72:87]
    ds_read_b128 v[32:35], v2 offset:19456
    s_setprio 0
    v_exp_f32 v88, v88
    v_exp_f32 v89, v89
    v_exp_f32 v90, v90
    v_cvt_pk_bf16_f32 v36, v88, v89
    v_exp_f32 v91, v91
    s_setprio 1
    v_exp_f32 v92, v92
    v_cvt_pk_bf16_f32 v37, v90, v91
    v_exp_f32 v93, v93
    v_exp_f32 v94, v94
    v_cvt_pk_bf16_f32 v38, v92, v93
    v_exp_f32 v95, v95
    v_exp_f32 v96, v96
    v_cvt_pk_bf16_f32 v39, v94, v95
    v_exp_f32 v97, v97
    v_exp_f32 v98, v98
    v_cvt_pk_bf16_f32 v40, v96, v97
    v_exp_f32 v99, v99
    v_exp_f32 v100, v100
    v_cvt_pk_bf16_f32 v41, v98, v99
    v_exp_f32 v101, v101
    v_exp_f32 v102, v102
    v_cvt_pk_bf16_f32 v42, v100, v101
    v_exp_f32 v103, v103
    s_nop 0
    v_cvt_pk_bf16_f32 v43, v102, v103
    s_waitcnt lgkmcnt(0)
    v_mfma_f32_32x32x16_bf16 v[88:103], v[20:23], v[232:235], v[56:71]
    ds_read_b128 v[20:23], v2 offset:28672
    v_mfma_f32_32x32x16_bf16 v[88:103], v[24:27], v[236:239], v[88:103]
    ds_read_b128 v[24:27], v2 offset:29696
    s_waitcnt vmcnt(4)
    v_mfma_f32_32x32x16_bf16 v[72:87], v[28:31], v[36:39], v[72:87]
    ds_read_b128 v[28:31], v2 offset:22528
    v_smfmac_f32_16x16x64_bf16 v[52:55], v[10:13], v[36:43], v14
    v_mfma_f32_32x32x16_bf16 v[72:87], v[32:35], v[40:43], v[72:87]
    ds_read_b128 v[32:35], v2 offset:23552
    s_cmp_lt_u32 s20, 4
    s_cbranch_scc1 mega_kernel_g_14
    s_barrier
mega_kernel_g_14:
    s_setprio 0
    v_exp_f32 v104, v104
    v_exp_f32 v105, v105
    v_exp_f32 v106, v106
    v_cvt_pk_bf16_f32 v44, v104, v105
    v_exp_f32 v107, v107
    s_setprio 1
    v_exp_f32 v108, v108
    v_cvt_pk_bf16_f32 v45, v106, v107
    v_exp_f32 v109, v109
    v_exp_f32 v110, v110
    v_cvt_pk_bf16_f32 v46, v108, v109
    v_exp_f32 v111, v111
    v_exp_f32 v112, v112
    v_cvt_pk_bf16_f32 v47, v110, v111
    v_exp_f32 v113, v113
    v_exp_f32 v114, v114
    v_cvt_pk_bf16_f32 v48, v112, v113
    v_exp_f32 v115, v115
    v_exp_f32 v116, v116
    v_cvt_pk_bf16_f32 v49, v114, v115
    v_exp_f32 v117, v117
    v_exp_f32 v118, v118
    v_cvt_pk_bf16_f32 v50, v116, v117
    v_exp_f32 v119, v119
    s_nop 0
    v_cvt_pk_bf16_f32 v51, v118, v119
    s_cmp_lt_u32 s20, 4
    s_cbranch_scc0 mega_kernel_g_15
    s_barrier
mega_kernel_g_15:
    s_waitcnt lgkmcnt(0)
    v_mfma_f32_32x32x16_bf16 v[104:119], v[20:23], v[232:235], v[56:71]
    ds_read_b128 v[20:23], v2 offset:32768
    v_mfma_f32_32x32x16_bf16 v[104:119], v[24:27], v[236:239], v[104:119]
    ds_read_b128 v[24:27], v2 offset:33792
    v_mfma_f32_32x32x16_bf16 v[72:87], v[28:31], v[44:47], v[72:87]
    ds_read_b128 v[28:31], v2 offset:26624
    v_smfmac_f32_16x16x64_bf16 v[52:55], v[10:13], v[44:51], v14
    v_mfma_f32_32x32x16_bf16 v[72:87], v[32:35], v[48:51], v[72:87]
    ds_read_b128 v[32:35], v2 offset:27648
    s_setprio 0
    v_exp_f32 v88, v88
    v_exp_f32 v89, v89
    v_exp_f32 v90, v90
    v_cvt_pk_bf16_f32 v36, v88, v89
    v_exp_f32 v91, v91
    s_setprio 1
    v_exp_f32 v92, v92
    v_cvt_pk_bf16_f32 v37, v90, v91
    v_exp_f32 v93, v93
    v_exp_f32 v94, v94
    v_cvt_pk_bf16_f32 v38, v92, v93
    v_exp_f32 v95, v95
    v_exp_f32 v96, v96
    v_cvt_pk_bf16_f32 v39, v94, v95
    v_exp_f32 v97, v97
    v_exp_f32 v98, v98
    v_cvt_pk_bf16_f32 v40, v96, v97
    v_exp_f32 v99, v99
    v_exp_f32 v100, v100
    v_cvt_pk_bf16_f32 v41, v98, v99
    v_exp_f32 v101, v101
    v_exp_f32 v102, v102
    v_cvt_pk_bf16_f32 v42, v100, v101
    v_exp_f32 v103, v103
    s_nop 0
    v_cvt_pk_bf16_f32 v43, v102, v103
    s_waitcnt lgkmcnt(0)
    v_mfma_f32_32x32x16_bf16 v[88:103], v[20:23], v[232:235], v[56:71]
    ds_read_b128 v[20:23], v2 offset:36864
    s_lshr_b32 s3, s20, 1
    s_cmp_eq_u32 s3, 1
    s_cbranch_scc0 mega_kernel_g_16
    v_lshlrev_b32 v253, 7, v0
    buffer_load_dword v253, v253, s[12:15], s47 offen
mega_kernel_g_16:
    v_mfma_f32_32x32x16_bf16 v[88:103], v[24:27], v[236:239], v[88:103]
    ds_read_b128 v[24:27], v2 offset:37888
    v_mfma_f32_32x32x16_bf16 v[72:87], v[28:31], v[36:39], v[72:87]
    ds_read_b128 v[28:31], v2 offset:30720
    v_smfmac_f32_16x16x64_bf16 v[52:55], v[10:13], v[36:43], v14
    v_mfma_f32_32x32x16_bf16 v[72:87], v[32:35], v[40:43], v[72:87]
    ds_read_b128 v[32:35], v2 offset:31744
    s_setprio 0
    v_exp_f32 v104, v104
    v_exp_f32 v105, v105
    v_exp_f32 v106, v106
    v_cvt_pk_bf16_f32 v44, v104, v105
    v_exp_f32 v107, v107
    s_setprio 1
    v_exp_f32 v108, v108
    v_cvt_pk_bf16_f32 v45, v106, v107
    v_exp_f32 v109, v109
    v_exp_f32 v110, v110
    v_cvt_pk_bf16_f32 v46, v108, v109
    v_exp_f32 v111, v111
    v_exp_f32 v112, v112
    v_cvt_pk_bf16_f32 v47, v110, v111
    v_exp_f32 v113, v113
    v_exp_f32 v114, v114
    v_cvt_pk_bf16_f32 v48, v112, v113
    v_exp_f32 v115, v115
    v_exp_f32 v116, v116
    v_cvt_pk_bf16_f32 v49, v114, v115
    v_exp_f32 v117, v117
    v_exp_f32 v118, v118
    v_cvt_pk_bf16_f32 v50, v116, v117
    v_exp_f32 v119, v119
    s_nop 0
    v_cvt_pk_bf16_f32 v51, v118, v119
    v_add_f32 v5, v52, v53
    v_cmp_lt_f32 vcc, s43, v5
    s_waitcnt lgkmcnt(0)
    v_mfma_f32_32x32x16_bf16 v[72:87], v[28:31], v[44:47], v[72:87]
    ds_read_b128 v[28:31], v2 offset:34816
    v_smfmac_f32_16x16x64_bf16 v[52:55], v[10:13], v[44:51], v14
    v_mfma_f32_32x32x16_bf16 v[72:87], v[32:35], v[48:51], v[72:87]
    ds_read_b128 v[32:35], v2 offset:35840
    s_cbranch_vccnz mega_kernel_rr_17c
mega_kernel_rr_17:
    v_mfma_f32_32x32x16_bf16 v[104:119], v[20:23], v[232:235], v[56:71]
    ds_read_b128 v[20:23], v2 offset:40960
    buffer_load_dwordx4 v4, s[16:19], s24 offen offset:0 sc1 lds
    v_mfma_f32_32x32x16_bf16 v[104:119], v[24:27], v[236:239], v[104:119]
    ds_read_b128 v[24:27], v2 offset:41984
    s_setprio 0
    v_exp_f32 v88, v88
    v_exp_f32 v89, v89
    v_exp_f32 v90, v90
    v_cvt_pk_bf16_f32 v36, v88, v89
    v_exp_f32 v91, v91
    s_setprio 1
    v_exp_f32 v92, v92
    v_cvt_pk_bf16_f32 v37, v90, v91
    v_exp_f32 v93, v93
    v_exp_f32 v94, v94
    v_cvt_pk_bf16_f32 v38, v92, v93
    v_exp_f32 v95, v95
    v_exp_f32 v96, v96
    v_cvt_pk_bf16_f32 v39, v94, v95
    v_exp_f32 v97, v97
    v_exp_f32 v98, v98
    v_cvt_pk_bf16_f32 v40, v96, v97
    v_exp_f32 v99, v99
    v_exp_f32 v100, v100
    v_cvt_pk_bf16_f32 v41, v98, v99
    v_exp_f32 v101, v101
    v_exp_f32 v102, v102
    v_cvt_pk_bf16_f32 v42, v100, v101
    v_exp_f32 v103, v103
    s_nop 0
    v_cvt_pk_bf16_f32 v43, v102, v103
    s_waitcnt lgkmcnt(0)
    v_mfma_f32_32x32x16_bf16 v[88:103], v[20:23], v[232:235], v[56:71]
    ds_read_b128 v[20:23], v2 offset:45056
    buffer_load_dwordx4 v4, s[16:19], s24 offen offset:1024 sc1 lds
    v_mfma_f32_32x32x16_bf16 v[88:103], v[24:27], v[236:239], v[88:103]
    ds_read_b128 v[24:27], v2 offset:46080
    v_mfma_f32_32x32x16_bf16 v[72:87], v[28:31], v[36:39], v[72:87]
    ds_read_b128 v[28:31], v2 offset:38912
    v_smfmac_f32_16x16x64_bf16 v[52:55], v[10:13], v[36:43], v14
    v_mfma_f32_32x32x16_bf16 v[72:87], v[32:35], v[40:43], v[72:87]
    ds_read_b128 v[32:35], v2 offset:39936
    s_setprio 0
    v_exp_f32 v104, v104
    v_exp_f32 v105, v105
    v_exp_f32 v106, v106
    v_cvt_pk_bf16_f32 v44, v104, v105
    v_exp_f32 v107, v107
    s_setprio 1
    v_exp_f32 v108, v108
    v_cvt_pk_bf16_f32 v45, v106, v107
    v_exp_f32 v109, v109
    v_exp_f32 v110, v110
    v_cvt_pk_bf16_f32 v46, v108, v109
    v_exp_f32 v111, v111
    v_exp_f32 v112, v112
    v_cvt_pk_bf16_f32 v47, v110, v111
    v_exp_f32 v113, v113
    v_exp_f32 v114, v114
    v_cvt_pk_bf16_f32 v48, v112, v113
    v_exp_f32 v115, v115
    v_exp_f32 v116, v116
    v_cvt_pk_bf16_f32 v49, v114, v115
    v_exp_f32 v117, v117
    v_exp_f32 v118, v118
    v_cvt_pk_bf16_f32 v50, v116, v117
    v_exp_f32 v119, v119
    s_nop 0
    v_cvt_pk_bf16_f32 v51, v118, v119
    s_waitcnt lgkmcnt(0)
    v_mfma_f32_32x32x16_bf16 v[104:119], v[20:23], v[232:235], v[56:71]
    ds_read_b128 v[20:23], v2 offset:49152
    buffer_load_dwordx4 v4, s[16:19], s24 offen offset:2048 sc1 lds
    v_mfma_f32_32x32x16_bf16 v[104:119], v[24:27], v[236:239], v[104:119]
    ds_read_b128 v[24:27], v2 offset:50176
    v_mfma_f32_32x32x16_bf16 v[72:87], v[28:31], v[44:47], v[72:87]
    ds_read_b128 v[28:31], v2 offset:43008
    v_smfmac_f32_16x16x64_bf16 v[52:55], v[10:13], v[44:51], v14
    v_mfma_f32_32x32x16_bf16 v[72:87], v[32:35], v[48:51], v[72:87]
    ds_read_b128 v[32:35], v2 offset:44032
    s_setprio 0
    v_exp_f32 v88, v88
    v_exp_f32 v89, v89
    v_exp_f32 v90, v90
    v_cvt_pk_bf16_f32 v36, v88, v89
    v_exp_f32 v91, v91
    s_setprio 1
    v_exp_f32 v92, v92
    v_cvt_pk_bf16_f32 v37, v90, v91
    v_exp_f32 v93, v93
    v_exp_f32 v94, v94
    v_cvt_pk_bf16_f32 v38, v92, v93
    v_exp_f32 v95, v95
    v_exp_f32 v96, v96
    v_cvt_pk_bf16_f32 v39, v94, v95
    v_exp_f32 v97, v97
    v_exp_f32 v98, v98
    v_cvt_pk_bf16_f32 v40, v96, v97
    v_exp_f32 v99, v99
    v_exp_f32 v100, v100
    v_cvt_pk_bf16_f32 v41, v98, v99
    v_exp_f32 v101, v101
    v_exp_f32 v102, v102
    v_cvt_pk_bf16_f32 v42, v100, v101
    v_exp_f32 v103, v103
    s_nop 0
    v_cvt_pk_bf16_f32 v43, v102, v103
    s_waitcnt lgkmcnt(0)
    v_mfma_f32_32x32x16_bf16 v[88:103], v[20:23], v[232:235], v[56:71]
    ds_read_b128 v[20:23], v2 offset:53248
    buffer_load_dwordx4 v4, s[16:19], s24 offen offset:3072 sc1 lds
    v_mfma_f32_32x32x16_bf16 v[88:103], v[24:27], v[236:239], v[88:103]
    ds_read_b128 v[24:27], v2 offset:54272
    v_mfma_f32_32x32x16_bf16 v[72:87], v[28:31], v[36:39], v[72:87]
    ds_read_b128 v[28:31], v2 offset:47104
    v_smfmac_f32_16x16x64_bf16 v[52:55], v[10:13], v[36:43], v14
    v_mfma_f32_32x32x16_bf16 v[72:87], v[32:35], v[40:43], v[72:87]
    ds_read_b128 v[32:35], v2 offset:48128
    s_setprio 0
    v_exp_f32 v104, v104
    v_exp_f32 v105, v105
    v_exp_f32 v106, v106
    v_cvt_pk_bf16_f32 v44, v104, v105
    v_exp_f32 v107, v107
    s_setprio 1
    v_exp_f32 v108, v108
    v_cvt_pk_bf16_f32 v45, v106, v107
    v_exp_f32 v109, v109
    v_exp_f32 v110, v110
    v_cvt_pk_bf16_f32 v46, v108, v109
    v_exp_f32 v111, v111
    v_exp_f32 v112, v112
    v_cvt_pk_bf16_f32 v47, v110, v111
    v_exp_f32 v113, v113
    v_exp_f32 v114, v114
    v_cvt_pk_bf16_f32 v48, v112, v113
    v_exp_f32 v115, v115
    v_exp_f32 v116, v116
    v_cvt_pk_bf16_f32 v49, v114, v115
    v_exp_f32 v117, v117
    v_exp_f32 v118, v118
    v_cvt_pk_bf16_f32 v50, v116, v117
    v_exp_f32 v119, v119
    s_nop 0
    v_cvt_pk_bf16_f32 v51, v118, v119
    s_waitcnt lgkmcnt(0)
    v_mfma_f32_32x32x16_bf16 v[104:119], v[20:23], v[232:235], v[56:71]
    ds_read_b128 v[20:23], v2 offset:57344
    s_add_u32 s24, s24, 32768
    s_add_u32 m0, s42, 65536
    v_mfma_f32_32x32x16_bf16 v[104:119], v[24:27], v[236:239], v[104:119]
    ds_read_b128 v[24:27], v2 offset:58368
    v_mfma_f32_32x32x16_bf16 v[72:87], v[28:31], v[44:47], v[72:87]
    ds_read_b128 v[28:31], v2 offset:51200
    v_smfmac_f32_16x16x64_bf16 v[52:55], v[10:13], v[44:51], v14
    v_mfma_f32_32x32x16_bf16 v[72:87], v[32:35], v[48:51], v[72:87]
    ds_read_b128 v[32:35], v2 offset:52224
    s_setprio 0
    v_exp_f32 v88, v88
    v_exp_f32 v89, v89
    v_exp_f32 v90, v90
    v_cvt_pk_bf16_f32 v36, v88, v89
    v_exp_f32 v91, v91
    s_setprio 1
    v_exp_f32 v92, v92
    v_cvt_pk_bf16_f32 v37, v90, v91
    v_exp_f32 v93, v93
    v_exp_f32 v94, v94
    v_cvt_pk_bf16_f32 v38, v92, v93
    v_exp_f32 v95, v95
    v_exp_f32 v96, v96
    v_cvt_pk_bf16_f32 v39, v94, v95
    v_exp_f32 v97, v97
    v_exp_f32 v98, v98
    v_cvt_pk_bf16_f32 v40, v96, v97
    v_exp_f32 v99, v99
    v_exp_f32 v100, v100
    v_cvt_pk_bf16_f32 v41, v98, v99
    v_exp_f32 v101, v101
    v_exp_f32 v102, v102
    v_cvt_pk_bf16_f32 v42, v100, v101
    v_exp_f32 v103, v103
    s_nop 0
    v_cvt_pk_bf16_f32 v43, v102, v103
    s_waitcnt lgkmcnt(0)
    v_mfma_f32_32x32x16_bf16 v[88:103], v[20:23], v[232:235], v[56:71]
    ds_read_b128 v[20:23], v2 offset:61440
    v_mfma_f32_32x32x16_bf16 v[88:103], v[24:27], v[236:239], v[88:103]
    ds_read_b128 v[24:27], v2 offset:62464
    s_waitcnt vmcnt(4)
    v_mfma_f32_32x32x16_bf16 v[72:87], v[28:31], v[36:39], v[72:87]
    ds_read_b128 v[28:31], v2 offset:55296
    v_smfmac_f32_16x16x64_bf16 v[52:55], v[10:13], v[36:43], v14
    v_mfma_f32_32x32x16_bf16 v[72:87], v[32:35], v[40:43], v[72:87]
    ds_read_b128 v[32:35], v2 offset:56320
    s_cmp_lt_u32 s20, 4
    s_cbranch_scc1 mega_kernel_g_18
    s_barrier
mega_kernel_g_18:
    s_setprio 0
    v_exp_f32 v104, v104
    v_exp_f32 v105, v105
    v_exp_f32 v106, v106
    v_cvt_pk_bf16_f32 v44, v104, v105
    v_exp_f32 v107, v107
    s_setprio 1
    v_exp_f32 v108, v108
    v_cvt_pk_bf16_f32 v45, v106, v107
    v_exp_f32 v109, v109
    v_exp_f32 v110, v110
    v_cvt_pk_bf16_f32 v46, v108, v109
    v_exp_f32 v111, v111
    v_exp_f32 v112, v112
    v_cvt_pk_bf16_f32 v47, v110, v111
    v_exp_f32 v113, v113
    v_exp_f32 v114, v114
    v_cvt_pk_bf16_f32 v48, v112, v113
    v_exp_f32 v115, v115
    v_exp_f32 v116, v116
    v_cvt_pk_bf16_f32 v49, v114, v115
    v_exp_f32 v117, v117
    v_exp_f32 v118, v118
    v_cvt_pk_bf16_f32 v50, v116, v117
    v_exp_f32 v119, v119
    s_nop 0
    v_cvt_pk_bf16_f32 v51, v118, v119
    s_cmp_lt_u32 s20, 4
    s_cbranch_scc0 mega_kernel_g_19
    s_barrier
mega_kernel_g_19:
    s_waitcnt lgkmcnt(0)
    v_mfma_f32_32x32x16_bf16 v[104:119], v[20:23], v[232:235], v[56:71]
    ds_read_b128 v[20:23], v3 offset:0
    buffer_load_dwordx2 v[254:255], v249, s[16:19], s30 offen sc1
    v_mfma_f32_32x32x16_bf16 v[104:119], v[24:27], v[236:239], v[104:119]
    ds_read_b128 v[24:27], v3 offset:1024
    v_mfma_f32_32x32x16_bf16 v[72:87], v[28:31], v[44:47], v[72:87]
    ds_read_b128 v[28:31], v2 offset:59392
    v_smfmac_f32_16x16x64_bf16 v[52:55], v[10:13], v[44:51], v14
    v_mfma_f32_32x32x16_bf16 v[72:87], v[32:35], v[48:51], v[72:87]
    ds_read_b128 v[32:35], v2 offset:60416
    s_setprio 0
    v_exp_f32 v88, v88
    v_exp_f32 v89, v89
    v_exp_f32 v90, v90
    v_cvt_pk_bf16_f32 v36, v88, v89
    v_exp_f32 v91, v91
    s_setprio 1
    v_exp_f32 v92, v92
    v_cvt_pk_bf16_f32 v37, v90, v91
    v_exp_f32 v93, v93
    v_exp_f32 v94, v94
    v_cvt_pk_bf16_f32 v38, v92, v93
    v_exp_f32 v95, v95
    v_exp_f32 v96, v96
    v_cvt_pk_bf16_f32 v39, v94, v95
    v_exp_f32 v97, v97
    v_exp_f32 v98, v98
    v_cvt_pk_bf16_f32 v40, v96, v97
    v_exp_f32 v99, v99
    v_exp_f32 v100, v100
    v_cvt_pk_bf16_f32 v41, v98, v99
    v_exp_f32 v101, v101
    v_exp_f32 v102, v102
    v_cvt_pk_bf16_f32 v42, v100, v101
    v_exp_f32 v103, v103
    s_nop 0
    v_cvt_pk_bf16_f32 v43, v102, v103
    s_waitcnt lgkmcnt(0)
    v_mfma_f32_32x32x16_bf16 v[88:103], v[20:23], v[232:235], v[56:71]
    ds_read_b128 v[20:23], v3 offset:4096
    s_lshr_b32 s3, s20, 1
    s_cmp_eq_u32 s3, 2
    s_cbranch_scc0 mega_kernel_g_20
    v_lshlrev_b32 v253, 7, v0
    buffer_load_dword v253, v253, s[12:15], s47 offen
mega_kernel_g_20:
    v_mfma_f32_32x32x16_bf16 v[88:103], v[24:27], v[236:239], v[88:103]
    ds_read_b128 v[24:27], v3 offset:5120
    v_mfma_f32_32x32x16_bf16 v[72:87], v[28:31], v[36:39], v[72:87]
    ds_read_b128 v[28:31], v2 offset:63488
    v_smfmac_f32_16x16x64_bf16 v[52:55], v[10:13], v[36:43], v14
    v_mfma_f32_32x32x16_bf16 v[72:87], v[32:35], v[40:43], v[72:87]
    ds_read_b128 v[32:35], v2 offset:64512
    s_setprio 0
    v_exp_f32 v104, v104
    v_exp_f32 v105, v105
    v_exp_f32 v106, v106
    v_cvt_pk_bf16_f32 v44, v104, v105
    v_exp_f32 v107, v107
    s_setprio 1
    v_exp_f32 v108, v108
    v_cvt_pk_bf16_f32 v45, v106, v107
    v_exp_f32 v109, v109
    v_exp_f32 v110, v110
    v_cvt_pk_bf16_f32 v46, v108, v109
    v_exp_f32 v111, v111
    v_exp_f32 v112, v112
    v_cvt_pk_bf16_f32 v47, v110, v111
    v_exp_f32 v113, v113
    v_exp_f32 v114, v114
    v_cvt_pk_bf16_f32 v48, v112, v113
    v_exp_f32 v115, v115
    v_exp_f32 v116, v116
    v_cvt_pk_bf16_f32 v49, v114, v115
    v_exp_f32 v117, v117
    v_exp_f32 v118, v118
    v_cvt_pk_bf16_f32 v50, v116, v117
    v_exp_f32 v119, v119
    s_nop 0
    v_cvt_pk_bf16_f32 v51, v118, v119
    v_add_f32 v5, v52, v53
    v_cmp_lt_f32 vcc, s43, v5
    s_waitcnt lgkmcnt(0)
    v_mfma_f32_32x32x16_bf16 v[72:87], v[28:31], v[44:47], v[72:87]
    ds_read_b128 v[28:31], v3 offset:2048
    v_smfmac_f32_16x16x64_bf16 v[52:55], v[10:13], v[44:51], v14
    v_mfma_f32_32x32x16_bf16 v[72:87], v[32:35], v[48:51], v[72:87]
    ds_read_b128 v[32:35], v3 offset:3072
    s_cbranch_vccnz mega_kernel_rr_21c
mega_kernel_rr_21:
    v_mfma_f32_32x32x16_bf16 v[104:119], v[20:23], v[232:235], v[56:71]
    ds_read_b128 v[20:23], v3 offset:8192
    buffer_load_dwordx4 v4, s[16:19], s24 offen offset:0 sc1 lds
    v_mfma_f32_32x32x16_bf16 v[104:119], v[24:27], v[236:239], v[104:119]
    ds_read_b128 v[24:27], v3 offset:9216
    s_setprio 0
    v_exp_f32 v88, v88
    v_exp_f32 v89, v89
    v_exp_f32 v90, v90
    v_cvt_pk_bf16_f32 v36, v88, v89
    v_exp_f32 v91, v91
    s_setprio 1
    v_exp_f32 v92, v92
    v_cvt_pk_bf16_f32 v37, v90, v91
    v_exp_f32 v93, v93
    v_exp_f32 v94, v94
    v_cvt_pk_bf16_f32 v38, v92, v93
    v_exp_f32 v95, v95
    v_exp_f32 v96, v96
    v_cvt_pk_bf16_f32 v39, v94, v95
    v_exp_f32 v97, v97
    v_exp_f32 v98, v98
    v_cvt_pk_bf16_f32 v40, v96, v97
    v_exp_f32 v99, v99
    v_exp_f32 v100, v100
    v_cvt_pk_bf16_f32 v41, v98, v99
    v_exp_f32 v101, v101
    v_exp_f32 v102, v102
    v_cvt_pk_bf16_f32 v42, v100, v101
    v_exp_f32 v103, v103
    s_nop 0
    v_cvt_pk_bf16_f32 v43, v102, v103
    s_waitcnt lgkmcnt(0)
    v_mfma_f32_32x32x16_bf16 v[88:103], v[20:23], v[232:235], v[56:71]
    ds_read_b128 v[20:23], v3 offset:12288
    buffer_load_dwordx4 v4, s[16:19], s24 offen offset:1024 sc1 lds
    v_mfma_f32_32x32x16_bf16 v[88:103], v[24:27], v[236:239], v[88:103]
    ds_read_b128 v[24:27], v3 offset:13312
    v_mfma_f32_32x32x16_bf16 v[72:87], v[28:31], v[36:39], v[72:87]
    ds_read_b128 v[28:31], v3 offset:6144
    v_smfmac_f32_16x16x64_bf16 v[52:55], v[10:13], v[36:43], v14
    v_mfma_f32_32x32x16_bf16 v[72:87], v[32:35], v[40:43], v[72:87]
    ds_read_b128 v[32:35], v3 offset:7168
    s_setprio 0
    v_exp_f32 v104, v104
    v_exp_f32 v105, v105
    v_exp_f32 v106, v106
    v_cvt_pk_bf16_f32 v44, v104, v105
    v_exp_f32 v107, v107
    s_setprio 1
    v_exp_f32 v108, v108
    v_cvt_pk_bf16_f32 v45, v106, v107
    v_exp_f32 v109, v109
    v_exp_f32 v110, v110
    v_cvt_pk_bf16_f32 v46, v108, v109
    v_exp_f32 v111, v111
    v_exp_f32 v112, v112
    v_cvt_pk_bf16_f32 v47, v110, v111
    v_exp_f32 v113, v113
    v_exp_f32 v114, v114
    v_cvt_pk_bf16_f32 v48, v112, v113
    v_exp_f32 v115, v115
    v_exp_f32 v116, v116
    v_cvt_pk_bf16_f32 v49, v114, v115
    v_exp_f32 v117, v117
    v_exp_f32 v118, v118
    v_cvt_pk_bf16_f32 v50, v116, v117
    v_exp_f32 v119, v119
    s_nop 0
    v_cvt_pk_bf16_f32 v51, v118, v119
    s_waitcnt lgkmcnt(0)
    v_mfma_f32_32x32x16_bf16 v[104:119], v[20:23], v[232:235], v[56:71]
    ds_read_b128 v[20:23], v3 offset:16384
    buffer_load_dwordx4 v4, s[16:19], s24 offen offset:2048 sc1 lds
    v_mfma_f32_32x32x16_bf16 v[104:119], v[24:27], v[236:239], v[104:119]
    ds_read_b128 v[24:27], v3 offset:17408
    v_mfma_f32_32x32x16_bf16 v[72:87], v[28:31], v[44:47], v[72:87]
    ds_read_b128 v[28:31], v3 offset:10240
    v_smfmac_f32_16x16x64_bf16 v[52:55], v[10:13], v[44:51], v14
    v_mfma_f32_32x32x16_bf16 v[72:87], v[32:35], v[48:51], v[72:87]
    ds_read_b128 v[32:35], v3 offset:11264
    s_setprio 0
    v_exp_f32 v88, v88
    v_exp_f32 v89, v89
    v_exp_f32 v90, v90
    v_cvt_pk_bf16_f32 v36, v88, v89
    v_exp_f32 v91, v91
    s_setprio 1
    v_exp_f32 v92, v92
    v_cvt_pk_bf16_f32 v37, v90, v91
    v_exp_f32 v93, v93
    v_exp_f32 v94, v94
    v_cvt_pk_bf16_f32 v38, v92, v93
    v_exp_f32 v95, v95
    v_exp_f32 v96, v96
    v_cvt_pk_bf16_f32 v39, v94, v95
    v_exp_f32 v97, v97
    v_exp_f32 v98, v98
    v_cvt_pk_bf16_f32 v40, v96, v97
    v_exp_f32 v99, v99
    v_exp_f32 v100, v100
    v_cvt_pk_bf16_f32 v41, v98, v99
    v_exp_f32 v101, v101
    v_exp_f32 v102, v102
    v_cvt_pk_bf16_f32 v42, v100, v101
    v_exp_f32 v103, v103
    s_nop 0
    v_cvt_pk_bf16_f32 v43, v102, v103
    s_waitcnt lgkmcnt(0)
    v_mfma_f32_32x32x16_bf16 v[88:103], v[20:23], v[232:235], v[56:71]
    ds_read_b128 v[20:23], v3 offset:20480
    buffer_load_dwordx4 v4, s[16:19], s24 offen offset:3072 sc1 lds
    v_mfma_f32_32x32x16_bf16 v[88:103], v[24:27], v[236:239], v[88:103]
    ds_read_b128 v[24:27], v3 offset:21504
    v_mfma_f32_32x32x16_bf16 v[72:87], v[28:31], v[36:39], v[72:87]
    ds_read_b128 v[28:31], v3 offset:14336
    v_smfmac_f32_16x16x64_bf16 v[52:55], v[10:13], v[36:43], v14
    v_mfma_f32_32x32x16_bf16 v[72:87], v[32:35], v[40:43], v[72:87]
    ds_read_b128 v[32:35], v3 offset:15360
    s_setprio 0
    v_exp_f32 v104, v104
    v_exp_f32 v105, v105
    v_exp_f32 v106, v106
    v_cvt_pk_bf16_f32 v44, v104, v105
    v_exp_f32 v107, v107
    s_setprio 1
    v_exp_f32 v108, v108
    v_cvt_pk_bf16_f32 v45, v106, v107
    v_exp_f32 v109, v109
    v_exp_f32 v110, v110
    v_cvt_pk_bf16_f32 v46, v108, v109
    v_exp_f32 v111, v111
    v_exp_f32 v112, v112
    v_cvt_pk_bf16_f32 v47, v110, v111
    v_exp_f32 v113, v113
    v_exp_f32 v114, v114
    v_cvt_pk_bf16_f32 v48, v112, v113
    v_exp_f32 v115, v115
    v_exp_f32 v116, v116
    v_cvt_pk_bf16_f32 v49, v114, v115
    v_exp_f32 v117, v117
    v_exp_f32 v118, v118
    v_cvt_pk_bf16_f32 v50, v116, v117
    v_exp_f32 v119, v119
    s_nop 0
    v_cvt_pk_bf16_f32 v51, v118, v119
    s_waitcnt lgkmcnt(0)
    v_mfma_f32_32x32x16_bf16 v[104:119], v[20:23], v[232:235], v[56:71]
    ds_read_b128 v[20:23], v3 offset:24576
    s_mov_b32 s24, s25
    s_add_u32 m0, s42, 98304
    v_mfma_f32_32x32x16_bf16 v[104:119], v[24:27], v[236:239], v[104:119]
    ds_read_b128 v[24:27], v3 offset:25600
    s_mov_b32 s6, s11
    s_mov_b32 s7, 0
    v_mfma_f32_32x32x16_bf16 v[72:87], v[28:31], v[44:47], v[72:87]
    ds_read_b128 v[28:31], v3 offset:18432
    v_smfmac_f32_16x16x64_bf16 v[52:55], v[10:13], v[44:51], v14
    v_mfma_f32_32x32x16_bf16 v[72:87], v[32:35], v[48:51], v[72:87]
    ds_read_b128 v[32:35], v3 offset:19456
    s_setprio 0
    v_exp_f32 v88, v88
    v_exp_f32 v89, v89
    v_exp_f32 v90, v90
    v_cvt_pk_bf16_f32 v36, v88, v89
    v_exp_f32 v91, v91
    s_setprio 1
    v_exp_f32 v92, v92
    v_cvt_pk_bf16_f32 v37, v90, v91
    v_exp_f32 v93, v93
    v_exp_f32 v94, v94
    v_cvt_pk_bf16_f32 v38, v92, v93
    v_exp_f32 v95, v95
    v_exp_f32 v96, v96
    v_cvt_pk_bf16_f32 v39, v94, v95
    v_exp_f32 v97, v97
    v_exp_f32 v98, v98
    v_cvt_pk_bf16_f32 v40, v96, v97
    v_exp_f32 v99, v99
    v_exp_f32 v100, v100
    v_cvt_pk_bf16_f32 v41, v98, v99
    v_exp_f32 v101, v101
    v_exp_f32 v102, v102
    v_cvt_pk_bf16_f32 v42, v100, v101
    v_exp_f32 v103, v103
    s_nop 0
    v_cvt_pk_bf16_f32 v43, v102, v103
    s_waitcnt lgkmcnt(0)
    v_mfma_f32_32x32x16_bf16 v[88:103], v[20:23], v[232:235], v[56:71]
    ds_read_b128 v[20:23], v3 offset:28672
    v_mfma_f32_32x32x16_bf16 v[88:103], v[24:27], v[236:239], v[88:103]
    ds_read_b128 v[24:27], v3 offset:29696
    s_waitcnt vmcnt(4)
    v_and_b32 v250, v254, v255
    v_cmp_eq_u32 vcc, 1, v250
    s_and_b64 vcc, vcc, s[6:7]
    s_cmp_eq_u64 vcc, s[6:7]
    s_cbranch_scc0 mega_kernel_a_fsp
mega_kernel_a_fsp_ret:
    v_mfma_f32_32x32x16_bf16 v[72:87], v[28:31], v[36:39], v[72:87]
    ds_read_b128 v[28:31], v3 offset:22528
    v_smfmac_f32_16x16x64_bf16 v[52:55], v[10:13], v[36:43], v14
    v_mfma_f32_32x32x16_bf16 v[72:87], v[32:35], v[40:43], v[72:87]
    ds_read_b128 v[32:35], v3 offset:23552
    s_cmp_lt_u32 s20, 4
    s_cbranch_scc1 mega_kernel_g_22
    s_barrier
mega_kernel_g_22:
    s_setprio 0
    v_exp_f32 v104, v104
    v_exp_f32 v105, v105
    v_exp_f32 v106, v106
    v_cvt_pk_bf16_f32 v44, v104, v105
    v_exp_f32 v107, v107
    s_setprio 1
    v_exp_f32 v108, v108
    v_cvt_pk_bf16_f32 v45, v106, v107
    v_exp_f32 v109, v109
    v_exp_f32 v110, v110
    v_cvt_pk_bf16_f32 v46, v108, v109
    v_exp_f32 v111, v111
    v_exp_f32 v112, v112
    v_cvt_pk_bf16_f32 v47, v110, v111
    v_exp_f32 v113, v113
    v_exp_f32 v114, v114
    v_cvt_pk_bf16_f32 v48, v112, v113
    v_exp_f32 v115, v115
    v_exp_f32 v116, v116
    v_cvt_pk_bf16_f32 v49, v114, v115
    v_exp_f32 v117, v117
    v_exp_f32 v118, v118
    v_cvt_pk_bf16_f32 v50, v116, v117
    v_exp_f32 v119, v119
    s_nop 0
    v_cvt_pk_bf16_f32 v51, v118, v119
    s_cmp_lt_u32 s20, 4
    s_cbranch_scc0 mega_kernel_g_23
    s_barrier
mega_kernel_g_23:
    s_waitcnt lgkmcnt(0)
    v_mfma_f32_32x32x16_bf16 v[104:119], v[20:23], v[232:235], v[56:71]
    ds_read_b128 v[20:23], v1 offset:0
    s_cmp_eq_u32 s20, 1
    s_cbranch_scc0 mega_kernel_g_24
mega_kernel_cp38:
    s_getpc_b64 s[4:5]
    s_bfe_u32 s3, s2, 0x20003
    s_lshl_b32 s3, s3, 13
    v_lshlrev_b32 v253, 7, v0
    v_add_u32 v253, s3, v253
    v_min_u32 v253, mega_kernel_codeend-mega_kernel_cp38-8, v253
    global_load_dword v253, v253, s[4:5]
mega_kernel_g_24:
    v_mfma_f32_32x32x16_bf16 v[104:119], v[24:27], v[236:239], v[104:119]
    ds_read_b128 v[24:27], v1 offset:1024
    v_mfma_f32_32x32x16_bf16 v[72:87], v[28:31], v[44:47], v[72:87]
    ds_read_b128 v[28:31], v3 offset:26624
    v_smfmac_f32_16x16x64_bf16 v[52:55], v[10:13], v[44:51], v14
    v_mfma_f32_32x32x16_bf16 v[72:87], v[32:35], v[48:51], v[72:87]
    ds_read_b128 v[32:35], v3 offset:27648
    s_setprio 0
    v_exp_f32 v88, v88
    v_exp_f32 v89, v89
    v_exp_f32 v90, v90
    v_cvt_pk_bf16_f32 v36, v88, v89
    v_exp_f32 v91, v91
    s_setprio 1
    v_exp_f32 v92, v92
    v_cvt_pk_bf16_f32 v37, v90, v91
    v_exp_f32 v93, v93
    v_exp_f32 v94, v94
    v_cvt_pk_bf16_f32 v38, v92, v93
    v_exp_f32 v95, v95
    v_exp_f32 v96, v96
    v_cvt_pk_bf16_f32 v39, v94, v95
    v_exp_f32 v97, v97
    v_exp_f32 v98, v98
    v_cvt_pk_bf16_f32 v40, v96, v97
    v_exp_f32 v99, v99
    v_exp_f32 v100, v100
    v_cvt_pk_bf16_f32 v41, v98, v99
    v_exp_f32 v101, v101
    v_exp_f32 v102, v102
    v_cvt_pk_bf16_f32 v42, v100, v101
    v_exp_f32 v103, v103
    s_nop 0
    v_cvt_pk_bf16_f32 v43, v102, v103
    s_waitcnt lgkmcnt(0)
    v_mfma_f32_32x32x16_bf16 v[88:103], v[20:23], v[232:235], v[56:71]
    ds_read_b128 v[20:23], v1 offset:4096
    s_lshr_b32 s3, s20, 1
    s_cmp_eq_u32 s3, 3
    s_cbranch_scc0 mega_kernel_g_25
    v_lshlrev_b32 v253, 7, v0
    buffer_load_dword v253, v253, s[12:15], s47 offen
mega_kernel_g_25:
    v_mfma_f32_32x32x16_bf16 v[88:103], v[24:27], v[236:239], v[88:103]
    ds_read_b128 v[24:27], v1 offset:5120
    v_mfma_f32_32x32x16_bf16 v[72:87], v[28:31], v[36:39], v[72:87]
    ds_read_b128 v[28:31], v3 offset:30720
    v_smfmac_f32_16x16x64_bf16 v[52:55], v[10:13], v[36:43], v14
    v_mfma_f32_32x32x16_bf16 v[72:87], v[32:35], v[40:43], v[72:87]
    ds_read_b128 v[32:35], v3 offset:31744
    s_setprio 0
    v_exp_f32 v104, v104
    v_exp_f32 v105, v105
    v_exp_f32 v106, v106
    v_cvt_pk_bf16_f32 v44, v104, v105
    v_exp_f32 v107, v107
    s_setprio 1
    v_exp_f32 v108, v108
    v_cvt_pk_bf16_f32 v45, v106, v107
    v_exp_f32 v109, v109
    v_exp_f32 v110, v110
    v_cvt_pk_bf16_f32 v46, v108, v109
    v_exp_f32 v111, v111
    v_exp_f32 v112, v112
    v_cvt_pk_bf16_f32 v47, v110, v111
    v_exp_f32 v113, v113
    v_exp_f32 v114, v114
    v_cvt_pk_bf16_f32 v48, v112, v113
    v_exp_f32 v115, v115
    v_exp_f32 v116, v116
    v_cvt_pk_bf16_f32 v49, v114, v115
    v_exp_f32 v117, v117
    v_exp_f32 v118, v118
    v_cvt_pk_bf16_f32 v50, v116, v117
    v_exp_f32 v119, v119
    s_nop 0
    v_cvt_pk_bf16_f32 v51, v118, v119
    v_add_f32 v5, v52, v53
    v_cmp_lt_f32 vcc, s43, v5
    s_waitcnt lgkmcnt(0)
    v_mfma_f32_32x32x16_bf16 v[72:87], v[28:31], v[44:47], v[72:87]
    ds_read_b128 v[28:31], v1 offset:2048
    s_mov_b32 s48, 0xffffffff
    s_mov_b32 s49, 0xfffffff0
    s_mov_b32 s50, 0xfffffffe
    s_mov_b32 s51, 0xffffffe0
    v_smfmac_f32_16x16x64_bf16 v[52:55], v[10:13], v[44:51], v14
    v_mfma_f32_32x32x16_bf16 v[72:87], v[32:35], v[48:51], v[72:87]
    ds_read_b128 v[32:35], v1 offset:3072
    s_cbranch_vccnz mega_kernel_rr_26c
mega_kernel_rr_26:
    v_mfma_f32_32x32x16_bf16 v[104:119], v[20:23], v[232:235], v[56:71]
    ds_read_b128 v[20:23], v1 offset:8192
    buffer_load_dwordx4 v4, s[16:19], s24 offen offset:0 sc1 lds
    v_mfma_f32_32x32x16_bf16 v[104:119], v[24:27], v[236:239], v[104:119]
    ds_read_b128 v[24:27], v1 offset:9216
    s_setprio 0
    v_exp_f32 v88, v88
    v_exp_f32 v89, v89
    v_exp_f32 v90, v90
    v_cvt_pk_bf16_f32 v36, v88, v89
    v_exp_f32 v91, v91
    s_setprio 1
    v_exp_f32 v92, v92
    v_cvt_pk_bf16_f32 v37, v90, v91
    v_exp_f32 v93, v93
    v_exp_f32 v94, v94
    v_cvt_pk_bf16_f32 v38, v92, v93
    v_exp_f32 v95, v95
    v_exp_f32 v96, v96
    v_cvt_pk_bf16_f32 v39, v94, v95
    v_exp_f32 v97, v97
    v_exp_f32 v98, v98
    v_cvt_pk_bf16_f32 v40, v96, v97
    v_exp_f32 v99, v99
    v_exp_f32 v100, v100
    v_cvt_pk_bf16_f32 v41, v98, v99
    v_exp_f32 v101, v101
    v_exp_f32 v102, v102
    v_cvt_pk_bf16_f32 v42, v100, v101
    v_exp_f32 v103, v103
    s_nop 0
    v_cvt_pk_bf16_f32 v43, v102, v103
    s_waitcnt lgkmcnt(0)
    v_mfma_f32_32x32x16_bf16 v[88:103], v[20:23], v[232:235], v[56:71]
    ds_read_b128 v[20:23], v1 offset:12288
    buffer_load_dwordx4 v4, s[16:19], s24 offen offset:1024 sc1 lds
    v_mfma_f32_32x32x16_bf16 v[88:103], v[24:27], v[236:239], v[88:103]
    ds_read_b128 v[24:27], v1 offset:13312
    v_mfma_f32_32x32x16_bf16 v[72:87], v[28:31], v[36:39], v[72:87]
    ds_read_b128 v[28:31], v1 offset:6144
    s_mov_b32 s52, 0xfffffffc
    s_mov_b32 s53, 0xffffffc0
    s_mov_b32 s54, 0xfffffff8
    s_mov_b32 s55, 0xffffff80
    v_smfmac_f32_16x16x64_bf16 v[52:55], v[10:13], v[36:43], v14
    v_mfma_f32_32x32x16_bf16 v[72:87], v[32:35], v[40:43], v[72:87]
    ds_read_b128 v[32:35], v1 offset:7168
    s_setprio 0
    v_exp_f32 v104, v104
    v_exp_f32 v105, v105
    v_exp_f32 v106, v106
    v_cvt_pk_bf16_f32 v44, v104, v105
    v_exp_f32 v107, v107
    s_setprio 1
    v_exp_f32 v108, v108
    v_cvt_pk_bf16_f32 v45, v106, v107
    v_exp_f32 v109, v109
    v_exp_f32 v110, v110
    v_cvt_pk_bf16_f32 v46, v108, v109
    v_exp_f32 v111, v111
    v_exp_f32 v112, v112
    v_cvt_pk_bf16_f32 v47, v110, v111
    v_exp_f32 v113, v113
    v_exp_f32 v114, v114
    v_cvt_pk_bf16_f32 v48, v112, v113
    v_exp_f32 v115, v115
    v_exp_f32 v116, v116
    v_cvt_pk_bf16_f32 v49, v114, v115
    v_exp_f32 v117, v117
    v_exp_f32 v118, v118
    v_cvt_pk_bf16_f32 v50, v116, v117
    v_exp_f32 v119, v119
    s_nop 0
    v_cvt_pk_bf16_f32 v51, v118, v119
    s_waitcnt lgkmcnt(0)
    v_mfma_f32_32x32x16_bf16 v[104:119], v[20:23], v[232:235], v[56:71]
    ds_read_b128 v[20:23], v1 offset:16384
    buffer_load_dwordx4 v4, s[16:19], s24 offen offset:2048 sc1 lds
    v_mfma_f32_32x32x16_bf16 v[104:119], v[24:27], v[236:239], v[104:119]
    ds_read_b128 v[24:27], v1 offset:17408
    v_mfma_f32_32x32x16_bf16 v[72:87], v[28:31], v[44:47], v[72:87]
    ds_read_b128 v[28:31], v1 offset:10240
    s_mov_b32 s56, 0xffffff00
    s_mov_b32 s57, 0xfffff000
    s_mov_b32 s58, 0xfffffe00
    s_mov_b32 s59, 0xffffe000
    v_smfmac_f32_16x16x64_bf16 v[52:55], v[10:13], v[44:51], v14
    v_mfma_f32_32x32x16_bf16 v[72:87], v[32:35], v[48:51], v[72:87]
    ds_read_b128 v[32:35], v1 offset:11264
    s_setprio 0
    v_exp_f32 v88, v88
    v_exp_f32 v89, v89
    v_exp_f32 v90, v90
    v_cvt_pk_bf16_f32 v36, v88, v89
    v_exp_f32 v91, v91
    s_setprio 1
    v_exp_f32 v92, v92
    v_cvt_pk_bf16_f32 v37, v90, v91
    v_exp_f32 v93, v93
    v_exp_f32 v94, v94
    v_cvt_pk_bf16_f32 v38, v92, v93
    v_exp_f32 v95, v95
    v_exp_f32 v96, v96
    v_cvt_pk_bf16_f32 v39, v94, v95
    v_exp_f32 v97, v97
    v_exp_f32 v98, v98
    v_cvt_pk_bf16_f32 v40, v96, v97
    v_exp_f32 v99, v99
    v_exp_f32 v100, v100
    v_cvt_pk_bf16_f32 v41, v98, v99
    v_exp_f32 v101, v101
    v_exp_f32 v102, v102
    v_cvt_pk_bf16_f32 v42, v100, v101
    v_exp_f32 v103, v103
    s_nop 0
    v_cvt_pk_bf16_f32 v43, v102, v103
    s_waitcnt lgkmcnt(0)
    v_mfma_f32_32x32x16_bf16 v[88:103], v[20:23], v[232:235], v[56:71]
    ds_read_b128 v[20:23], v1 offset:20480
    buffer_load_dwordx4 v4, s[16:19], s24 offen offset:3072 sc1 lds
    v_mfma_f32_32x32x16_bf16 v[88:103], v[24:27], v[236:239], v[88:103]
    ds_read_b128 v[24:27], v1 offset:21504
    v_mfma_f32_32x32x16_bf16 v[72:87], v[28:31], v[36:39], v[72:87]
    ds_read_b128 v[28:31], v1 offset:14336
    s_mov_b32 s60, 0xfffffc00
    s_mov_b32 s61, 0xffffc000
    s_mov_b32 s62, 0xfffff800
    s_mov_b32 s63, 0xffff8000
    v_smfmac_f32_16x16x64_bf16 v[52:55], v[10:13], v[36:43], v14
    v_mfma_f32_32x32x16_bf16 v[72:87], v[32:35], v[40:43], v[72:87]
    ds_read_b128 v[32:35], v1 offset:15360
    s_setprio 0
    v_exp_f32 v104, v104
    v_exp_f32 v105, v105
    v_exp_f32 v106, v106
    v_cvt_pk_bf16_f32 v44, v104, v105
    v_exp_f32 v107, v107
    s_setprio 1
    v_exp_f32 v108, v108
    v_cvt_pk_bf16_f32 v45, v106, v107
    v_exp_f32 v109, v109
    v_exp_f32 v110, v110
    v_cvt_pk_bf16_f32 v46, v108, v109
    v_exp_f32 v111, v111
    v_exp_f32 v112, v112
    v_cvt_pk_bf16_f32 v47, v110, v111
    v_exp_f32 v113, v113
    v_exp_f32 v114, v114
    v_cvt_pk_bf16_f32 v48, v112, v113
    v_exp_f32 v115, v115
    v_exp_f32 v116, v116
    v_cvt_pk_bf16_f32 v49, v114, v115
    v_exp_f32 v117, v117
    v_exp_f32 v118, v118
    v_cvt_pk_bf16_f32 v50, v116, v117
    v_exp_f32 v119, v119
    s_nop 0
    v_cvt_pk_bf16_f32 v51, v118, v119
    s_waitcnt lgkmcnt(0)
    v_mfma_f32_32x32x16_bf16 v[104:119], v[20:23], v[232:235], v[56:71]
    ds_read_b128 v[20:23], v1 offset:24576
    s_mov_b32 s24, s26
    s_add_u32 m0, s42, 131072
    v_mfma_f32_32x32x16_bf16 v[104:119], v[24:27], v[236:239], v[104:119]
    ds_read_b128 v[24:27], v1 offset:25600
    v_mfma_f32_32x32x16_bf16 v[72:87], v[28:31], v[44:47], v[72:87]
    ds_read_b128 v[28:31], v1 offset:18432
    s_mov_b32 s64, 0xffff0000
    s_mov_b32 s65, 0xfff00000
    s_mov_b32 s66, 0xfffe0000
    s_mov_b32 s67, 0xffe00000
    v_smfmac_f32_16x16x64_bf16 v[52:55], v[10:13], v[44:51], v14
    v_mfma_f32_32x32x16_bf16 v[72:87], v[32:35], v[48:51], v[72:87]
    ds_read_b128 v[32:35], v1 offset:19456
    s_setprio 0
    v_exp_f32 v88, v88
    v_exp_f32 v89, v89
    v_exp_f32 v90, v90
    v_cvt_pk_bf16_f32 v36, v88, v89
    v_exp_f32 v91, v91
    s_setprio 1
    v_exp_f32 v92, v92
    v_cvt_pk_bf16_f32 v37, v90, v91
    v_exp_f32 v93, v93
    v_exp_f32 v94, v94
    v_cvt_pk_bf16_f32 v38, v92, v93
    v_exp_f32 v95, v95
    v_exp_f32 v96, v96
    v_cvt_pk_bf16_f32 v39, v94, v95
    v_exp_f32 v97, v97
    v_exp_f32 v98, v98
    v_cvt_pk_bf16_f32 v40, v96, v97
    v_exp_f32 v99, v99
    v_exp_f32 v100, v100
    v_cvt_pk_bf16_f32 v41, v98, v99
    v_exp_f32 v101, v101
    v_exp_f32 v102, v102
    v_cvt_pk_bf16_f32 v42, v100, v101
    v_exp_f32 v103, v103
    s_nop 0
    v_cvt_pk_bf16_f32 v43, v102, v103
    s_waitcnt lgkmcnt(0)
    v_mfma_f32_32x32x16_bf16 v[88:103], v[20:23], v[232:235], v[56:71]
    ds_read_b128 v[20:23], v1 offset:28672
    v_mfma_f32_32x32x16_bf16 v[88:103], v[24:27], v[236:239], v[88:103]
    ds_read_b128 v[24:27], v1 offset:29696
    s_waitcnt vmcnt(4)
    v_mfma_f32_32x32x16_bf16 v[72:87], v[28:31], v[36:39], v[72:87]
    ds_read_b128 v[28:31], v1 offset:22528
    s_mov_b32 s68, 0xfffc0000
    s_mov_b32 s69, 0xffc00000
    s_mov_b32 s70, 0xfff80000
    s_mov_b32 s71, 0xff800000
    v_smfmac_f32_16x16x64_bf16 v[52:55], v[10:13], v[36:43], v14
    v_mfma_f32_32x32x16_bf16 v[72:87], v[32:35], v[40:43], v[72:87]
    ds_read_b128 v[32:35], v1 offset:23552
    s_cmp_lt_u32 s20, 4
    s_cbranch_scc1 mega_kernel_g_27
    s_barrier
mega_kernel_g_27:
    s_setprio 0
    v_exp_f32 v104, v104
    v_exp_f32 v105, v105
    v_exp_f32 v106, v106
    v_cvt_pk_bf16_f32 v44, v104, v105
    v_exp_f32 v107, v107
    s_setprio 1
    v_exp_f32 v108, v108
    v_cvt_pk_bf16_f32 v45, v106, v107
    v_exp_f32 v109, v109
    v_exp_f32 v110, v110
    v_cvt_pk_bf16_f32 v46, v108, v109
    v_exp_f32 v111, v111
    v_exp_f32 v112, v112
    v_cvt_pk_bf16_f32 v47, v110, v111
    v_exp_f32 v113, v113
    v_exp_f32 v114, v114
    v_cvt_pk_bf16_f32 v48, v112, v113
    v_exp_f32 v115, v115
    v_exp_f32 v116, v116
    v_cvt_pk_bf16_f32 v49, v114, v115
    v_exp_f32 v117, v117
    v_exp_f32 v118, v118
    v_cvt_pk_bf16_f32 v50, v116, v117
    v_exp_f32 v119, v119
    s_nop 0
    v_cvt_pk_bf16_f32 v51, v118, v119
    s_cmp_lt_u32 s20, 4
    s_cbranch_scc0 mega_kernel_g_28
    s_barrier
mega_kernel_g_28:
    s_waitcnt lgkmcnt(0)
    v_mfma_f32_32x32x16_bf16 v[104:119], v[20:23], v[232:235], v[56:71]
    ds_read_b128 v[20:23], v1 offset:32768
    buffer_load_dwordx4 v[240:243], v1, s[16:19], s46 offen offset:0 sc1
    v_mfma_f32_32x32x16_bf16 v[104:119], v[24:27], v[236:239], v[104:119]
    ds_read_b128 v[24:27], v1 offset:33792
    v_mfma_f32_32x32x16_bf16 v[72:87], v[28:31], v[44:47], v[72:87]
    ds_read_b128 v[28:31], v1 offset:26624
    s_mov_b32 s72, 0xff000000
    s_mov_b32 s73, 0xf0000000
    s_mov_b32 s74, 0xfe000000
    s_mov_b32 s75, 0xe0000000
    v_smfmac_f32_16x16x64_bf16 v[52:55], v[10:13], v[44:51], v14
    v_mfma_f32_32x32x16_bf16 v[72:87], v[32:35], v[48:51], v[72:87]
    ds_read_b128 v[32:35], v1 offset:27648
    s_setprio 0
    v_exp_f32 v88, v88
    v_exp_f32 v89, v89
    v_exp_f32 v90, v90
    v_cvt_pk_bf16_f32 v36, v88, v89
    v_exp_f32 v91, v91
    s_setprio 1
    v_exp_f32 v92, v92
    v_cvt_pk_bf16_f32 v37, v90, v91
    v_exp_f32 v93, v93
    v_exp_f32 v94, v94
    v_cvt_pk_bf16_f32 v38, v92, v93
    v_exp_f32 v95, v95
    v_exp_f32 v96, v96
    v_cvt_pk_bf16_f32 v39, v94, v95
    v_exp_f32 v97, v97
    v_exp_f32 v98, v98
    v_cvt_pk_bf16_f32 v40, v96, v97
    v_exp_f32 v99, v99
    v_exp_f32 v100, v100
    v_cvt_pk_bf16_f32 v41, v98, v99
    v_exp_f32 v101, v101
    v_exp_f32 v102, v102
    v_cvt_pk_bf16_f32 v42, v100, v101
    v_exp_f32 v103, v103
    s_nop 0
    v_cvt_pk_bf16_f32 v43, v102, v103
    s_waitcnt lgkmcnt(0)
    v_mfma_f32_32x32x16_bf16 v[88:103], v[20:23], v[232:235], v[56:71]
    ds_read_b128 v[20:23], v1 offset:36864
    buffer_load_dwordx4 v[244:247], v1, s[16:19], s46 offen offset:1024 sc1
    v_mfma_f32_32x32x16_bf16 v[88:103], v[24:27], v[236:239], v[88:103]
    ds_read_b128 v[24:27], v1 offset:37888
    v_mfma_f32_32x32x16_bf16 v[72:87], v[28:31], v[36:39], v[72:87]
    ds_read_b128 v[28:31], v1 offset:30720
    s_mov_b32 s76, 0xfc000000
    s_mov_b32 s77, 0xc0000000
    s_mov_b32 s78, 0xf8000000
    s_mov_b32 s79, 0x80000000
    v_smfmac_f32_16x16x64_bf16 v[52:55], v[10:13], v[36:43], v14
    v_mfma_f32_32x32x16_bf16 v[72:87], v[32:35], v[40:43], v[72:87]
    ds_read_b128 v[32:35], v1 offset:31744
    s_setprio 0
    v_exp_f32 v104, v104
    v_exp_f32 v105, v105
    v_exp_f32 v106, v106
    v_cvt_pk_bf16_f32 v44, v104, v105
    v_exp_f32 v107, v107
    s_setprio 1
    v_exp_f32 v108, v108
    v_cvt_pk_bf16_f32 v45, v106, v107
    v_exp_f32 v109, v109
    v_exp_f32 v110, v110
    v_cvt_pk_bf16_f32 v46, v108, v109
    v_exp_f32 v111, v111
    v_exp_f32 v112, v112
    v_cvt_pk_bf16_f32 v47, v110, v111
    v_exp_f32 v113, v113
    v_exp_f32 v114, v114
    v_cvt_pk_bf16_f32 v48, v112, v113
    v_exp_f32 v115, v115
    v_exp_f32 v116, v116
    v_cvt_pk_bf16_f32 v49, v114, v115
    v_exp_f32 v117, v117
    v_exp_f32 v118, v118
    v_cvt_pk_bf16_f32 v50, v116, v117
    v_exp_f32 v119, v119
    s_nop 0
    v_cvt_pk_bf16_f32 v51, v118, v119
    v_add_f32 v5, v52, v53
    v_cmp_lt_f32 vcc, s43, v5
    s_waitcnt lgkmcnt(0)
    v_mfma_f32_32x32x16_bf16 v[72:87], v[28:31], v[44:47], v[72:87]
    ds_read_b128 v[28:31], v1 offset:34816
    v_smfmac_f32_16x16x64_bf16 v[52:55], v[10:13], v[44:51], v14
    v_mfma_f32_32x32x16_bf16 v[72:87], v[32:35], v[48:51], v[72:87]
    ds_read_b128 v[32:35], v1 offset:35840
    s_cbranch_vccnz mega_kernel_rr_29c
mega_kernel_rr_29:
    v_mfma_f32_32x32x16_bf16 v[104:119], v[20:23], v[232:235], v[56:71]
    ds_read_b128 v[20:23], v1 offset:40960
    buffer_load_dwordx4 v4, s[16:19], s24 offen offset:0 sc1 lds
    v_mfma_f32_32x32x16_bf16 v[104:119], v[24:27], v[236:239], v[104:119]
    ds_read_b128 v[24:27], v1 offset:41984
    s_setprio 0
    v_exp_f32 v88, v88
    v_exp_f32 v89, v89
    v_exp_f32 v90, v90
    v_cvt_pk_bf16_f32 v36, v88, v89
    v_exp_f32 v91, v91
    s_setprio 1
    v_exp_f32 v92, v92
    v_cvt_pk_bf16_f32 v37, v90, v91
    v_exp_f32 v93, v93
    v_exp_f32 v94, v94
    v_cvt_pk_bf16_f32 v38, v92, v93
    v_exp_f32 v95, v95
    v_exp_f32 v96, v96
    v_cvt_pk_bf16_f32 v39, v94, v95
    v_exp_f32 v97, v97
    v_exp_f32 v98, v98
    v_cvt_pk_bf16_f32 v40, v96, v97
    v_exp_f32 v99, v99
    v_exp_f32 v100, v100
    v_cvt_pk_bf16_f32 v41, v98, v99
    v_exp_f32 v101, v101
    v_exp_f32 v102, v102
    v_cvt_pk_bf16_f32 v42, v100, v101
    v_exp_f32 v103, v103
    s_nop 0
    v_cvt_pk_bf16_f32 v43, v102, v103
    s_waitcnt lgkmcnt(0)
    v_mfma_f32_32x32x16_bf16 v[88:103], v[20:23], v[232:235], v[56:71]
    ds_read_b128 v[20:23], v1 offset:45056
    buffer_load_dwordx4 v4, s[16:19], s24 offen offset:1024 sc1 lds
    v_mfma_f32_32x32x16_bf16 v[88:103], v[24:27], v[236:239], v[88:103]
    ds_read_b128 v[24:27], v1 offset:46080
    v_mfma_f32_32x32x16_bf16 v[72:87], v[28:31], v[36:39], v[72:87]
    ds_read_b128 v[28:31], v1 offset:38912
    v_smfmac_f32_16x16x64_bf16 v[52:55], v[10:13], v[36:43], v14
    v_mfma_f32_32x32x16_bf16 v[72:87], v[32:35], v[40:43], v[72:87]
    ds_read_b128 v[32:35], v1 offset:39936
    s_setprio 0
    v_exp_f32 v104, v104
    v_exp_f32 v105, v105
    v_exp_f32 v106, v106
    v_cvt_pk_bf16_f32 v44, v104, v105
    v_exp_f32 v107, v107
    s_setprio 1
    v_exp_f32 v108, v108
    v_cvt_pk_bf16_f32 v45, v106, v107
    v_exp_f32 v109, v109
    v_exp_f32 v110, v110
    v_cvt_pk_bf16_f32 v46, v108, v109
    v_exp_f32 v111, v111
    v_exp_f32 v112, v112
    v_cvt_pk_bf16_f32 v47, v110, v111
    v_exp_f32 v113, v113
    v_exp_f32 v114, v114
    v_cvt_pk_bf16_f32 v48, v112, v113
    v_exp_f32 v115, v115
    v_exp_f32 v116, v116
    v_cvt_pk_bf16_f32 v49, v114, v115
    v_exp_f32 v117, v117
    v_exp_f32 v118, v118
    v_cvt_pk_bf16_f32 v50, v116, v117
    v_exp_f32 v119, v119
    s_nop 0
    v_cvt_pk_bf16_f32 v51, v118, v119
    s_waitcnt lgkmcnt(0)
    v_mfma_f32_32x32x16_bf16 v[104:119], v[20:23], v[232:235], v[56:71]
    ds_read_b128 v[20:23], v1 offset:49152
    buffer_load_dwordx4 v4, s[16:19], s24 offen offset:2048 sc1 lds
    v_mfma_f32_32x32x16_bf16 v[104:119], v[24:27], v[236:239], v[104:119]
    ds_read_b128 v[24:27], v1 offset:50176
    v_mfma_f32_32x32x16_bf16 v[72:87], v[28:31], v[44:47], v[72:87]
    ds_read_b128 v[28:31], v1 offset:43008
    v_smfmac_f32_16x16x64_bf16 v[52:55], v[10:13], v[44:51], v14
    v_mfma_f32_32x32x16_bf16 v[72:87], v[32:35], v[48:51], v[72:87]
    ds_read_b128 v[32:35], v1 offset:44032
    s_setprio 0
    v_exp_f32 v88, v88
    v_exp_f32 v89, v89
    v_exp_f32 v90, v90
    v_cvt_pk_bf16_f32 v36, v88, v89
    v_exp_f32 v91, v91
    s_setprio 1
    v_exp_f32 v92, v92
    v_cvt_pk_bf16_f32 v37, v90, v91
    v_exp_f32 v93, v93
    v_exp_f32 v94, v94
    v_cvt_pk_bf16_f32 v38, v92, v93
    v_exp_f32 v95, v95
    v_exp_f32 v96, v96
    v_cvt_pk_bf16_f32 v39, v94, v95
    v_exp_f32 v97, v97
    v_exp_f32 v98, v98
    v_cvt_pk_bf16_f32 v40, v96, v97
    v_exp_f32 v99, v99
    v_exp_f32 v100, v100
    v_cvt_pk_bf16_f32 v41, v98, v99
    v_exp_f32 v101, v101
    v_exp_f32 v102, v102
    v_cvt_pk_bf16_f32 v42, v100, v101
    v_exp_f32 v103, v103
    s_nop 0
    v_cvt_pk_bf16_f32 v43, v102, v103
    s_waitcnt lgkmcnt(0)
    v_mfma_f32_32x32x16_bf16 v[88:103], v[20:23], v[232:235], v[56:71]
    ds_read_b128 v[20:23], v1 offset:53248
    buffer_load_dwordx4 v4, s[16:19], s24 offen offset:3072 sc1 lds
    v_mfma_f32_32x32x16_bf16 v[88:103], v[24:27], v[236:239], v[88:103]
    ds_read_b128 v[24:27], v1 offset:54272
    v_mfma_f32_32x32x16_bf16 v[72:87], v[28:31], v[36:39], v[72:87]
    ds_read_b128 v[28:31], v1 offset:47104
    v_smfmac_f32_16x16x64_bf16 v[52:55], v[10:13], v[36:43], v14
    v_mfma_f32_32x32x16_bf16 v[72:87], v[32:35], v[40:43], v[72:87]
    ds_read_b128 v[32:35], v1 offset:48128
    s_setprio 0
    v_exp_f32 v104, v104
    v_exp_f32 v105, v105
    v_exp_f32 v106, v106
    v_cvt_pk_bf16_f32 v44, v104, v105
    v_exp_f32 v107, v107
    s_setprio 1
    v_exp_f32 v108, v108
    v_cvt_pk_bf16_f32 v45, v106, v107
    v_exp_f32 v109, v109
    v_exp_f32 v110, v110
    v_cvt_pk_bf16_f32 v46, v108, v109
    v_exp_f32 v111, v111
    v_exp_f32 v112, v112
    v_cvt_pk_bf16_f32 v47, v110, v111
    v_exp_f32 v113, v113
    v_exp_f32 v114, v114
    v_cvt_pk_bf16_f32 v48, v112, v113
    v_exp_f32 v115, v115
    v_exp_f32 v116, v116
    v_cvt_pk_bf16_f32 v49, v114, v115
    v_exp_f32 v117, v117
    v_exp_f32 v118, v118
    v_cvt_pk_bf16_f32 v50, v116, v117
    v_exp_f32 v119, v119
    s_nop 0
    v_cvt_pk_bf16_f32 v51, v118, v119
    s_waitcnt lgkmcnt(0)
    v_mfma_f32_32x32x16_bf16 v[104:119], v[20:23], v[232:235], v[56:71]
    ds_read_b128 v[20:23], v1 offset:57344
    v_mfma_f32_32x32x16_bf16 v[104:119], v[24:27], v[236:239], v[104:119]
    ds_read_b128 v[24:27], v1 offset:58368
    v_mfma_f32_32x32x16_bf16 v[72:87], v[28:31], v[44:47], v[72:87]
    ds_read_b128 v[28:31], v1 offset:51200
    v_smfmac_f32_16x16x64_bf16 v[52:55], v[10:13], v[44:51], v14
    v_mfma_f32_32x32x16_bf16 v[72:87], v[32:35], v[48:51], v[72:87]
    ds_read_b128 v[32:35], v1 offset:52224
    s_setprio 0
    v_exp_f32 v88, v88
    v_exp_f32 v89, v89
    v_exp_f32 v90, v90
    v_cvt_pk_bf16_f32 v36, v88, v89
    v_exp_f32 v91, v91
    s_setprio 1
    v_exp_f32 v92, v92
    v_cvt_pk_bf16_f32 v37, v90, v91
    v_exp_f32 v93, v93
    v_exp_f32 v94, v94
    v_cvt_pk_bf16_f32 v38, v92, v93
    v_exp_f32 v95, v95
    v_exp_f32 v96, v96
    v_cvt_pk_bf16_f32 v39, v94, v95
    v_exp_f32 v97, v97
    v_exp_f32 v98, v98
    v_cvt_pk_bf16_f32 v40, v96, v97
    v_exp_f32 v99, v99
    v_exp_f32 v100, v100
    v_cvt_pk_bf16_f32 v41, v98, v99
    v_exp_f32 v101, v101
    v_exp_f32 v102, v102
    v_cvt_pk_bf16_f32 v42, v100, v101
    v_exp_f32 v103, v103
    s_setprio 3
    v_cvt_pk_bf16_f32 v43, v102, v103
    s_cmp_eq_u32 s45, 0
    s_cselect_b32 s3, 4096, 0
    v_add_u32 v17, 98304, v4
    v_add_u32 v8, s3, v17
    v_bfe_u32 v5, v0, 2, 2
    v_lshlrev_b32 v5, 11, v5
    v_lshrrev_b32 v6, 4, v0
    v_lshl_add_u32 v5, v6, 6, v5
    v_and_b32 v6, 3, v0
    v_lshl_add_u32 v18, v6, 4, v5
    v_xor_b32 v19, 32, v18
    v_mov_b32 v15, s44
    s_waitcnt lgkmcnt(0)
    v_mfma_f32_32x32x16_bf16 v[88:103], v[20:23], v[232:235], v[56:71]
    ds_read_b128 v[20:23], v1 offset:61440
    v_mfma_f32_32x32x16_bf16 v[88:103], v[24:27], v[236:239], v[88:103]
    ds_read_b128 v[24:27], v1 offset:62464
    s_waitcnt vmcnt(0)
    v_mfma_f32_32x32x16_bf16 v[72:87], v[28:31], v[36:39], v[72:87]
    ds_read_b128 v[28:31], v1 offset:55296
    v_smfmac_f32_16x16x64_bf16 v[52:55], v[10:13], v[36:43], v14
    v_mfma_f32_32x32x16_bf16 v[72:87], v[32:35], v[40:43], v[72:87]
    ds_read_b128 v[32:35], v1 offset:56320
    s_cmp_lt_u32 s20, 4
    s_cbranch_scc1 mega_kernel_g_30
    s_barrier
mega_kernel_g_30:
    s_setprio 0
    v_exp_f32 v104, v104
    v_exp_f32 v105, v105
    v_exp_f32 v106, v106
    v_cvt_pk_bf16_f32 v44, v104, v105
    v_exp_f32 v107, v107
    s_setprio 1
    v_exp_f32 v108, v108
    v_cvt_pk_bf16_f32 v45, v106, v107
    v_exp_f32 v109, v109
    v_exp_f32 v110, v110
    v_cvt_pk_bf16_f32 v46, v108, v109
    v_exp_f32 v111, v111
    v_exp_f32 v112, v112
    v_cvt_pk_bf16_f32 v47, v110, v111
    v_exp_f32 v113, v113
    v_exp_f32 v114, v114
    v_cvt_pk_bf16_f32 v48, v112, v113
    v_exp_f32 v115, v115
    v_exp_f32 v116, v116
    v_cvt_pk_bf16_f32 v49, v114, v115
    v_exp_f32 v117, v117
    v_exp_f32 v118, v118
    v_cvt_pk_bf16_f32 v50, v116, v117
    v_exp_f32 v119, v119
    s_nop 0
    v_cvt_pk_bf16_f32 v51, v118, v119
    s_cmp_lt_u32 s20, 4
    s_cbranch_scc0 mega_kernel_g_31
    s_barrier
mega_kernel_g_31:
    s_waitcnt lgkmcnt(0)
    v_mfma_f32_32x32x16_bf16 v[104:119], v[20:23], v[232:235], v[56:71]
    ds_read_b128 v[20:23], v2 offset:0
    ds_read_b128 v[120:123], v8 offset:28672
    ds_read_b128 v[124:127], v8 offset:29696
    v_mfma_f32_32x32x16_bf16 v[104:119], v[24:27], v[236:239], v[104:119]
    ds_read_b128 v[24:27], v2 offset:1024
    v_mfma_f32_32x32x16_bf16 v[72:87], v[28:31], v[44:47], v[72:87]
    ds_read_b128 v[28:31], v1 offset:59392
    v_smfmac_f32_16x16x64_bf16 v[52:55], v[10:13], v[44:51], v14
    v_mfma_f32_32x32x16_bf16 v[72:87], v[32:35], v[48:51], v[72:87]
    ds_read_b128 v[32:35], v1 offset:60416
    s_setprio 0
    v_exp_f32 v88, v88
    v_exp_f32 v89, v89
    v_exp_f32 v90, v90
    v_cvt_pk_bf16_f32 v36, v88, v89
    v_exp_f32 v91, v91
    s_setprio 1
    v_exp_f32 v92, v92
    v_cvt_pk_bf16_f32 v37, v90, v91
    v_exp_f32 v93, v93
    v_exp_f32 v94, v94
    v_cvt_pk_bf16_f32 v38, v92, v93
    v_exp_f32 v95, v95
    v_exp_f32 v96, v96
    v_cvt_pk_bf16_f32 v39, v94, v95
    v_exp_f32 v97, v97
    v_exp_f32 v98, v98
    v_cvt_pk_bf16_f32 v40, v96, v97
    v_exp_f32 v99, v99
    v_exp_f32 v100, v100
    v_cvt_pk_bf16_f32 v41, v98, v99
    v_exp_f32 v101, v101
    v_exp_f32 v102, v102
    v_cvt_pk_bf16_f32 v42, v100, v101
    v_exp_f32 v103, v103
    s_nop 0
    v_cvt_pk_bf16_f32 v43, v102, v103
    s_waitcnt lgkmcnt(0)
    v_mfma_f32_32x32x16_bf16 v[88:103], v[20:23], v[232:235], v[56:71]
    ds_read_b128 v[20:23], v2 offset:4096
    v_mfma_f32_32x32x16_bf16 v[88:103], v[24:27], v[236:239], v[88:103]
    ds_read_b128 v[24:27], v2 offset:5120
    v_mfma_f32_32x32x16_bf16 v[188:203], v[120:123], v[240:243], 0
    ds_read_b128 v[120:123], v17 offset:32768
    v_mfma_f32_32x32x16_bf16 v[188:203], v[124:127], v[244:247], v[188:203]
    ds_read_b128 v[124:127], v17 offset:33792
    v_mfma_f32_32x32x16_bf16 v[72:87], v[28:31], v[36:39], v[72:87]
    ds_read_b128 v[28:31], v1 offset:63488
    v_smfmac_f32_16x16x64_bf16 v[52:55], v[10:13], v[36:43], v14
    v_mfma_f32_32x32x16_bf16 v[72:87], v[32:35], v[40:43], v[72:87]
    ds_read_b128 v[32:35], v1 offset:64512
    s_setprio 0
    v_exp_f32 v104, v104
    v_exp_f32 v105, v105
    v_exp_f32 v106, v106
    v_cvt_pk_bf16_f32 v44, v104, v105
    v_exp_f32 v107, v107
    s_setprio 1
    v_exp_f32 v108, v108
    v_cvt_pk_bf16_f32 v45, v106, v107
    v_exp_f32 v109, v109
    v_exp_f32 v110, v110
    v_cvt_pk_bf16_f32 v46, v108, v109
    v_exp_f32 v111, v111
    v_exp_f32 v112, v112
    v_cvt_pk_bf16_f32 v47, v110, v111
    v_exp_f32 v113, v113
    v_exp_f32 v114, v114
    v_cvt_pk_bf16_f32 v48, v112, v113
    v_exp_f32 v115, v115
    v_exp_f32 v116, v116
    v_cvt_pk_bf16_f32 v49, v114, v115
    v_exp_f32 v117, v117
    v_exp_f32 v118, v118
    v_cvt_pk_bf16_f32 v50, v116, v117
    v_exp_f32 v119, v119
    s_setprio 3
    v_cvt_pk_bf16_f32 v51, v118, v119
    s_cmp_eq_u32 s45, 0
    v_mov_b64 v[152:153], 0
    v_mov_b64 v[154:155], 0
    s_cbranch_scc1 mega_kernel_a_t0a
mega_kernel_a_t0a_ret:
    v_max3_f32 v5, v188, v189, v190
    v_max3_f32 v5, v5, v191, v192
    v_max3_f32 v5, v5, v193, v194
    v_max3_f32 v5, v5, v195, v196
    v_max3_f32 v5, v5, v197, v198
    v_max3_f32 v5, v5, v199, v200
    v_max3_f32 v5, v5, v201, v202
    v_max_f32 v5, v5, v203
    v_mov_b32 v9, v5
    s_nop 1
    v_permlane32_swap_b32 v5, v9
    s_nop 1
    v_max_f32 v5, v5, v9
    v_sub_f32 v156, 0xc2a00000, v5
    v_mov_b32 v157, v156
    v_add_f32 v188, v188, v156
    v_add_f32 v189, v189, v156
    v_add_f32 v190, v190, v156
    v_add_f32 v191, v191, v156
    v_add_f32 v192, v192, v156
    v_add_f32 v193, v193, v156
    v_add_f32 v194, v194, v156
    v_add_f32 v195, v195, v156
    v_add_f32 v196, v196, v156
    v_add_f32 v197, v197, v156
    v_add_f32 v198, v198, v156
    v_add_f32 v199, v199, v156
    v_add_f32 v200, v200, v156
    v_add_f32 v201, v201, v156
    v_add_f32 v202, v202, v156
    v_add_f32 v203, v203, v156
    v_mov_b32 v158, v156
    v_mov_b32 v159, v156
    v_mov_b32 v160, v156
    v_mov_b32 v161, v156
    v_mov_b32 v162, v156
    v_mov_b32 v163, v156
    v_mov_b32 v164, v156
    v_mov_b32 v165, v156
    v_mov_b32 v166, v156
    v_mov_b32 v167, v156
    v_mov_b32 v168, v156
    v_mov_b32 v169, v156
    v_mov_b32 v170, v156
    v_mov_b32 v171, v156
    s_cbranch_scc1 mega_kernel_a_t0b
mega_kernel_a_t0b_ret:
    v_cndmask_b32 v204, v15, v156, s[48:49]
    v_cndmask_b32 v205, v15, v157, s[50:51]
    v_cndmask_b32 v206, v15, v158, s[52:53]
    v_cndmask_b32 v207, v15, v159, s[54:55]
    v_cndmask_b32 v208, v15, v160, s[56:57]
    v_cndmask_b32 v209, v15, v161, s[58:59]
    v_cndmask_b32 v210, v15, v162, s[60:61]
    v_cndmask_b32 v211, v15, v163, s[62:63]
    v_cndmask_b32 v212, v15, v164, s[64:65]
    v_cndmask_b32 v213, v15, v165, s[66:67]
    v_cndmask_b32 v214, v15, v166, s[68:69]
    v_cndmask_b32 v215, v15, v167, s[70:71]
    v_cndmask_b32 v216, v15, v168, s[72:73]
    v_cndmask_b32 v217, v15, v169, s[74:75]
    v_cndmask_b32 v218, v15, v170, s[76:77]
    v_cndmask_b32 v219, v15, v171, s[78:79]
    s_cmp_eq_u32 s28, 7
    s_cbranch_scc1 mega_kernel_blk_a
mega_kernel_blk_b:
    v_add_f32 v5, v52, v53
    v_cmp_lt_f32 vcc, s43, v5
    s_waitcnt lgkmcnt(0)
    v_mfma_f32_32x32x16_bf16 v[72:87], v[28:31], v[44:47], v[72:87]
    ds_read_b128 v[28:31], v2 offset:2048
    v_smfmac_f32_16x16x64_bf16 v[52:55], v[10:13], v[44:51], v14
    v_mfma_f32_32x32x16_bf16 v[72:87], v[32:35], v[48:51], v[72:87]
    ds_read_b128 v[32:35], v2 offset:3072
    s_cbranch_vccnz mega_kernel_rr_32c
mega_kernel_rr_32:
    v_mfma_f32_32x32x16_bf16 v[104:119], v[20:23], v[232:235], v[56:71]
    ds_read_b128 v[20:23], v2 offset:8192
    v_mfma_f32_32x32x16_bf16 v[104:119], v[24:27], v[236:239], v[104:119]
    ds_read_b128 v[24:27], v2 offset:9216
    s_cmp_eq_u32 s28, 7
    s_cbranch_scc0 mega_kernel_g_33
    v_mfma_f32_32x32x16_bf16 v[172:187], v[128:131], v[136:139], v[172:187]
    v_smfmac_f32_16x16x64_bf16 v[152:155], v[10:13], v[136:143], v14
    v_mfma_f32_32x32x16_bf16 v[172:187], v[132:135], v[140:143], v[172:187]
mega_kernel_g_33:
    s_setprio 0
    v_exp_f32 v88, v88
    v_exp_f32 v89, v89
    v_exp_f32 v90, v90
    v_cvt_pk_bf16_f32 v36, v88, v89
    v_exp_f32 v91, v91
    s_setprio 1
    v_exp_f32 v92, v92
    v_cvt_pk_bf16_f32 v37, v90, v91
    v_exp_f32 v93, v93
    v_exp_f32 v94, v94
    v_cvt_pk_bf16_f32 v38, v92, v93
    v_exp_f32 v95, v95
    v_exp_f32 v96, v96
    v_cvt_pk_bf16_f32 v39, v94, v95
    v_exp_f32 v97, v97
    v_exp_f32 v98, v98
    v_cvt_pk_bf16_f32 v40, v96, v97
    v_exp_f32 v99, v99
    v_exp_f32 v100, v100
    v_cvt_pk_bf16_f32 v41, v98, v99
    v_exp_f32 v101, v101
    v_exp_f32 v102, v102
    v_cvt_pk_bf16_f32 v42, v100, v101
    v_exp_f32 v103, v103
    s_setprio 3
    v_cvt_pk_bf16_f32 v43, v102, v103
    s_cmp_eq_u32 s28, 7
    s_cbranch_scc0 mega_kernel_g_34
    s_sub_u32 s7, s32, 4194304
    v_add_f32 v7, v152, v153
    v_maximum3_f32 v6, abs(v172), abs(v173), abs(v174)
    v_maximum3_f32 v5, abs(v175), abs(v176), abs(v177)
    v_maximum3_f32 v6, v6, abs(v178), abs(v179)
    v_maximum3_f32 v5, v5, abs(v180), abs(v181)
    v_maximum3_f32 v6, v6, abs(v182), abs(v183)
    v_maximum3_f32 v5, v5, abs(v184), abs(v185)
    v_maximum3_f32 v6, v6, abs(v186), abs(v187)
    v_maximum3_f32 v6, v6, v5, v5
    v_maximum3_f32 v5, v6, v7, v7
    s_mov_b32 s3, 0xd800000
    v_cmp_gt_f32 s[4:5], s3, v6
    v_cmp_ngt_f32 vcc, 0x7b800000, v5
    s_or_b64 vcc, vcc, s[4:5]
    s_cbranch_vccnz mega_kernel_fin_35s
mega_kernel_fin_35:
    v_rcp_f32 v6, v7
    s_nop 0
    v_mul_f32 v172, v172, v6
    v_mul_f32 v173, v173, v6
    v_mul_f32 v174, v174, v6
    v_mul_f32 v175, v175, v6
    v_mul_f32 v176, v176, v6
    v_mul_f32 v177, v177, v6
    v_mul_f32 v178, v178, v6
    v_mul_f32 v179, v179, v6
    v_mul_f32 v180, v180, v6
    v_mul_f32 v181, v181, v6
    v_mul_f32 v182, v182, v6
    v_mul_f32 v183, v183, v6
    v_mul_f32 v184, v184, v6
    v_mul_f32 v185, v185, v6
    v_mul_f32 v186, v186, v6
    v_mul_f32 v187, v187, v6
    v_cvt_pk_bf16_f32 v136, v172, v173
    v_cvt_pk_bf16_f32 v137, v174, v175
    v_cvt_pk_bf16_f32 v138, v176, v177
    v_cvt_pk_bf16_f32 v139, v178, v179
    v_cvt_pk_bf16_f32 v140, v180, v181
    v_cvt_pk_bf16_f32 v141, v182, v183
    v_cvt_pk_bf16_f32 v142, v184, v185
    v_cvt_pk_bf16_f32 v143, v186, v187
    buffer_store_dwordx4 v[136:139], v1, s[16:19], s7 offen sc1
    buffer_store_dwordx4 v[140:143], v1, s[16:19], s7 offen offset:1024 sc1
mega_kernel_g_34:
    s_waitcnt lgkmcnt(0)
    v_mfma_f32_32x32x16_bf16 v[88:103], v[20:23], v[232:235], v[56:71]
    ds_read_b128 v[20:23], v2 offset:12288
    v_mfma_f32_32x32x16_bf16 v[88:103], v[24:27], v[236:239], v[88:103]
    ds_read_b128 v[24:27], v2 offset:13312
    v_mfma_f32_32x32x16_bf16 v[72:87], v[28:31], v[36:39], v[72:87]
    ds_read_b128 v[28:31], v2 offset:6144
    v_smfmac_f32_16x16x64_bf16 v[52:55], v[10:13], v[36:43], v14
    v_mfma_f32_32x32x16_bf16 v[72:87], v[32:35], v[40:43], v[72:87]
    ds_read_b128 v[32:35], v2 offset:7168
    s_setprio 0
    v_exp_f32 v104, v104
    v_exp_f32 v105, v105
    v_exp_f32 v106, v106
    v_cvt_pk_bf16_f32 v44, v104, v105
    v_exp_f32 v107, v107
    s_setprio 1
    v_exp_f32 v108, v108
    v_cvt_pk_bf16_f32 v45, v106, v107
    v_exp_f32 v109, v109
    v_exp_f32 v110, v110
    v_cvt_pk_bf16_f32 v46, v108, v109
    v_exp_f32 v111, v111
    v_exp_f32 v112, v112
    v_cvt_pk_bf16_f32 v47, v110, v111
    v_exp_f32 v113, v113
    v_exp_f32 v114, v114
    v_cvt_pk_bf16_f32 v48, v112, v113
    v_exp_f32 v115, v115
    v_exp_f32 v116, v116
    v_cvt_pk_bf16_f32 v49, v114, v115
    v_exp_f32 v117, v117
    v_exp_f32 v118, v118
    v_cvt_pk_bf16_f32 v50, v116, v117
    v_exp_f32 v119, v119
    s_nop 0
    v_cvt_pk_bf16_f32 v51, v118, v119
    s_waitcnt lgkmcnt(0)
    v_mfma_f32_32x32x16_bf16 v[104:119], v[20:23], v[232:235], v[56:71]
    ds_read_b128 v[20:23], v2 offset:16384
    v_mfma_f32_32x32x16_bf16 v[104:119], v[24:27], v[236:239], v[104:119]
    ds_read_b128 v[24:27], v2 offset:17408
    s_waitcnt vmcnt(0)
    s_mov_b64 exec, 1
    buffer_store_dword v251, v248, s[16:19], s35 offen sc1
    s_mov_b64 exec, -1
    v_mfma_f32_32x32x16_bf16 v[72:87], v[28:31], v[44:47], v[72:87]
    ds_read_b128 v[28:31], v2 offset:10240
    v_smfmac_f32_16x16x64_bf16 v[52:55], v[10:13], v[44:51], v14
    v_mfma_f32_32x32x16_bf16 v[72:87], v[32:35], v[48:51], v[72:87]
    ds_read_b128 v[32:35], v2 offset:11264
    s_cmp_eq_u32 s39, 1
    s_cbranch_scc0 mega_kernel_g_36
    s_barrier
mega_kernel_g_36:
    s_setprio 0
    v_exp_f32 v88, v88
    v_exp_f32 v89, v89
    v_exp_f32 v90, v90
    v_cvt_pk_bf16_f32 v36, v88, v89
    v_exp_f32 v91, v91
    s_setprio 1
    v_exp_f32 v92, v92
    v_cvt_pk_bf16_f32 v37, v90, v91
    v_exp_f32 v93, v93
    v_exp_f32 v94, v94
    v_cvt_pk_bf16_f32 v38, v92, v93
    v_exp_f32 v95, v95
    v_exp_f32 v96, v96
    v_cvt_pk_bf16_f32 v39, v94, v95
    v_exp_f32 v97, v97
    v_exp_f32 v98, v98
    v_cvt_pk_bf16_f32 v40, v96, v97
    v_exp_f32 v99, v99
    v_exp_f32 v100, v100
    v_cvt_pk_bf16_f32 v41, v98, v99
    v_exp_f32 v101, v101
    v_exp_f32 v102, v102
    v_cvt_pk_bf16_f32 v42, v100, v101
    v_exp_f32 v103, v103
    s_nop 0
    v_cvt_pk_bf16_f32 v43, v102, v103
    s_cmp_eq_u32 s39, 2
    s_cbranch_scc0 mega_kernel_g_37
    s_barrier
mega_kernel_g_37:
    s_waitcnt lgkmcnt(0)
    v_mfma_f32_32x32x16_bf16 v[88:103], v[20:23], v[232:235], v[56:71]
    ds_read_b128 v[20:23], v2 offset:20480
    s_add_u32 m0, s38, 0
    s_add_u32 s3, s37, 0
    buffer_load_dwordx4 v18, s[12:15], s3 offen lds
    v_mfma_f32_32x32x16_bf16 v[88:103], v[24:27], v[236:239], v[88:103]
    ds_read_b128 v[24:27], v2 offset:21504
    v_mfma_f32_32x32x16_bf16 v[72:87], v[28:31], v[36:39], v[72:87]
    ds_read_b128 v[28:31], v2 offset:14336
    v_smfmac_f32_16x16x64_bf16 v[52:55], v[10:13], v[36:43], v14
    v_mfma_f32_32x32x16_bf16 v[72:87], v[32:35], v[40:43], v[72:87]
    ds_read_b128 v[32:35], v2 offset:15360
    s_setprio 0
    v_exp_f32 v104, v104
    v_exp_f32 v105, v105
    v_exp_f32 v106, v106
    v_cvt_pk_bf16_f32 v44, v104, v105
    v_exp_f32 v107, v107
    s_setprio 1
    v_exp_f32 v108, v108
    v_cvt_pk_bf16_f32 v45, v106, v107
    v_exp_f32 v109, v109
    v_exp_f32 v110, v110
    v_cvt_pk_bf16_f32 v46, v108, v109
    v_exp_f32 v111, v111
    v_exp_f32 v112, v112
    v_cvt_pk_bf16_f32 v47, v110, v111
    v_exp_f32 v113, v113
    v_exp_f32 v114, v114
    v_cvt_pk_bf16_f32 v48, v112, v113
    v_exp_f32 v115, v115
    v_exp_f32 v116, v116
    v_cvt_pk_bf16_f32 v49, v114, v115
    v_exp_f32 v117, v117
    v_exp_f32 v118, v118
    v_cvt_pk_bf16_f32 v50, v116, v117
    v_exp_f32 v119, v119
    s_nop 0
    v_cvt_pk_bf16_f32 v51, v118, v119
    s_waitcnt lgkmcnt(0)
    v_mfma_f32_32x32x16_bf16 v[104:119], v[20:23], v[232:235], v[56:71]
    ds_read_b128 v[20:23], v2 offset:24576
    s_add_u32 m0, s38, 1024
    s_add_u32 s3, s37, 8192
    buffer_load_dwordx4 v19, s[12:15], s3 offen lds
    v_mfma_f32_32x32x16_bf16 v[104:119], v[24:27], v[236:239], v[104:119]
    ds_read_b128 v[24:27], v2 offset:25600
    v_mfma_f32_32x32x16_bf16 v[72:87], v[28:31], v[44:47], v[72:87]
    ds_read_b128 v[28:31], v2 offset:18432
    v_smfmac_f32_16x16x64_bf16 v[52:55], v[10:13], v[44:51], v14
    v_mfma_f32_32x32x16_bf16 v[72:87], v[32:35], v[48:51], v[72:87]
    ds_read_b128 v[32:35], v2 offset:19456
    s_setprio 0
    v_exp_f32 v88, v88
    v_exp_f32 v89, v89
    v_exp_f32 v90, v90
    v_cvt_pk_bf16_f32 v36, v88, v89
    v_exp_f32 v91, v91
    s_setprio 1
    v_exp_f32 v92, v92
    v_cvt_pk_bf16_f32 v37, v90, v91
    v_exp_f32 v93, v93
    v_exp_f32 v94, v94
    v_cvt_pk_bf16_f32 v38, v92, v93
    v_exp_f32 v95, v95
    v_exp_f32 v96, v96
    v_cvt_pk_bf16_f32 v39, v94, v95
    v_exp_f32 v97, v97
    v_exp_f32 v98, v98
    v_cvt_pk_bf16_f32 v40, v96, v97
    v_exp_f32 v99, v99
    v_exp_f32 v100, v100
    v_cvt_pk_bf16_f32 v41, v98, v99
    v_exp_f32 v101, v101
    v_exp_f32 v102, v102
    v_cvt_pk_bf16_f32 v42, v100, v101
    v_exp_f32 v103, v103
    s_nop 0
    v_cvt_pk_bf16_f32 v43, v102, v103
    s_waitcnt lgkmcnt(0)
    v_mfma_f32_32x32x16_bf16 v[88:103], v[20:23], v[232:235], v[56:71]
    ds_read_b128 v[20:23], v2 offset:28672
    s_add_u32 m0, s38, 2048
    s_add_u32 s3, s37, 16384
    buffer_load_dwordx4 v18, s[12:15], s3 offen lds
    v_mfma_f32_32x32x16_bf16 v[88:103], v[24:27], v[236:239], v[88:103]
    ds_read_b128 v[24:27], v2 offset:29696
    v_mfma_f32_32x32x16_bf16 v[72:87], v[28:31], v[36:39], v[72:87]
    ds_read_b128 v[28:31], v2 offset:22528
    v_smfmac_f32_16x16x64_bf16 v[52:55], v[10:13], v[36:43], v14
    v_mfma_f32_32x32x16_bf16 v[72:87], v[32:35], v[40:43], v[72:87]
    ds_read_b128 v[32:35], v2 offset:23552
    s_setprio 0
    v_exp_f32 v104, v104
    v_exp_f32 v105, v105
    v_exp_f32 v106, v106
    v_cvt_pk_bf16_f32 v44, v104, v105
    v_exp_f32 v107, v107
    s_setprio 1
    v_exp_f32 v108, v108
    v_cvt_pk_bf16_f32 v45, v106, v107
    v_exp_f32 v109, v109
    v_exp_f32 v110, v110
    v_cvt_pk_bf16_f32 v46, v108, v109
    v_exp_f32 v111, v111
    v_exp_f32 v112, v112
    v_cvt_pk_bf16_f32 v47, v110, v111
    v_exp_f32 v113, v113
    v_exp_f32 v114, v114
    v_cvt_pk_bf16_f32 v48, v112, v113
    v_exp_f32 v115, v115
    v_exp_f32 v116, v116
    v_cvt_pk_bf16_f32 v49, v114, v115
    v_exp_f32 v117, v117
    v_exp_f32 v118, v118
    v_cvt_pk_bf16_f32 v50, v116, v117
    v_exp_f32 v119, v119
    s_nop 0
    v_cvt_pk_bf16_f32 v51, v118, v119
    s_waitcnt lgkmcnt(0)
    v_mfma_f32_32x32x16_bf16 v[104:119], v[20:23], v[232:235], v[56:71]
    s_add_u32 m0, s38, 3072
    s_add_u32 s3, s37, 24576
    buffer_load_dwordx4 v19, s[12:15], s3 offen lds
    s_add_u32 s38, s38, 32768
    s_add_u32 s37, s37, 262144
    v_mfma_f32_32x32x16_bf16 v[104:119], v[24:27], v[236:239], v[104:119]
    buffer_load_dwordx2 v[254:255], v249, s[16:19], s29 offen sc1
    v_mfma_f32_32x32x16_bf16 v[72:87], v[28:31], v[44:47], v[72:87]
    ds_read_b128 v[28:31], v2 offset:26624
    v_smfmac_f32_16x16x64_bf16 v[52:55], v[10:13], v[44:51], v14
    v_mfma_f32_32x32x16_bf16 v[72:87], v[32:35], v[48:51], v[72:87]
    ds_read_b128 v[32:35], v2 offset:27648
    s_setprio 0
    v_exp_f32 v88, v88
    v_exp_f32 v89, v89
    v_exp_f32 v90, v90
    v_cvt_pk_bf16_f32 v36, v88, v89
    v_exp_f32 v91, v91
    s_setprio 1
    v_exp_f32 v92, v92
    v_cvt_pk_bf16_f32 v37, v90, v91
    v_exp_f32 v93, v93
    v_exp_f32 v94, v94
    v_cvt_pk_bf16_f32 v38, v92, v93
    v_exp_f32 v95, v95
    v_exp_f32 v96, v96
    v_cvt_pk_bf16_f32 v39, v94, v95
    v_exp_f32 v97, v97
    v_exp_f32 v98, v98
    v_cvt_pk_bf16_f32 v40, v96, v97
    v_exp_f32 v99, v99
    v_exp_f32 v100, v100
    v_cvt_pk_bf16_f32 v41, v98, v99
    v_exp_f32 v101, v101
    v_exp_f32 v102, v102
    v_cvt_pk_bf16_f32 v42, v100, v101
    v_exp_f32 v103, v103
    s_nop 0
    v_cvt_pk_bf16_f32 v43, v102, v103
    s_nop 0
    s_waitcnt lgkmcnt(0)
    v_mfma_f32_32x32x16_bf16 v[72:87], v[28:31], v[36:39], v[72:87]
    ds_read_b128 v[28:31], v2 offset:30720
    v_smfmac_f32_16x16x64_bf16 v[52:55], v[10:13], v[36:43], v14
    v_mfma_f32_32x32x16_bf16 v[72:87], v[32:35], v[40:43], v[72:87]
    ds_read_b128 v[32:35], v2 offset:31744
    s_setprio 0
    v_exp_f32 v104, v104
    v_exp_f32 v105, v105
    v_exp_f32 v106, v106
    v_cvt_pk_bf16_f32 v44, v104, v105
    v_exp_f32 v107, v107
    s_setprio 1
    v_exp_f32 v108, v108
    v_cvt_pk_bf16_f32 v45, v106, v107
    v_exp_f32 v109, v109
    v_exp_f32 v110, v110
    v_cvt_pk_bf16_f32 v46, v108, v109
    v_exp_f32 v111, v111
    v_exp_f32 v112, v112
    v_cvt_pk_bf16_f32 v47, v110, v111
    v_exp_f32 v113, v113
    v_exp_f32 v114, v114
    v_cvt_pk_bf16_f32 v48, v112, v113
    v_exp_f32 v115, v115
    v_exp_f32 v116, v116
    v_cvt_pk_bf16_f32 v49, v114, v115
    v_exp_f32 v117, v117
    v_exp_f32 v118, v118
    v_cvt_pk_bf16_f32 v50, v116, v117
    v_exp_f32 v119, v119
    s_nop 0
    v_cvt_pk_bf16_f32 v51, v118, v119
    s_cmp_eq_u32 s28, 7
    s_cbranch_scc1 mega_kernel_end_b
mega_kernel_blk_a:
    s_nop 0
    s_waitcnt lgkmcnt(0)
    v_mfma_f32_32x32x16_bf16 v[204:219], v[120:123], v[240:243], v[204:219]
    ds_read_b128 v[120:123], v17 offset:24576
    v_mfma_f32_32x32x16_bf16 v[204:219], v[124:127], v[244:247], v[204:219]
    ds_read_b128 v[124:127], v17 offset:25600
    s_cmp_eq_u32 s28, 7
    s_cbranch_scc1 mega_kernel_g_38
    v_mfma_f32_32x32x16_bf16 v[72:87], v[28:31], v[44:47], v[72:87]
    v_smfmac_f32_16x16x64_bf16 v[52:55], v[10:13], v[44:51], v14
    v_mfma_f32_32x32x16_bf16 v[72:87], v[32:35], v[48:51], v[72:87]
mega_kernel_g_38:
    ds_read_b128 v[128:131], v17 offset:30720
    ds_read_b128 v[132:135], v17 offset:31744
    s_setprio 0
    v_exp_f32 v188, v188
    v_exp_f32 v189, v189
    v_exp_f32 v190, v190
    v_cvt_pk_bf16_f32 v136, v188, v189
    v_exp_f32 v191, v191
    s_setprio 1
    v_exp_f32 v192, v192
    v_cvt_pk_bf16_f32 v137, v190, v191
    v_exp_f32 v193, v193
    v_exp_f32 v194, v194
    v_cvt_pk_bf16_f32 v138, v192, v193
    v_exp_f32 v195, v195
    v_exp_f32 v196, v196
    v_cvt_pk_bf16_f32 v139, v194, v195
    v_exp_f32 v197, v197
    v_exp_f32 v198, v198
    v_cvt_pk_bf16_f32 v140, v196, v197
    v_exp_f32 v199, v199
    v_exp_f32 v200, v200
    v_cvt_pk_bf16_f32 v141, v198, v199
    v_exp_f32 v201, v201
    v_exp_f32 v202, v202
    v_cvt_pk_bf16_f32 v142, v200, v201
    v_exp_f32 v203, v203
    s_setprio 3
    v_cvt_pk_bf16_f32 v143, v202, v203
    s_cmp_eq_u32 s28, 7
    s_cbranch_scc1 mega_kernel_g_39
    s_sub_u32 s7, s32, 0
    v_add_f32 v7, v52, v53
    v_maximum3_f32 v6, abs(v72), abs(v73), abs(v74)
    v_maximum3_f32 v5, abs(v75), abs(v76), abs(v77)
    v_maximum3_f32 v6, v6, abs(v78), abs(v79)
    v_maximum3_f32 v5, v5, abs(v80), abs(v81)
    v_maximum3_f32 v6, v6, abs(v82), abs(v83)
    v_maximum3_f32 v5, v5, abs(v84), abs(v85)
    v_maximum3_f32 v6, v6, abs(v86), abs(v87)
    v_maximum3_f32 v6, v6, v5, v5
    v_maximum3_f32 v5, v6, v7, v7
    s_mov_b32 s3, 0xd800000
    v_cmp_gt_f32 s[4:5], s3, v6
    v_cmp_ngt_f32 vcc, 0x7b800000, v5
    s_or_b64 vcc, vcc, s[4:5]
    s_cbranch_vccnz mega_kernel_fin_40s
mega_kernel_fin_40:
    v_rcp_f32 v6, v7
    s_nop 0
    v_mul_f32 v72, v72, v6
    v_mul_f32 v73, v73, v6
    v_mul_f32 v74, v74, v6
    v_mul_f32 v75, v75, v6
    v_mul_f32 v76, v76, v6
    v_mul_f32 v77, v77, v6
    v_mul_f32 v78, v78, v6
    v_mul_f32 v79, v79, v6
    v_mul_f32 v80, v80, v6
    v_mul_f32 v81, v81, v6
    v_mul_f32 v82, v82, v6
    v_mul_f32 v83, v83, v6
    v_mul_f32 v84, v84, v6
    v_mul_f32 v85, v85, v6
    v_mul_f32 v86, v86, v6
    v_mul_f32 v87, v87, v6
    v_cvt_pk_bf16_f32 v36, v72, v73
    v_cvt_pk_bf16_f32 v37, v74, v75
    v_cvt_pk_bf16_f32 v38, v76, v77
    v_cvt_pk_bf16_f32 v39, v78, v79
    v_cvt_pk_bf16_f32 v40, v80, v81
    v_cvt_pk_bf16_f32 v41, v82, v83
    v_cvt_pk_bf16_f32 v42, v84, v85
    v_cvt_pk_bf16_f32 v43, v86, v87
    buffer_store_dwordx4 v[36:39], v1, s[16:19], s7 offen sc1
    buffer_store_dwordx4 v[40:43], v1, s[16:19], s7 offen offset:1024 sc1
mega_kernel_g_39:
    s_cmp_lt_u32 s45, 2
    s_cbranch_scc1 mega_kernel_sk_41n
mega_kernel_sk_41:
    s_waitcnt lgkmcnt(0)
    v_mfma_f32_32x32x16_bf16 v[188:203], v[120:123], v[240:243], v[156:171]
    ds_read_b128 v[120:123], v17 offset:20480
    v_mfma_f32_32x32x16_bf16 v[188:203], v[124:127], v[244:247], v[188:203]
    ds_read_b128 v[124:127], v17 offset:21504
    v_mfma_f32_32x32x16_bf16 v[172:187], v[128:131], v[136:139], 0
    ds_read_b128 v[128:131], v17 offset:34816
    v_smfmac_f32_16x16x64_bf16 v[152:155], v[10:13], v[136:143], v14
    v_mfma_f32_32x32x16_bf16 v[172:187], v[132:135], v[140:143], v[172:187]
    ds_read_b128 v[132:135], v17 offset:35840
    s_setprio 0
    v_exp_f32 v204, v204
    v_exp_f32 v205, v205
    v_exp_f32 v206, v206
    v_cvt_pk_bf16_f32 v144, v204, v205
    v_exp_f32 v207, v207
    s_setprio 1
    v_exp_f32 v208, v208
    v_cvt_pk_bf16_f32 v145, v206, v207
    v_exp_f32 v209, v209
    v_exp_f32 v210, v210
    v_cvt_pk_bf16_f32 v146, v208, v209
    v_exp_f32 v211, v211
    v_exp_f32 v212, v212
    v_cvt_pk_bf16_f32 v147, v210, v211
    v_exp_f32 v213, v213
    v_exp_f32 v214, v214
    v_cvt_pk_bf16_f32 v148, v212, v213
    v_exp_f32 v215, v215
    v_exp_f32 v216, v216
    v_cvt_pk_bf16_f32 v149, v214, v215
    v_exp_f32 v217, v217
    v_exp_f32 v218, v218
    v_cvt_pk_bf16_f32 v150, v216, v217
    v_exp_f32 v219, v219
    s_nop 0
    v_cvt_pk_bf16_f32 v151, v218, v219
    s_cmp_lt_u32 s45, 3
    s_cbranch_scc1 mega_kernel_sk_42n
mega_kernel_sk_42:
    s_waitcnt lgkmcnt(0)
    v_mfma_f32_32x32x16_bf16 v[204:219], v[120:123], v[240:243], v[156:171]
    ds_read_b128 v[120:123], v17 offset:16384
    v_mfma_f32_32x32x16_bf16 v[204:219], v[124:127], v[244:247], v[204:219]
    ds_read_b128 v[124:127], v17 offset:17408
    s_waitcnt vmcnt(0)
    s_mov_b64 exec, 1
    buffer_store_dword v251, v248, s[16:19], s34 offen sc1
    s_mov_b64 exec, -1
    v_mfma_f32_32x32x16_bf16 v[172:187], v[128:131], v[144:147], v[172:187]
    ds_read_b128 v[128:131], v17 offset:26624
    v_smfmac_f32_16x16x64_bf16 v[152:155], v[10:13], v[144:151], v14
    v_mfma_f32_32x32x16_bf16 v[172:187], v[132:135], v[148:151], v[172:187]
    ds_read_b128 v[132:135], v17 offset:27648
    s_cmp_eq_u32 s27, 1
    s_cbranch_scc0 mega_kernel_g_43
    s_barrier
mega_kernel_g_43:
    s_setprio 0
    v_exp_f32 v188, v188
    v_exp_f32 v189, v189
    v_exp_f32 v190, v190
    v_cvt_pk_bf16_f32 v136, v188, v189
    v_exp_f32 v191, v191
    s_setprio 1
    v_exp_f32 v192, v192
    v_cvt_pk_bf16_f32 v137, v190, v191
    v_exp_f32 v193, v193
    v_exp_f32 v194, v194
    v_cvt_pk_bf16_f32 v138, v192, v193
    v_exp_f32 v195, v195
    v_exp_f32 v196, v196
    v_cvt_pk_bf16_f32 v139, v194, v195
    v_exp_f32 v197, v197
    v_exp_f32 v198, v198
    v_cvt_pk_bf16_f32 v140, v196, v197
    v_exp_f32 v199, v199
    v_exp_f32 v200, v200
    v_cvt_pk_bf16_f32 v141, v198, v199
    v_exp_f32 v201, v201
    v_exp_f32 v202, v202
    v_cvt_pk_bf16_f32 v142, v200, v201
    v_exp_f32 v203, v203
    s_nop 0
    v_cvt_pk_bf16_f32 v143, v202, v203
    s_cmp_eq_u32 s27, 2
    s_cbranch_scc0 mega_kernel_g_44
    s_barrier
mega_kernel_g_44:
    s_cmp_lt_u32 s45, 4
    s_cbranch_scc1 mega_kernel_sk_45n
mega_kernel_sk_45:
    s_waitcnt lgkmcnt(0)
    v_mfma_f32_32x32x16_bf16 v[188:203], v[120:123], v[240:243], v[156:171]
    ds_read_b128 v[120:123], v17 offset:12288
    s_add_u32 m0, s38, 0
    s_add_u32 s3, s37, 0
    buffer_load_dwordx4 v18, s[12:15], s3 offen lds
    v_mfma_f32_32x32x16_bf16 v[188:203], v[124:127], v[244:247], v[188:203]
    ds_read_b128 v[124:127], v17 offset:13312
    v_mfma_f32_32x32x16_bf16 v[172:187], v[128:131], v[136:139], v[172:187]
    ds_read_b128 v[128:131], v17 offset:22528
    v_smfmac_f32_16x16x64_bf16 v[152:155], v[10:13], v[136:143], v14
    v_mfma_f32_32x32x16_bf16 v[172:187], v[132:135], v[140:143], v[172:187]
    ds_read_b128 v[132:135], v17 offset:23552
    s_setprio 0
    v_exp_f32 v204, v204
    v_exp_f32 v205, v205
    v_exp_f32 v206, v206
    v_cvt_pk_bf16_f32 v144, v204, v205
    v_exp_f32 v207, v207
    s_setprio 1
    v_exp_f32 v208, v208
    v_cvt_pk_bf16_f32 v145, v206, v207
    v_exp_f32 v209, v209
    v_exp_f32 v210, v210
    v_cvt_pk_bf16_f32 v146, v208, v209
    v_exp_f32 v211, v211
    v_exp_f32 v212, v212
    v_cvt_pk_bf16_f32 v147, v210, v211
    v_exp_f32 v213, v213
    v_exp_f32 v214, v214
    v_cvt_pk_bf16_f32 v148, v212, v213
    v_exp_f32 v215, v215
    v_exp_f32 v216, v216
    v_cvt_pk_bf16_f32 v149, v214, v215
    v_exp_f32 v217, v217
    v_exp_f32 v218, v218
    v_cvt_pk_bf16_f32 v150, v216, v217
    v_exp_f32 v219, v219
    s_nop 0
    v_cvt_pk_bf16_f32 v151, v218, v219
    s_cmp_lt_u32 s45, 5
    s_cbranch_scc1 mega_kernel_sk_46n
mega_kernel_sk_46:
    s_waitcnt lgkmcnt(0)
    v_mfma_f32_32x32x16_bf16 v[204:219], v[120:123], v[240:243], v[156:171]
    ds_read_b128 v[120:123], v17 offset:8192
    s_add_u32 m0, s38, 1024
    s_add_u32 s3, s37, 8192
    buffer_load_dwordx4 v19, s[12:15], s3 offen lds
    v_mfma_f32_32x32x16_bf16 v[204:219], v[124:127], v[244:247], v[204:219]
    ds_read_b128 v[124:127], v17 offset:9216
    v_mfma_f32_32x32x16_bf16 v[172:187], v[128:131], v[144:147], v[172:187]
    ds_read_b128 v[128:131], v17 offset:18432
    v_smfmac_f32_16x16x64_bf16 v[152:155], v[10:13], v[144:151], v14
    v_mfma_f32_32x32x16_bf16 v[172:187], v[132:135], v[148:151], v[172:187]
    ds_read_b128 v[132:135], v17 offset:19456
    s_setprio 0
    v_exp_f32 v188, v188
    v_exp_f32 v189, v189
    v_exp_f32 v190, v190
    v_cvt_pk_bf16_f32 v136, v188, v189
    v_exp_f32 v191, v191
    s_setprio 1
    v_exp_f32 v192, v192
    v_cvt_pk_bf16_f32 v137, v190, v191
    v_exp_f32 v193, v193
    v_exp_f32 v194, v194
    v_cvt_pk_bf16_f32 v138, v192, v193
    v_exp_f32 v195, v195
    v_exp_f32 v196, v196
    v_cvt_pk_bf16_f32 v139, v194, v195
    v_exp_f32 v197, v197
    v_exp_f32 v198, v198
    v_cvt_pk_bf16_f32 v140, v196, v197
    v_exp_f32 v199, v199
    v_exp_f32 v200, v200
    v_cvt_pk_bf16_f32 v141, v198, v199
    v_exp_f32 v201, v201
    v_exp_f32 v202, v202
    v_cvt_pk_bf16_f32 v142, v200, v201
    v_exp_f32 v203, v203
    s_nop 0
    v_cvt_pk_bf16_f32 v143, v202, v203
    s_cmp_lt_u32 s45, 6
    s_cbranch_scc1 mega_kernel_sk_47n
mega_kernel_sk_47:
    s_waitcnt lgkmcnt(0)
    v_mfma_f32_32x32x16_bf16 v[188:203], v[120:123], v[240:243], v[156:171]
    ds_read_b128 v[120:123], v17 offset:4096
    s_add_u32 m0, s38, 2048
    s_add_u32 s3, s37, 16384
    buffer_load_dwordx4 v18, s[12:15], s3 offen lds
    v_mfma_f32_32x32x16_bf16 v[188:203], v[124:127], v[244:247], v[188:203]
    ds_read_b128 v[124:127], v17 offset:5120
    v_mfma_f32_32x32x16_bf16 v[172:187], v[128:131], v[136:139], v[172:187]
    ds_read_b128 v[128:131], v17 offset:14336
    v_smfmac_f32_16x16x64_bf16 v[152:155], v[10:13], v[136:143], v14
    v_mfma_f32_32x32x16_bf16 v[172:187], v[132:135], v[140:143], v[172:187]
    ds_read_b128 v[132:135], v17 offset:15360
    s_setprio 0
    v_exp_f32 v204, v204
    v_exp_f32 v205, v205
    v_exp_f32 v206, v206
    v_cvt_pk_bf16_f32 v144, v204, v205
    v_exp_f32 v207, v207
    s_setprio 1
    v_exp_f32 v208, v208
    v_cvt_pk_bf16_f32 v145, v206, v207
    v_exp_f32 v209, v209
    v_exp_f32 v210, v210
    v_cvt_pk_bf16_f32 v146, v208, v209
    v_exp_f32 v211, v211
    v_exp_f32 v212, v212
    v_cvt_pk_bf16_f32 v147, v210, v211
    v_exp_f32 v213, v213
    v_exp_f32 v214, v214
    v_cvt_pk_bf16_f32 v148, v212, v213
    v_exp_f32 v215, v215
    v_exp_f32 v216, v216
    v_cvt_pk_bf16_f32 v149, v214, v215
    v_exp_f32 v217, v217
    v_exp_f32 v218, v218
    v_cvt_pk_bf16_f32 v150, v216, v217
    v_exp_f32 v219, v219
    s_nop 0
    v_cvt_pk_bf16_f32 v151, v218, v219
    s_cmp_lt_u32 s45, 7
    s_cbranch_scc1 mega_kernel_sk_48n
mega_kernel_sk_48:
    s_waitcnt lgkmcnt(0)
    v_mfma_f32_32x32x16_bf16 v[204:219], v[120:123], v[240:243], v[156:171]
    ds_read_b128 v[120:123], v17 offset:0
    s_add_u32 m0, s38, 3072
    s_add_u32 s3, s37, 24576
    buffer_load_dwordx4 v19, s[12:15], s3 offen lds
    s_add_u32 s38, s38, 32768
    s_add_u32 s37, s37, 262144
    v_mfma_f32_32x32x16_bf16 v[204:219], v[124:127], v[244:247], v[204:219]
    ds_read_b128 v[124:127], v17 offset:1024
    buffer_load_dwordx2 v[254:255], v249, s[16:19], s29 offen sc1
    v_mfma_f32_32x32x16_bf16 v[172:187], v[128:131], v[144:147], v[172:187]
    ds_read_b128 v[128:131], v17 offset:10240
    v_smfmac_f32_16x16x64_bf16 v[152:155], v[10:13], v[144:151], v14
    v_mfma_f32_32x32x16_bf16 v[172:187], v[132:135], v[148:151], v[172:187]
    ds_read_b128 v[132:135], v17 offset:11264
    s_setprio 0
    v_exp_f32 v188, v188
    v_exp_f32 v189, v189
    v_exp_f32 v190, v190
    v_cvt_pk_bf16_f32 v136, v188, v189
    v_exp_f32 v191, v191
    s_setprio 1
    v_exp_f32 v192, v192
    v_cvt_pk_bf16_f32 v137, v190, v191
    v_exp_f32 v193, v193
    v_exp_f32 v194, v194
    v_cvt_pk_bf16_f32 v138, v192, v193
    v_exp_f32 v195, v195
    v_exp_f32 v196, v196
    v_cvt_pk_bf16_f32 v139, v194, v195
    v_exp_f32 v197, v197
    v_exp_f32 v198, v198
    v_cvt_pk_bf16_f32 v140, v196, v197
    v_exp_f32 v199, v199
    v_exp_f32 v200, v200
    v_cvt_pk_bf16_f32 v141, v198, v199
    v_exp_f32 v201, v201
    v_exp_f32 v202, v202
    v_cvt_pk_bf16_f32 v142, v200, v201
    v_exp_f32 v203, v203
    s_nop 0
    v_cvt_pk_bf16_f32 v143, v202, v203
    s_cmp_lt_u32 s45, 8
    s_cbranch_scc1 mega_kernel_sk_49n
mega_kernel_sk_49:
    v_cndmask_b32 v156, v156, v15, s[48:49]
    v_cndmask_b32 v157, v157, v15, s[50:51]
    v_cndmask_b32 v158, v158, v15, s[52:53]
    v_cndmask_b32 v159, v159, v15, s[54:55]
    v_cndmask_b32 v160, v160, v15, s[56:57]
    v_cndmask_b32 v161, v161, v15, s[58:59]
    v_cndmask_b32 v162, v162, v15, s[60:61]
    v_cndmask_b32 v163, v163, v15, s[62:63]
    v_cndmask_b32 v164, v164, v15, s[64:65]
    v_cndmask_b32 v165, v165, v15, s[66:67]
    v_cndmask_b32 v166, v166, v15, s[68:69]
    v_cndmask_b32 v167, v167, v15, s[70:71]
    v_cndmask_b32 v168, v168, v15, s[72:73]
    v_cndmask_b32 v169, v169, v15, s[74:75]
    v_cndmask_b32 v170, v170, v15, s[76:77]
    v_cndmask_b32 v171, v171, v15, s[78:79]
    s_nop 0
    s_waitcnt lgkmcnt(0)
    v_mfma_f32_32x32x16_bf16 v[188:203], v[120:123], v[240:243], v[156:171]
    v_mfma_f32_32x32x16_bf16 v[188:203], v[124:127], v[244:247], v[188:203]
    v_mfma_f32_32x32x16_bf16 v[172:187], v[128:131], v[136:139], v[172:187]
    ds_read_b128 v[128:131], v17 offset:6144
    v_smfmac_f32_16x16x64_bf16 v[152:155], v[10:13], v[136:143], v14
    v_mfma_f32_32x32x16_bf16 v[172:187], v[132:135], v[140:143], v[172:187]
    ds_read_b128 v[132:135], v17 offset:7168
    s_setprio 0
    v_exp_f32 v204, v204
    v_exp_f32 v205, v205
    v_exp_f32 v206, v206
    v_cvt_pk_bf16_f32 v144, v204, v205
    v_exp_f32 v207, v207
    s_setprio 1
    v_exp_f32 v208, v208
    v_cvt_pk_bf16_f32 v145, v206, v207
    v_exp_f32 v209, v209
    v_exp_f32 v210, v210
    v_cvt_pk_bf16_f32 v146, v208, v209
    v_exp_f32 v211, v211
    v_exp_f32 v212, v212
    v_cvt_pk_bf16_f32 v147, v210, v211
    v_exp_f32 v213, v213
    v_exp_f32 v214, v214
    v_cvt_pk_bf16_f32 v148, v212, v213
    v_exp_f32 v215, v215
    v_exp_f32 v216, v216
    v_cvt_pk_bf16_f32 v149, v214, v215
    v_exp_f32 v217, v217
    v_exp_f32 v218, v218
    v_cvt_pk_bf16_f32 v150, v216, v217
    v_exp_f32 v219, v219
    s_nop 0
    v_cvt_pk_bf16_f32 v151, v218, v219
    s_nop 0
    s_waitcnt lgkmcnt(0)
    v_mfma_f32_32x32x16_bf16 v[172:187], v[128:131], v[144:147], v[172:187]
    ds_read_b128 v[128:131], v17 offset:2048
    v_smfmac_f32_16x16x64_bf16 v[152:155], v[10:13], v[144:151], v14
    v_mfma_f32_32x32x16_bf16 v[172:187], v[132:135], v[148:151], v[172:187]
    ds_read_b128 v[132:135], v17 offset:3072
    s_setprio 0
    v_exp_f32 v188, v188
    v_exp_f32 v189, v189
    v_exp_f32 v190, v190
    v_cvt_pk_bf16_f32 v136, v188, v189
    v_exp_f32 v191, v191
    s_setprio 1
    v_exp_f32 v192, v192
    v_cvt_pk_bf16_f32 v137, v190, v191
    v_exp_f32 v193, v193
    v_exp_f32 v194, v194
    v_cvt_pk_bf16_f32 v138, v192, v193
    v_exp_f32 v195, v195
    v_exp_f32 v196, v196
    v_cvt_pk_bf16_f32 v139, v194, v195
    v_exp_f32 v197, v197
    v_exp_f32 v198, v198
    v_cvt_pk_bf16_f32 v140, v196, v197
    v_exp_f32 v199, v199
    v_exp_f32 v200, v200
    v_cvt_pk_bf16_f32 v141, v198, v199
    v_exp_f32 v201, v201
    v_exp_f32 v202, v202
    v_cvt_pk_bf16_f32 v142, v200, v201
    v_exp_f32 v203, v203
    s_nop 0
    v_cvt_pk_bf16_f32 v143, v202, v203
    s_cmp_eq_u32 s28, 7
    s_cbranch_scc1 mega_kernel_blk_b
    s_waitcnt lgkmcnt(0)
    v_mfma_f32_32x32x16_bf16 v[172:187], v[128:131], v[136:139], v[172:187]
    v_smfmac_f32_16x16x64_bf16 v[152:155], v[10:13], v[136:143], v14
    v_mfma_f32_32x32x16_bf16 v[172:187], v[132:135], v[140:143], v[172:187]
    s_call_b64 s[40:41], mega_kernel_pre3
    s_nop 7
    s_sub_u32 s7, s32, 4194304
    v_add_f32 v7, v152, v153
    v_maximum3_f32 v6, abs(v172), abs(v173), abs(v174)
    v_maximum3_f32 v5, abs(v175), abs(v176), abs(v177)
    v_maximum3_f32 v6, v6, abs(v178), abs(v179)
    v_maximum3_f32 v5, v5, abs(v180), abs(v181)
    v_maximum3_f32 v6, v6, abs(v182), abs(v183)
    v_maximum3_f32 v5, v5, abs(v184), abs(v185)
    v_maximum3_f32 v6, v6, abs(v186), abs(v187)
    v_maximum3_f32 v6, v6, v5, v5
    v_maximum3_f32 v5, v6, v7, v7
    s_mov_b32 s3, 0xd800000
    v_cmp_gt_f32 s[4:5], s3, v6
    v_cmp_ngt_f32 vcc, 0x7b800000, v5
    s_or_b64 vcc, vcc, s[4:5]
    s_cbranch_vccnz mega_kernel_fin_50s
mega_kernel_fin_50:
    v_rcp_f32 v6, v7
    s_nop 0
    v_mul_f32 v172, v172, v6
    v_mul_f32 v173, v173, v6
    v_mul_f32 v174, v174, v6
    v_mul_f32 v175, v175, v6
    v_mul_f32 v176, v176, v6
    v_mul_f32 v177, v177, v6
    v_mul_f32 v178, v178, v6
    v_mul_f32 v179, v179, v6
    v_mul_f32 v180, v180, v6
    v_mul_f32 v181, v181, v6
    v_mul_f32 v182, v182, v6
    v_mul_f32 v183, v183, v6
    v_mul_f32 v184, v184, v6
    v_mul_f32 v185, v185, v6
    v_mul_f32 v186, v186, v6
    v_mul_f32 v187, v187, v6
    v_cvt_pk_bf16_f32 v136, v172, v173
    v_cvt_pk_bf16_f32 v137, v174, v175
    v_cvt_pk_bf16_f32 v138, v176, v177
    v_cvt_pk_bf16_f32 v139, v178, v179
    v_cvt_pk_bf16_f32 v140, v180, v181
    v_cvt_pk_bf16_f32 v141, v182, v183
    v_cvt_pk_bf16_f32 v142, v184, v185
    v_cvt_pk_bf16_f32 v143, v186, v187
    buffer_store_dwordx4 v[136:139], v1, s[16:19], s7 offen sc1
    buffer_store_dwordx4 v[140:143], v1, s[16:19], s7 offen offset:1024 sc1
    s_branch mega_kernel_p_start
mega_kernel_end_b:
    s_waitcnt lgkmcnt(0)
    v_mfma_f32_32x32x16_bf16 v[72:87], v[28:31], v[44:47], v[72:87]
    v_smfmac_f32_16x16x64_bf16 v[52:55], v[10:13], v[44:51], v14
    v_mfma_f32_32x32x16_bf16 v[72:87], v[32:35], v[48:51], v[72:87]
    s_call_b64 s[40:41], mega_kernel_pre3
    s_nop 7
    s_sub_u32 s7, s32, 0
    v_add_f32 v7, v52, v53
    v_maximum3_f32 v6, abs(v72), abs(v73), abs(v74)
    v_maximum3_f32 v5, abs(v75), abs(v76), abs(v77)
    v_maximum3_f32 v6, v6, abs(v78), abs(v79)
    v_maximum3_f32 v5, v5, abs(v80), abs(v81)
    v_maximum3_f32 v6, v6, abs(v82), abs(v83)
    v_maximum3_f32 v5, v5, abs(v84), abs(v85)
    v_maximum3_f32 v6, v6, abs(v86), abs(v87)
    v_maximum3_f32 v6, v6, v5, v5
    v_maximum3_f32 v5, v6, v7, v7
    s_mov_b32 s3, 0xd800000
    v_cmp_gt_f32 s[4:5], s3, v6
    v_cmp_ngt_f32 vcc, 0x7b800000, v5
    s_or_b64 vcc, vcc, s[4:5]
    s_cbranch_vccnz mega_kernel_fin_51s
mega_kernel_fin_51:
    v_rcp_f32 v6, v7
    s_nop 0
    v_mul_f32 v72, v72, v6
    v_mul_f32 v73, v73, v6
    v_mul_f32 v74, v74, v6
    v_mul_f32 v75, v75, v6
    v_mul_f32 v76, v76, v6
    v_mul_f32 v77, v77, v6
    v_mul_f32 v78, v78, v6
    v_mul_f32 v79, v79, v6
    v_mul_f32 v80, v80, v6
    v_mul_f32 v81, v81, v6
    v_mul_f32 v82, v82, v6
    v_mul_f32 v83, v83, v6
    v_mul_f32 v84, v84, v6
    v_mul_f32 v85, v85, v6
    v_mul_f32 v86, v86, v6
    v_mul_f32 v87, v87, v6
    v_cvt_pk_bf16_f32 v36, v72, v73
    v_cvt_pk_bf16_f32 v37, v74, v75
    v_cvt_pk_bf16_f32 v38, v76, v77
    v_cvt_pk_bf16_f32 v39, v78, v79
    v_cvt_pk_bf16_f32 v40, v80, v81
    v_cvt_pk_bf16_f32 v41, v82, v83
    v_cvt_pk_bf16_f32 v42, v84, v85
    v_cvt_pk_bf16_f32 v43, v86, v87
    buffer_store_dwordx4 v[36:39], v1, s[16:19], s7 offen sc1
    buffer_store_dwordx4 v[40:43], v1, s[16:19], s7 offen offset:1024 sc1
mega_kernel_p_start:
    s_setprio 0
    s_cmp_lt_u32 s20, 4
    s_cbranch_scc1 mega_kernel_p_compute
    s_waitcnt vmcnt(6)
    s_barrier
    s_add_u32 m0, s26, s30
    s_lshl_b32 s3, s25, 12
    s_add_u32 s3, s3, s24
    buffer_load_dwordx4 v1, s[16:19], s3 offen offset:0 sc1 lds
    buffer_load_dwordx4 v1, s[16:19], s3 offen offset:1024 sc1 lds
    buffer_load_dwordx4 v1, s[16:19], s3 offen offset:2048 sc1 lds
    buffer_load_dwordx4 v1, s[16:19], s3 offen offset:3072 sc1 lds
    s_add_u32 s3, s25, 1
    s_and_b32 s3, s3, 7
    s_and_b32 s25, s25, 8
    s_or_b32 s25, s25, s3
    s_add_u32 s26, s26, 16384
    s_and_b32 s26, s26, 65535
    s_waitcnt vmcnt(4)
    s_barrier
    s_add_u32 m0, s26, s30
    s_lshl_b32 s3, s25, 12
    s_add_u32 s3, s3, s24
    buffer_load_dwordx4 v1, s[16:19], s3 offen offset:0 sc1 lds
    buffer_load_dwordx4 v1, s[16:19], s3 offen offset:1024 sc1 lds
    buffer_load_dwordx4 v1, s[16:19], s3 offen offset:2048 sc1 lds
    buffer_load_dwordx4 v1, s[16:19], s3 offen offset:3072 sc1 lds
    s_add_u32 s3, s25, 1
    s_and_b32 s3, s3, 7
    s_and_b32 s25, s25, 8
    s_or_b32 s25, s25, s3
    s_add_u32 s26, s26, 16384
    s_and_b32 s26, s26, 65535
    s_waitcnt vmcnt(4)
    s_mov_b32 s38, 4
    s_barrier
    s_branch mega_kernel_p_eret
mega_kernel_p_lloop:
    s_waitcnt vmcnt(8)
    s_barrier
    s_cmp_eq_u32 s38, 7
    s_cbranch_scc1 mega_kernel_p_e6
    s_cmp_eq_u32 s38, 8
    s_cbranch_scc1 mega_kernel_p_e8
mega_kernel_p_eret:
    s_add_u32 m0, s26, s30
    s_lshl_b32 s3, s25, 12
    s_add_u32 s3, s3, s24
    buffer_load_dwordx4 v1, s[16:19], s3 offen offset:0 sc1 lds
    buffer_load_dwordx4 v1, s[16:19], s3 offen offset:1024 sc1 lds
    buffer_load_dwordx4 v1, s[16:19], s3 offen offset:2048 sc1 lds
    buffer_load_dwordx4 v1, s[16:19], s3 offen offset:3072 sc1 lds
    s_sub_u32 m0, m0, 65536
    s_lshl_b32 s3, s25, 17
    s_add_u32 s3, s3, s37
    buffer_load_dwordx4 v18, s[12:15], s3 offen lds
    s_add_u32 m0, m0, 1024
    s_add_u32 s3, s3, 8192
    buffer_load_dwordx4 v19, s[12:15], s3 offen lds
    s_add_u32 m0, m0, 1024
    s_add_u32 s3, s3, 8192
    buffer_load_dwordx4 v18, s[12:15], s3 offen lds
    s_add_u32 m0, m0, 1024
    s_add_u32 s3, s3, 8192
    buffer_load_dwordx4 v19, s[12:15], s3 offen lds
    s_add_u32 s3, s25, 1
    s_and_b32 s3, s3, 7
    s_and_b32 s25, s25, 8
    s_or_b32 s25, s25, s3
    s_add_u32 s26, s26, 16384
    s_and_b32 s26, s26, 65535
    s_add_u32 s38, s38, 1
    s_cmp_lt_u32 s38, 16
    s_cbranch_scc1 mega_kernel_p_lloop
    s_waitcnt vmcnt(8)
    s_barrier
    s_waitcnt vmcnt(0)
    s_barrier
    s_endpgm
mega_kernel_p_compute:
    s_lshr_b32 s3, s20, 1
    s_and_b32 s4, s20, 1
    v_lshrrev_b32 v7, 4, v0
    v_and_b32 v8, 15, v0
    s_lshl_b32 s5, s3, 13
    s_add_u32 s5, s5, 65536
    v_lshlrev_b32 v2, 9, v7
    v_lshl_add_u32 v2, v8, 4, v2
    v_add_u32 v2, s5, v2
    v_lshrrev_b32 v9, 5, v0
    v_lshlrev_b32 v9, 12, v9
    v_bfe_u32 v10, v0, 4, 1
    v_lshl_add_u32 v9, v10, 10, v9
    s_lshl_b32 s5, s4, 9
    s_add_u32 s5, s5, 0
    v_add_u32 v9, s5, v9
    v_bfe_u32 v11, v0, 2, 2
    v_lshl_add_u32 v9, v11, 6, v9
    v_and_b32 v11, 3, v0
    v_lshl_add_u32 v9, v11, 3, v9
    v_lshl_add_u32 v3, v10, 5, v9
    v_xor_b32 v4, 32, v3
    s_setprio 1
    s_cmp_eq_u32 s20, 0
    s_cselect_b32 s36, s36, 0x7f000000
    s_barrier
    ds_read_b64_tr_b16 v[40:41], v3 offset:0
    ds_read_b64_tr_b16 v[42:43], v3 offset:2048
    ds_read_b128 v[24:27], v2 offset:0
    ds_read_b128 v[28:31], v2 offset:256
    ds_read_b128 v[32:35], v2 offset:4096
    ds_read_b128 v[36:39], v2 offset:4352
    ds_read_b64_tr_b16 v[44:45], v4 offset:0
    ds_read_b64_tr_b16 v[46:47], v4 offset:2048
    ds_read_b64_tr_b16 v[48:49], v3 offset:256
    ds_read_b64_tr_b16 v[50:51], v3 offset:2304
    ds_read_b64_tr_b16 v[52:53], v4 offset:256
    ds_read_b64_tr_b16 v[54:55], v4 offset:2304
    s_waitcnt lgkmcnt(6)
    v_mfma_f32_16x16x32_bf16 v[88:91], v[40:43], v[24:27], 0
    ds_read_b64_tr_b16 v[72:73], v3 offset:8192
    v_mfma_f32_16x16x32_bf16 v[92:95], v[40:43], v[28:31], 0
    ds_read_b64_tr_b16 v[74:75], v3 offset:10240
    v_mfma_f32_16x16x32_bf16 v[96:99], v[40:43], v[32:35], 0
    ds_read_b128 v[56:59], v2 offset:2048
    v_mfma_f32_16x16x32_bf16 v[100:103], v[40:43], v[36:39], 0
    ds_read_b128 v[60:63], v2 offset:2304
    s_waitcnt lgkmcnt(8)
    v_mfma_f32_16x16x32_bf16 v[116:119], v[44:47], v[36:39], 0
    ds_read_b128 v[64:67], v2 offset:6144
    v_mfma_f32_16x16x32_bf16 v[112:115], v[44:47], v[32:35], 0
    ds_read_b128 v[68:71], v2 offset:6400
    v_mfma_f32_16x16x32_bf16 v[108:111], v[44:47], v[28:31], 0
    ds_read_b64_tr_b16 v[76:77], v4 offset:8192
    v_mfma_f32_16x16x32_bf16 v[104:107], v[44:47], v[24:27], 0
    ds_read_b64_tr_b16 v[78:79], v4 offset:10240
    s_waitcnt lgkmcnt(10)
    v_mfma_f32_16x16x32_bf16 v[120:123], v[48:51], v[24:27], 0
    ds_read_b64_tr_b16 v[80:81], v3 offset:8448
    v_mfma_f32_16x16x32_bf16 v[124:127], v[48:51], v[28:31], 0
    ds_read_b64_tr_b16 v[82:83], v3 offset:10496
    v_mfma_f32_16x16x32_bf16 v[128:131], v[48:51], v[32:35], 0
    ds_read_b64_tr_b16 v[84:85], v4 offset:8448
    v_mfma_f32_16x16x32_bf16 v[132:135], v[48:51], v[36:39], 0
    ds_read_b64_tr_b16 v[86:87], v4 offset:10496
    s_waitcnt lgkmcnt(12)
    v_mfma_f32_16x16x32_bf16 v[148:151], v[52:55], v[36:39], 0
    s_waitcnt vmcnt(0)
    v_mfma_f32_16x16x32_bf16 v[144:147], v[52:55], v[32:35], 0
    v_mfma_f32_16x16x32_bf16 v[140:143], v[52:55], v[28:31], 0
    v_mfma_f32_16x16x32_bf16 v[136:139], v[52:55], v[24:27], 0
    s_waitcnt lgkmcnt(6)
    s_barrier
    v_mfma_f32_16x16x32_bf16 v[88:91], v[72:75], v[56:59], v[88:91]
    ds_read_b64_tr_b16 v[40:41], v3 offset:16384
    v_mfma_f32_16x16x32_bf16 v[92:95], v[72:75], v[60:63], v[92:95]
    ds_read_b64_tr_b16 v[42:43], v3 offset:18432
    v_mfma_f32_16x16x32_bf16 v[96:99], v[72:75], v[64:67], v[96:99]
    ds_read_b128 v[24:27], v2 offset:16384
    v_mfma_f32_16x16x32_bf16 v[100:103], v[72:75], v[68:71], v[100:103]
    ds_read_b128 v[28:31], v2 offset:16640
    s_waitcnt lgkmcnt(8)
    v_mfma_f32_16x16x32_bf16 v[116:119], v[76:79], v[68:71], v[116:119]
    ds_read_b128 v[32:35], v2 offset:20480
    v_mfma_f32_16x16x32_bf16 v[112:115], v[76:79], v[64:67], v[112:115]
    ds_read_b128 v[36:39], v2 offset:20736
    v_mfma_f32_16x16x32_bf16 v[108:111], v[76:79], v[60:63], v[108:111]
    ds_read_b64_tr_b16 v[44:45], v4 offset:16384
    v_mfma_f32_16x16x32_bf16 v[104:107], v[76:79], v[56:59], v[104:107]
    ds_read_b64_tr_b16 v[46:47], v4 offset:18432
    s_waitcnt lgkmcnt(10)
    v_mfma_f32_16x16x32_bf16 v[120:123], v[80:83], v[56:59], v[120:123]
    ds_read_b64_tr_b16 v[48:49], v3 offset:16640
    v_mfma_f32_16x16x32_bf16 v[124:127], v[80:83], v[60:63], v[124:127]
    ds_read_b64_tr_b16 v[50:51], v3 offset:18688
    v_mfma_f32_16x16x32_bf16 v[128:131], v[80:83], v[64:67], v[128:131]
    ds_read_b64_tr_b16 v[52:53], v4 offset:16640
    v_mfma_f32_16x16x32_bf16 v[132:135], v[80:83], v[68:71], v[132:135]
    ds_read_b64_tr_b16 v[54:55], v4 offset:18688
    s_waitcnt lgkmcnt(12)
    v_mfma_f32_16x16x32_bf16 v[148:151], v[84:87], v[68:71], v[148:151]
    s_mov_b64 exec, 1
    buffer_store_dword v251, v248, s[16:19], s36 offen sc1
    s_mov_b64 exec, -1
    v_mfma_f32_16x16x32_bf16 v[144:147], v[84:87], v[64:67], v[144:147]
    v_mfma_f32_16x16x32_bf16 v[140:143], v[84:87], v[60:63], v[140:143]
    v_mfma_f32_16x16x32_bf16 v[136:139], v[84:87], v[56:59], v[136:139]
    s_waitcnt lgkmcnt(6)
    v_mfma_f32_16x16x32_bf16 v[88:91], v[40:43], v[24:27], v[88:91]
    ds_read_b64_tr_b16 v[72:73], v3 offset:24576
    v_mfma_f32_16x16x32_bf16 v[92:95], v[40:43], v[28:31], v[92:95]
    ds_read_b64_tr_b16 v[74:75], v3 offset:26624
    v_mfma_f32_16x16x32_bf16 v[96:99], v[40:43], v[32:35], v[96:99]
    ds_read_b128 v[56:59], v2 offset:18432
    v_mfma_f32_16x16x32_bf16 v[100:103], v[40:43], v[36:39], v[100:103]
    ds_read_b128 v[60:63], v2 offset:18688
    s_waitcnt lgkmcnt(8)
    v_mfma_f32_16x16x32_bf16 v[116:119], v[44:47], v[36:39], v[116:119]
    ds_read_b128 v[64:67], v2 offset:22528
    v_mfma_f32_16x16x32_bf16 v[112:115], v[44:47], v[32:35], v[112:115]
    ds_read_b128 v[68:71], v2 offset:22784
    v_mfma_f32_16x16x32_bf16 v[108:111], v[44:47], v[28:31], v[108:111]
    ds_read_b64_tr_b16 v[76:77], v4 offset:24576
    v_mfma_f32_16x16x32_bf16 v[104:107], v[44:47], v[24:27], v[104:107]
    ds_read_b64_tr_b16 v[78:79], v4 offset:26624
    s_waitcnt lgkmcnt(10)
    v_mfma_f32_16x16x32_bf16 v[120:123], v[48:51], v[24:27], v[120:123]
    ds_read_b64_tr_b16 v[80:81], v3 offset:24832
    v_mfma_f32_16x16x32_bf16 v[124:127], v[48:51], v[28:31], v[124:127]
    ds_read_b64_tr_b16 v[82:83], v3 offset:26880
    v_mfma_f32_16x16x32_bf16 v[128:131], v[48:51], v[32:35], v[128:131]
    ds_read_b64_tr_b16 v[84:85], v4 offset:24832
    v_mfma_f32_16x16x32_bf16 v[132:135], v[48:51], v[36:39], v[132:135]
    ds_read_b64_tr_b16 v[86:87], v4 offset:26880
    s_waitcnt lgkmcnt(12)
    v_mfma_f32_16x16x32_bf16 v[148:151], v[52:55], v[36:39], v[148:151]
    s_lshl_b32 s5, s20, 13
    v_mfma_f32_16x16x32_bf16 v[144:147], v[52:55], v[32:35], v[144:147]
    s_add_u32 s5, s5, 131072
    v_mfma_f32_16x16x32_bf16 v[140:143], v[52:55], v[28:31], v[140:143]
    v_lshlrev_b32 v9, 7, v8
    v_mfma_f32_16x16x32_bf16 v[136:139], v[52:55], v[24:27], v[136:139]
    s_waitcnt lgkmcnt(6)
    s_barrier
    v_mfma_f32_16x16x32_bf16 v[88:91], v[72:75], v[56:59], v[88:91]
    ds_read_b64_tr_b16 v[40:41], v3 offset:32768
    v_mfma_f32_16x16x32_bf16 v[92:95], v[72:75], v[60:63], v[92:95]
    ds_read_b64_tr_b16 v[42:43], v3 offset:34816
    v_mfma_f32_16x16x32_bf16 v[96:99], v[72:75], v[64:67], v[96:99]
    ds_read_b128 v[24:27], v2 offset:32768
    v_mfma_f32_16x16x32_bf16 v[100:103], v[72:75], v[68:71], v[100:103]
    ds_read_b128 v[28:31], v2 offset:33024
    s_waitcnt lgkmcnt(8)
    v_mfma_f32_16x16x32_bf16 v[116:119], v[76:79], v[68:71], v[116:119]
    ds_read_b128 v[32:35], v2 offset:36864
    v_mfma_f32_16x16x32_bf16 v[112:115], v[76:79], v[64:67], v[112:115]
    ds_read_b128 v[36:39], v2 offset:37120
    v_mfma_f32_16x16x32_bf16 v[108:111], v[76:79], v[60:63], v[108:111]
    ds_read_b64_tr_b16 v[44:45], v4 offset:32768
    v_mfma_f32_16x16x32_bf16 v[104:107], v[76:79], v[56:59], v[104:107]
    ds_read_b64_tr_b16 v[46:47], v4 offset:34816
    s_waitcnt lgkmcnt(10)
    v_mfma_f32_16x16x32_bf16 v[120:123], v[80:83], v[56:59], v[120:123]
    ds_read_b64_tr_b16 v[48:49], v3 offset:33024
    v_mfma_f32_16x16x32_bf16 v[124:127], v[80:83], v[60:63], v[124:127]
    ds_read_b64_tr_b16 v[50:51], v3 offset:35072
    v_mfma_f32_16x16x32_bf16 v[128:131], v[80:83], v[64:67], v[128:131]
    ds_read_b64_tr_b16 v[52:53], v4 offset:33024
    v_mfma_f32_16x16x32_bf16 v[132:135], v[80:83], v[68:71], v[132:135]
    ds_read_b64_tr_b16 v[54:55], v4 offset:35072
    s_waitcnt lgkmcnt(12)
    v_mfma_f32_16x16x32_bf16 v[148:151], v[84:87], v[68:71], v[148:151]
    v_mfma_f32_16x16x32_bf16 v[144:147], v[84:87], v[64:67], v[144:147]
    v_mfma_f32_16x16x32_bf16 v[140:143], v[84:87], v[60:63], v[140:143]
    v_mfma_f32_16x16x32_bf16 v[136:139], v[84:87], v[56:59], v[136:139]
    s_waitcnt lgkmcnt(6)
    v_mfma_f32_16x16x32_bf16 v[88:91], v[40:43], v[24:27], v[88:91]
    ds_read_b64_tr_b16 v[72:73], v3 offset:40960
    v_mfma_f32_16x16x32_bf16 v[92:95], v[40:43], v[28:31], v[92:95]
    ds_read_b64_tr_b16 v[74:75], v3 offset:43008
    v_mfma_f32_16x16x32_bf16 v[96:99], v[40:43], v[32:35], v[96:99]
    ds_read_b128 v[56:59], v2 offset:34816
    v_mfma_f32_16x16x32_bf16 v[100:103], v[40:43], v[36:39], v[100:103]
    ds_read_b128 v[60:63], v2 offset:35072
    s_waitcnt lgkmcnt(8)
    v_mfma_f32_16x16x32_bf16 v[116:119], v[44:47], v[36:39], v[116:119]
    ds_read_b128 v[64:67], v2 offset:38912
    v_mfma_f32_16x16x32_bf16 v[112:115], v[44:47], v[32:35], v[112:115]
    ds_read_b128 v[68:71], v2 offset:39168
    v_mfma_f32_16x16x32_bf16 v[108:111], v[44:47], v[28:31], v[108:111]
    ds_read_b64_tr_b16 v[76:77], v4 offset:40960
    v_mfma_f32_16x16x32_bf16 v[104:107], v[44:47], v[24:27], v[104:107]
    ds_read_b64_tr_b16 v[78:79], v4 offset:43008
    s_waitcnt lgkmcnt(10)
    v_mfma_f32_16x16x32_bf16 v[120:123], v[48:51], v[24:27], v[120:123]
    ds_read_b64_tr_b16 v[80:81], v3 offset:41216
    v_mfma_f32_16x16x32_bf16 v[124:127], v[48:51], v[28:31], v[124:127]
    ds_read_b64_tr_b16 v[82:83], v3 offset:43264
    v_mfma_f32_16x16x32_bf16 v[128:131], v[48:51], v[32:35], v[128:131]
    ds_read_b64_tr_b16 v[84:85], v4 offset:41216
    v_mfma_f32_16x16x32_bf16 v[132:135], v[48:51], v[36:39], v[132:135]
    ds_read_b64_tr_b16 v[86:87], v4 offset:43264
    s_waitcnt lgkmcnt(12)
    v_mfma_f32_16x16x32_bf16 v[148:151], v[52:55], v[36:39], v[148:151]
    v_lshl_add_u32 v9, v10, 3, v9
    v_mfma_f32_16x16x32_bf16 v[144:147], v[52:55], v[32:35], v[144:147]
    v_add_u32 v9, s5, v9
    v_mfma_f32_16x16x32_bf16 v[140:143], v[52:55], v[28:31], v[140:143]
    v_lshrrev_b32 v11, 5, v0
    v_mfma_f32_16x16x32_bf16 v[136:139], v[52:55], v[24:27], v[136:139]
    s_waitcnt lgkmcnt(6)
    s_barrier
    v_mfma_f32_16x16x32_bf16 v[88:91], v[72:75], v[56:59], v[88:91]
    ds_read_b64_tr_b16 v[40:41], v3 offset:49152
    v_mfma_f32_16x16x32_bf16 v[92:95], v[72:75], v[60:63], v[92:95]
    ds_read_b64_tr_b16 v[42:43], v3 offset:51200
    v_mfma_f32_16x16x32_bf16 v[96:99], v[72:75], v[64:67], v[96:99]
    ds_read_b128 v[24:27], v2 offset:49152
    v_mfma_f32_16x16x32_bf16 v[100:103], v[72:75], v[68:71], v[100:103]
    ds_read_b128 v[28:31], v2 offset:49408
    s_waitcnt lgkmcnt(8)
    v_mfma_f32_16x16x32_bf16 v[116:119], v[76:79], v[68:71], v[116:119]
    ds_read_b128 v[32:35], v2 offset:53248
    v_mfma_f32_16x16x32_bf16 v[112:115], v[76:79], v[64:67], v[112:115]
    ds_read_b128 v[36:39], v2 offset:53504
    v_mfma_f32_16x16x32_bf16 v[108:111], v[76:79], v[60:63], v[108:111]
    ds_read_b64_tr_b16 v[44:45], v4 offset:49152
    v_mfma_f32_16x16x32_bf16 v[104:107], v[76:79], v[56:59], v[104:107]
    ds_read_b64_tr_b16 v[46:47], v4 offset:51200
    s_waitcnt lgkmcnt(10)
    v_mfma_f32_16x16x32_bf16 v[120:123], v[80:83], v[56:59], v[120:123]
    ds_read_b64_tr_b16 v[48:49], v3 offset:49408
    v_mfma_f32_16x16x32_bf16 v[124:127], v[80:83], v[60:63], v[124:127]
    ds_read_b64_tr_b16 v[50:51], v3 offset:51456
    v_mfma_f32_16x16x32_bf16 v[128:131], v[80:83], v[64:67], v[128:131]
    ds_read_b64_tr_b16 v[52:53], v4 offset:49408
    v_mfma_f32_16x16x32_bf16 v[132:135], v[80:83], v[68:71], v[132:135]
    ds_read_b64_tr_b16 v[54:55], v4 offset:51456
    s_waitcnt lgkmcnt(12)
    v_mfma_f32_16x16x32_bf16 v[148:151], v[84:87], v[68:71], v[148:151]
    v_mfma_f32_16x16x32_bf16 v[144:147], v[84:87], v[64:67], v[144:147]
    v_mfma_f32_16x16x32_bf16 v[140:143], v[84:87], v[60:63], v[140:143]
    v_mfma_f32_16x16x32_bf16 v[136:139], v[84:87], v[56:59], v[136:139]
    s_waitcnt lgkmcnt(6)
    v_mfma_f32_16x16x32_bf16 v[88:91], v[40:43], v[24:27], v[88:91]
    ds_read_b64_tr_b16 v[72:73], v3 offset:57344
    v_mfma_f32_16x16x32_bf16 v[92:95], v[40:43], v[28:31], v[92:95]
    ds_read_b64_tr_b16 v[74:75], v3 offset:59392
    v_mfma_f32_16x16x32_bf16 v[96:99], v[40:43], v[32:35], v[96:99]
    ds_read_b128 v[56:59], v2 offset:51200
    v_mfma_f32_16x16x32_bf16 v[100:103], v[40:43], v[36:39], v[100:103]
    ds_read_b128 v[60:63], v2 offset:51456
    s_waitcnt lgkmcnt(8)
    v_mfma_f32_16x16x32_bf16 v[116:119], v[44:47], v[36:39], v[116:119]
    ds_read_b128 v[64:67], v2 offset:55296
    v_mfma_f32_16x16x32_bf16 v[112:115], v[44:47], v[32:35], v[112:115]
    ds_read_b128 v[68:71], v2 offset:55552
    v_mfma_f32_16x16x32_bf16 v[108:111], v[44:47], v[28:31], v[108:111]
    ds_read_b64_tr_b16 v[76:77], v4 offset:57344
    v_mfma_f32_16x16x32_bf16 v[104:107], v[44:47], v[24:27], v[104:107]
    ds_read_b64_tr_b16 v[78:79], v4 offset:59392
    s_waitcnt lgkmcnt(10)
    v_mfma_f32_16x16x32_bf16 v[120:123], v[48:51], v[24:27], v[120:123]
    ds_read_b64_tr_b16 v[80:81], v3 offset:57600
    v_mfma_f32_16x16x32_bf16 v[124:127], v[48:51], v[28:31], v[124:127]
    ds_read_b64_tr_b16 v[82:83], v3 offset:59648
    v_mfma_f32_16x16x32_bf16 v[128:131], v[48:51], v[32:35], v[128:131]
    ds_read_b64_tr_b16 v[84:85], v4 offset:57600
    v_mfma_f32_16x16x32_bf16 v[132:135], v[48:51], v[36:39], v[132:135]
    ds_read_b64_tr_b16 v[86:87], v4 offset:59648
    s_waitcnt lgkmcnt(12)
    v_mfma_f32_16x16x32_bf16 v[148:151], v[52:55], v[36:39], v[148:151]
    v_and_b32 v12, 7, v0
    v_mfma_f32_16x16x32_bf16 v[144:147], v[52:55], v[32:35], v[144:147]
    v_xor_b32 v11, v11, v12
    v_mfma_f32_16x16x32_bf16 v[140:143], v[52:55], v[28:31], v[140:143]
    v_xor_b32 v13, 0, v11
    v_mfma_f32_16x16x32_bf16 v[136:139], v[52:55], v[24:27], v[136:139]
    s_waitcnt lgkmcnt(6)
    s_barrier
    v_mfma_f32_16x16x32_bf16 v[88:91], v[72:75], v[56:59], v[88:91]
    ds_read_b64_tr_b16 v[40:41], v3 offset:0
    v_mfma_f32_16x16x32_bf16 v[92:95], v[72:75], v[60:63], v[92:95]
    ds_read_b64_tr_b16 v[42:43], v3 offset:2048
    v_mfma_f32_16x16x32_bf16 v[96:99], v[72:75], v[64:67], v[96:99]
    ds_read_b128 v[24:27], v2 offset:0
    v_mfma_f32_16x16x32_bf16 v[100:103], v[72:75], v[68:71], v[100:103]
    ds_read_b128 v[28:31], v2 offset:256
    s_waitcnt lgkmcnt(8)
    v_mfma_f32_16x16x32_bf16 v[116:119], v[76:79], v[68:71], v[116:119]
    ds_read_b128 v[32:35], v2 offset:4096
    v_mfma_f32_16x16x32_bf16 v[112:115], v[76:79], v[64:67], v[112:115]
    ds_read_b128 v[36:39], v2 offset:4352
    v_mfma_f32_16x16x32_bf16 v[108:111], v[76:79], v[60:63], v[108:111]
    ds_read_b64_tr_b16 v[44:45], v4 offset:0
    v_mfma_f32_16x16x32_bf16 v[104:107], v[76:79], v[56:59], v[104:107]
    ds_read_b64_tr_b16 v[46:47], v4 offset:2048
    s_waitcnt lgkmcnt(10)
    v_mfma_f32_16x16x32_bf16 v[120:123], v[80:83], v[56:59], v[120:123]
    ds_read_b64_tr_b16 v[48:49], v3 offset:256
    v_mfma_f32_16x16x32_bf16 v[124:127], v[80:83], v[60:63], v[124:127]
    ds_read_b64_tr_b16 v[50:51], v3 offset:2304
    v_mfma_f32_16x16x32_bf16 v[128:131], v[80:83], v[64:67], v[128:131]
    ds_read_b64_tr_b16 v[52:53], v4 offset:256
    v_mfma_f32_16x16x32_bf16 v[132:135], v[80:83], v[68:71], v[132:135]
    ds_read_b64_tr_b16 v[54:55], v4 offset:2304
    s_waitcnt lgkmcnt(12)
    v_mfma_f32_16x16x32_bf16 v[148:151], v[84:87], v[68:71], v[148:151]
    v_mfma_f32_16x16x32_bf16 v[144:147], v[84:87], v[64:67], v[144:147]
    v_mfma_f32_16x16x32_bf16 v[140:143], v[84:87], v[60:63], v[140:143]
    v_mfma_f32_16x16x32_bf16 v[136:139], v[84:87], v[56:59], v[136:139]
    s_waitcnt lgkmcnt(6)
    v_mfma_f32_16x16x32_bf16 v[88:91], v[40:43], v[24:27], v[88:91]
    ds_read_b64_tr_b16 v[72:73], v3 offset:8192
    v_mfma_f32_16x16x32_bf16 v[92:95], v[40:43], v[28:31], v[92:95]
    ds_read_b64_tr_b16 v[74:75], v3 offset:10240
    v_mfma_f32_16x16x32_bf16 v[96:99], v[40:43], v[32:35], v[96:99]
    ds_read_b128 v[56:59], v2 offset:2048
    v_mfma_f32_16x16x32_bf16 v[100:103], v[40:43], v[36:39], v[100:103]
    ds_read_b128 v[60:63], v2 offset:2304
    s_waitcnt lgkmcnt(8)
    v_mfma_f32_16x16x32_bf16 v[116:119], v[44:47], v[36:39], v[116:119]
    ds_read_b128 v[64:67], v2 offset:6144
    v_mfma_f32_16x16x32_bf16 v[112:115], v[44:47], v[32:35], v[112:115]
    ds_read_b128 v[68:71], v2 offset:6400
    v_mfma_f32_16x16x32_bf16 v[108:111], v[44:47], v[28:31], v[108:111]
    ds_read_b64_tr_b16 v[76:77], v4 offset:8192
    v_mfma_f32_16x16x32_bf16 v[104:107], v[44:47], v[24:27], v[104:107]
    ds_read_b64_tr_b16 v[78:79], v4 offset:10240
    s_waitcnt lgkmcnt(10)
    v_mfma_f32_16x16x32_bf16 v[120:123], v[48:51], v[24:27], v[120:123]
    ds_read_b64_tr_b16 v[80:81], v3 offset:8448
    v_mfma_f32_16x16x32_bf16 v[124:127], v[48:51], v[28:31], v[124:127]
    ds_read_b64_tr_b16 v[82:83], v3 offset:10496
    v_mfma_f32_16x16x32_bf16 v[128:131], v[48:51], v[32:35], v[128:131]
    ds_read_b64_tr_b16 v[84:85], v4 offset:8448
    v_mfma_f32_16x16x32_bf16 v[132:135], v[48:51], v[36:39], v[132:135]
    ds_read_b64_tr_b16 v[86:87], v4 offset:10496
    s_waitcnt lgkmcnt(12)
    v_mfma_f32_16x16x32_bf16 v[148:151], v[52:55], v[36:39], v[148:151]
    v_lshl_add_u32 v20, v13, 4, v9
    v_mfma_f32_16x16x32_bf16 v[144:147], v[52:55], v[32:35], v[144:147]
    v_xor_b32 v13, 2, v11
    v_mfma_f32_16x16x32_bf16 v[140:143], v[52:55], v[28:31], v[140:143]
    v_lshl_add_u32 v21, v13, 4, v9
    v_mfma_f32_16x16x32_bf16 v[136:139], v[52:55], v[24:27], v[136:139]
    s_waitcnt lgkmcnt(6)
    s_barrier
    v_mfma_f32_16x16x32_bf16 v[88:91], v[72:75], v[56:59], v[88:91]
    ds_read_b64_tr_b16 v[40:41], v3 offset:16384
    v_mfma_f32_16x16x32_bf16 v[92:95], v[72:75], v[60:63], v[92:95]
    ds_read_b64_tr_b16 v[42:43], v3 offset:18432
    v_mfma_f32_16x16x32_bf16 v[96:99], v[72:75], v[64:67], v[96:99]
    ds_read_b128 v[24:27], v2 offset:16384
    v_mfma_f32_16x16x32_bf16 v[100:103], v[72:75], v[68:71], v[100:103]
    ds_read_b128 v[28:31], v2 offset:16640
    s_waitcnt lgkmcnt(8)
    v_mfma_f32_16x16x32_bf16 v[116:119], v[76:79], v[68:71], v[116:119]
    ds_read_b128 v[32:35], v2 offset:20480
    v_mfma_f32_16x16x32_bf16 v[112:115], v[76:79], v[64:67], v[112:115]
    ds_read_b128 v[36:39], v2 offset:20736
    v_mfma_f32_16x16x32_bf16 v[108:111], v[76:79], v[60:63], v[108:111]
    ds_read_b64_tr_b16 v[44:45], v4 offset:16384
    v_mfma_f32_16x16x32_bf16 v[104:107], v[76:79], v[56:59], v[104:107]
    ds_read_b64_tr_b16 v[46:47], v4 offset:18432
    s_waitcnt lgkmcnt(10)
    v_mfma_f32_16x16x32_bf16 v[120:123], v[80:83], v[56:59], v[120:123]
    ds_read_b64_tr_b16 v[48:49], v3 offset:16640
    v_mfma_f32_16x16x32_bf16 v[124:127], v[80:83], v[60:63], v[124:127]
    ds_read_b64_tr_b16 v[50:51], v3 offset:18688
    v_mfma_f32_16x16x32_bf16 v[128:131], v[80:83], v[64:67], v[128:131]
    ds_read_b64_tr_b16 v[52:53], v4 offset:16640
    v_mfma_f32_16x16x32_bf16 v[132:135], v[80:83], v[68:71], v[132:135]
    ds_read_b64_tr_b16 v[54:55], v4 offset:18688
    s_waitcnt lgkmcnt(12)
    v_mfma_f32_16x16x32_bf16 v[148:151], v[84:87], v[68:71], v[148:151]
    v_mfma_f32_16x16x32_bf16 v[144:147], v[84:87], v[64:67], v[144:147]
    v_mfma_f32_16x16x32_bf16 v[140:143], v[84:87], v[60:63], v[140:143]
    v_mfma_f32_16x16x32_bf16 v[136:139], v[84:87], v[56:59], v[136:139]
    s_waitcnt lgkmcnt(6)
    v_mfma_f32_16x16x32_bf16 v[88:91], v[40:43], v[24:27], v[88:91]
    ds_read_b64_tr_b16 v[72:73], v3 offset:24576
    v_mfma_f32_16x16x32_bf16 v[92:95], v[40:43], v[28:31], v[92:95]
    ds_read_b64_tr_b16 v[74:75], v3 offset:26624
    v_mfma_f32_16x16x32_bf16 v[96:99], v[40:43], v[32:35], v[96:99]
    ds_read_b128 v[56:59], v2 offset:18432
    v_mfma_f32_16x16x32_bf16 v[100:103], v[40:43], v[36:39], v[100:103]
    ds_read_b128 v[60:63], v2 offset:18688
    s_waitcnt lgkmcnt(8)
    v_mfma_f32_16x16x32_bf16 v[116:119], v[44:47], v[36:39], v[116:119]
    ds_read_b128 v[64:67], v2 offset:22528
    v_mfma_f32_16x16x32_bf16 v[112:115], v[44:47], v[32:35], v[112:115]
    ds_read_b128 v[68:71], v2 offset:22784
    v_mfma_f32_16x16x32_bf16 v[108:111], v[44:47], v[28:31], v[108:111]
    ds_read_b64_tr_b16 v[76:77], v4 offset:24576
    v_mfma_f32_16x16x32_bf16 v[104:107], v[44:47], v[24:27], v[104:107]
    ds_read_b64_tr_b16 v[78:79], v4 offset:26624
    s_waitcnt lgkmcnt(10)
    v_mfma_f32_16x16x32_bf16 v[120:123], v[48:51], v[24:27], v[120:123]
    ds_read_b64_tr_b16 v[80:81], v3 offset:24832
    v_mfma_f32_16x16x32_bf16 v[124:127], v[48:51], v[28:31], v[124:127]
    ds_read_b64_tr_b16 v[82:83], v3 offset:26880
    v_mfma_f32_16x16x32_bf16 v[128:131], v[48:51], v[32:35], v[128:131]
    ds_read_b64_tr_b16 v[84:85], v4 offset:24832
    v_mfma_f32_16x16x32_bf16 v[132:135], v[48:51], v[36:39], v[132:135]
    ds_read_b64_tr_b16 v[86:87], v4 offset:26880
    s_waitcnt lgkmcnt(12)
    v_mfma_f32_16x16x32_bf16 v[148:151], v[52:55], v[36:39], v[148:151]
    v_xor_b32 v13, 4, v11
    v_mfma_f32_16x16x32_bf16 v[144:147], v[52:55], v[32:35], v[144:147]
    v_lshl_add_u32 v22, v13, 4, v9
    v_mfma_f32_16x16x32_bf16 v[140:143], v[52:55], v[28:31], v[140:143]
    v_xor_b32 v13, 6, v11
    v_mfma_f32_16x16x32_bf16 v[136:139], v[52:55], v[24:27], v[136:139]
    s_waitcnt lgkmcnt(6)
    s_barrier
    v_mfma_f32_16x16x32_bf16 v[88:91], v[72:75], v[56:59], v[88:91]
    ds_read_b64_tr_b16 v[40:41], v3 offset:32768
    v_mfma_f32_16x16x32_bf16 v[92:95], v[72:75], v[60:63], v[92:95]
    ds_read_b64_tr_b16 v[42:43], v3 offset:34816
    v_mfma_f32_16x16x32_bf16 v[96:99], v[72:75], v[64:67], v[96:99]
    ds_read_b128 v[24:27], v2 offset:32768
    v_mfma_f32_16x16x32_bf16 v[100:103], v[72:75], v[68:71], v[100:103]
    ds_read_b128 v[28:31], v2 offset:33024
    s_waitcnt lgkmcnt(8)
    v_mfma_f32_16x16x32_bf16 v[116:119], v[76:79], v[68:71], v[116:119]
    ds_read_b128 v[32:35], v2 offset:36864
    v_mfma_f32_16x16x32_bf16 v[112:115], v[76:79], v[64:67], v[112:115]
    ds_read_b128 v[36:39], v2 offset:37120
    v_mfma_f32_16x16x32_bf16 v[108:111], v[76:79], v[60:63], v[108:111]
    ds_read_b64_tr_b16 v[44:45], v4 offset:32768
    v_mfma_f32_16x16x32_bf16 v[104:107], v[76:79], v[56:59], v[104:107]
    ds_read_b64_tr_b16 v[46:47], v4 offset:34816
    s_waitcnt lgkmcnt(10)
    v_mfma_f32_16x16x32_bf16 v[120:123], v[80:83], v[56:59], v[120:123]
    ds_read_b64_tr_b16 v[48:49], v3 offset:33024
    v_mfma_f32_16x16x32_bf16 v[124:127], v[80:83], v[60:63], v[124:127]
    ds_read_b64_tr_b16 v[50:51], v3 offset:35072
    v_mfma_f32_16x16x32_bf16 v[128:131], v[80:83], v[64:67], v[128:131]
    ds_read_b64_tr_b16 v[52:53], v4 offset:33024
    v_mfma_f32_16x16x32_bf16 v[132:135], v[80:83], v[68:71], v[132:135]
    ds_read_b64_tr_b16 v[54:55], v4 offset:35072
    s_waitcnt lgkmcnt(12)
    v_mfma_f32_16x16x32_bf16 v[148:151], v[84:87], v[68:71], v[148:151]
    v_mfma_f32_16x16x32_bf16 v[144:147], v[84:87], v[64:67], v[144:147]
    v_mfma_f32_16x16x32_bf16 v[140:143], v[84:87], v[60:63], v[140:143]
    v_mfma_f32_16x16x32_bf16 v[136:139], v[84:87], v[56:59], v[136:139]
    s_waitcnt lgkmcnt(6)
    v_mfma_f32_16x16x32_bf16 v[88:91], v[40:43], v[24:27], v[88:91]
    ds_read_b64_tr_b16 v[72:73], v3 offset:40960
    v_mfma_f32_16x16x32_bf16 v[92:95], v[40:43], v[28:31], v[92:95]
    ds_read_b64_tr_b16 v[74:75], v3 offset:43008
    v_mfma_f32_16x16x32_bf16 v[96:99], v[40:43], v[32:35], v[96:99]
    ds_read_b128 v[56:59], v2 offset:34816
    v_mfma_f32_16x16x32_bf16 v[100:103], v[40:43], v[36:39], v[100:103]
    ds_read_b128 v[60:63], v2 offset:35072
    s_waitcnt lgkmcnt(8)
    v_mfma_f32_16x16x32_bf16 v[116:119], v[44:47], v[36:39], v[116:119]
    ds_read_b128 v[64:67], v2 offset:38912
    v_mfma_f32_16x16x32_bf16 v[112:115], v[44:47], v[32:35], v[112:115]
    ds_read_b128 v[68:71], v2 offset:39168
    v_mfma_f32_16x16x32_bf16 v[108:111], v[44:47], v[28:31], v[108:111]
    ds_read_b64_tr_b16 v[76:77], v4 offset:40960
    v_mfma_f32_16x16x32_bf16 v[104:107], v[44:47], v[24:27], v[104:107]
    ds_read_b64_tr_b16 v[78:79], v4 offset:43008
    s_waitcnt lgkmcnt(10)
    v_mfma_f32_16x16x32_bf16 v[120:123], v[48:51], v[24:27], v[120:123]
    ds_read_b64_tr_b16 v[80:81], v3 offset:41216
    v_mfma_f32_16x16x32_bf16 v[124:127], v[48:51], v[28:31], v[124:127]
    ds_read_b64_tr_b16 v[82:83], v3 offset:43264
    v_mfma_f32_16x16x32_bf16 v[128:131], v[48:51], v[32:35], v[128:131]
    ds_read_b64_tr_b16 v[84:85], v4 offset:41216
    v_mfma_f32_16x16x32_bf16 v[132:135], v[48:51], v[36:39], v[132:135]
    ds_read_b64_tr_b16 v[86:87], v4 offset:43264
    s_waitcnt lgkmcnt(12)
    v_mfma_f32_16x16x32_bf16 v[148:151], v[52:55], v[36:39], v[148:151]
    v_lshl_add_u32 v23, v13, 4, v9
    v_mfma_f32_16x16x32_bf16 v[144:147], v[52:55], v[32:35], v[144:147]
    v_lshrrev_b32 v11, 3, v0
    v_mfma_f32_16x16x32_bf16 v[140:143], v[52:55], v[28:31], v[140:143]
    v_xor_b32 v13, v11, v12
    v_mfma_f32_16x16x32_bf16 v[136:139], v[52:55], v[24:27], v[136:139]
    s_waitcnt lgkmcnt(6)
    s_barrier
    v_mfma_f32_16x16x32_bf16 v[88:91], v[72:75], v[56:59], v[88:91]
    ds_read_b64_tr_b16 v[40:41], v3 offset:49152
    v_mfma_f32_16x16x32_bf16 v[92:95], v[72:75], v[60:63], v[92:95]
    ds_read_b64_tr_b16 v[42:43], v3 offset:51200
    v_mfma_f32_16x16x32_bf16 v[96:99], v[72:75], v[64:67], v[96:99]
    ds_read_b128 v[24:27], v2 offset:49152
    v_mfma_f32_16x16x32_bf16 v[100:103], v[72:75], v[68:71], v[100:103]
    ds_read_b128 v[28:31], v2 offset:49408
    s_waitcnt lgkmcnt(8)
    v_mfma_f32_16x16x32_bf16 v[116:119], v[76:79], v[68:71], v[116:119]
    ds_read_b128 v[32:35], v2 offset:53248
    v_mfma_f32_16x16x32_bf16 v[112:115], v[76:79], v[64:67], v[112:115]
    ds_read_b128 v[36:39], v2 offset:53504
    v_mfma_f32_16x16x32_bf16 v[108:111], v[76:79], v[60:63], v[108:111]
    ds_read_b64_tr_b16 v[44:45], v4 offset:49152
    v_mfma_f32_16x16x32_bf16 v[104:107], v[76:79], v[56:59], v[104:107]
    ds_read_b64_tr_b16 v[46:47], v4 offset:51200
    s_waitcnt lgkmcnt(10)
    v_mfma_f32_16x16x32_bf16 v[120:123], v[80:83], v[56:59], v[120:123]
    ds_read_b64_tr_b16 v[48:49], v3 offset:49408
    v_mfma_f32_16x16x32_bf16 v[124:127], v[80:83], v[60:63], v[124:127]
    ds_read_b64_tr_b16 v[50:51], v3 offset:51456
    v_mfma_f32_16x16x32_bf16 v[128:131], v[80:83], v[64:67], v[128:131]
    ds_read_b64_tr_b16 v[52:53], v4 offset:49408
    v_mfma_f32_16x16x32_bf16 v[132:135], v[80:83], v[68:71], v[132:135]
    ds_read_b64_tr_b16 v[54:55], v4 offset:51456
    s_waitcnt lgkmcnt(12)
    v_mfma_f32_16x16x32_bf16 v[148:151], v[84:87], v[68:71], v[148:151]
    v_mfma_f32_16x16x32_bf16 v[144:147], v[84:87], v[64:67], v[144:147]
    v_mfma_f32_16x16x32_bf16 v[140:143], v[84:87], v[60:63], v[140:143]
    v_mfma_f32_16x16x32_bf16 v[136:139], v[84:87], v[56:59], v[136:139]
    s_waitcnt lgkmcnt(6)
    v_mfma_f32_16x16x32_bf16 v[88:91], v[40:43], v[24:27], v[88:91]
    ds_read_b64_tr_b16 v[72:73], v3 offset:57344
    v_mfma_f32_16x16x32_bf16 v[92:95], v[40:43], v[28:31], v[92:95]
    ds_read_b64_tr_b16 v[74:75], v3 offset:59392
    v_mfma_f32_16x16x32_bf16 v[96:99], v[40:43], v[32:35], v[96:99]
    ds_read_b128 v[56:59], v2 offset:51200
    v_mfma_f32_16x16x32_bf16 v[100:103], v[40:43], v[36:39], v[100:103]
    ds_read_b128 v[60:63], v2 offset:51456
    s_waitcnt lgkmcnt(8)
    v_mfma_f32_16x16x32_bf16 v[116:119], v[44:47], v[36:39], v[116:119]
    ds_read_b128 v[64:67], v2 offset:55296
    v_mfma_f32_16x16x32_bf16 v[112:115], v[44:47], v[32:35], v[112:115]
    ds_read_b128 v[68:71], v2 offset:55552
    v_mfma_f32_16x16x32_bf16 v[108:111], v[44:47], v[28:31], v[108:111]
    ds_read_b64_tr_b16 v[76:77], v4 offset:57344
    v_mfma_f32_16x16x32_bf16 v[104:107], v[44:47], v[24:27], v[104:107]
    ds_read_b64_tr_b16 v[78:79], v4 offset:59392
    s_waitcnt lgkmcnt(10)
    v_mfma_f32_16x16x32_bf16 v[120:123], v[48:51], v[24:27], v[120:123]
    ds_read_b64_tr_b16 v[80:81], v3 offset:57600
    v_mfma_f32_16x16x32_bf16 v[124:127], v[48:51], v[28:31], v[124:127]
    ds_read_b64_tr_b16 v[82:83], v3 offset:59648
    v_mfma_f32_16x16x32_bf16 v[128:131], v[48:51], v[32:35], v[128:131]
    ds_read_b64_tr_b16 v[84:85], v4 offset:57600
    v_mfma_f32_16x16x32_bf16 v[132:135], v[48:51], v[36:39], v[132:135]
    ds_read_b64_tr_b16 v[86:87], v4 offset:59648
    s_waitcnt lgkmcnt(12)
    v_mfma_f32_16x16x32_bf16 v[148:151], v[52:55], v[36:39], v[148:151]
    v_lshlrev_b32 v5, 7, v11
    v_mfma_f32_16x16x32_bf16 v[144:147], v[52:55], v[32:35], v[144:147]
    v_lshl_add_u32 v5, v13, 4, v5
    v_mfma_f32_16x16x32_bf16 v[140:143], v[52:55], v[28:31], v[140:143]
    v_add_u32 v5, s5, v5
    v_mfma_f32_16x16x32_bf16 v[136:139], v[52:55], v[24:27], v[136:139]
    s_waitcnt lgkmcnt(6)
    s_barrier
    v_mfma_f32_16x16x32_bf16 v[88:91], v[72:75], v[56:59], v[88:91]
    ds_read_b64_tr_b16 v[40:41], v3 offset:0
    v_mfma_f32_16x16x32_bf16 v[92:95], v[72:75], v[60:63], v[92:95]
    ds_read_b64_tr_b16 v[42:43], v3 offset:2048
    v_mfma_f32_16x16x32_bf16 v[96:99], v[72:75], v[64:67], v[96:99]
    ds_read_b128 v[24:27], v2 offset:0
    v_mfma_f32_16x16x32_bf16 v[100:103], v[72:75], v[68:71], v[100:103]
    ds_read_b128 v[28:31], v2 offset:256
    s_waitcnt lgkmcnt(8)
    v_mfma_f32_16x16x32_bf16 v[116:119], v[76:79], v[68:71], v[116:119]
    ds_read_b128 v[32:35], v2 offset:4096
    v_mfma_f32_16x16x32_bf16 v[112:115], v[76:79], v[64:67], v[112:115]
    ds_read_b128 v[36:39], v2 offset:4352
    v_mfma_f32_16x16x32_bf16 v[108:111], v[76:79], v[60:63], v[108:111]
    ds_read_b64_tr_b16 v[44:45], v4 offset:0
    v_mfma_f32_16x16x32_bf16 v[104:107], v[76:79], v[56:59], v[104:107]
    ds_read_b64_tr_b16 v[46:47], v4 offset:2048
    s_waitcnt lgkmcnt(10)
    v_mfma_f32_16x16x32_bf16 v[120:123], v[80:83], v[56:59], v[120:123]
    ds_read_b64_tr_b16 v[48:49], v3 offset:256
    v_mfma_f32_16x16x32_bf16 v[124:127], v[80:83], v[60:63], v[124:127]
    ds_read_b64_tr_b16 v[50:51], v3 offset:2304
    v_mfma_f32_16x16x32_bf16 v[128:131], v[80:83], v[64:67], v[128:131]
    ds_read_b64_tr_b16 v[52:53], v4 offset:256
    v_mfma_f32_16x16x32_bf16 v[132:135], v[80:83], v[68:71], v[132:135]
    ds_read_b64_tr_b16 v[54:55], v4 offset:2304
    s_waitcnt lgkmcnt(12)
    v_mfma_f32_16x16x32_bf16 v[148:151], v[84:87], v[68:71], v[148:151]
    v_mfma_f32_16x16x32_bf16 v[144:147], v[84:87], v[64:67], v[144:147]
    v_mfma_f32_16x16x32_bf16 v[140:143], v[84:87], v[60:63], v[140:143]
    v_mfma_f32_16x16x32_bf16 v[136:139], v[84:87], v[56:59], v[136:139]
    s_waitcnt lgkmcnt(6)
    v_mfma_f32_16x16x32_bf16 v[88:91], v[40:43], v[24:27], v[88:91]
    ds_read_b64_tr_b16 v[72:73], v3 offset:8192
    v_mfma_f32_16x16x32_bf16 v[92:95], v[40:43], v[28:31], v[92:95]
    ds_read_b64_tr_b16 v[74:75], v3 offset:10240
    v_mfma_f32_16x16x32_bf16 v[96:99], v[40:43], v[32:35], v[96:99]
    ds_read_b128 v[56:59], v2 offset:2048
    v_mfma_f32_16x16x32_bf16 v[100:103], v[40:43], v[36:39], v[100:103]
    ds_read_b128 v[60:63], v2 offset:2304
    s_waitcnt lgkmcnt(8)
    v_mfma_f32_16x16x32_bf16 v[116:119], v[44:47], v[36:39], v[116:119]
    ds_read_b128 v[64:67], v2 offset:6144
    v_mfma_f32_16x16x32_bf16 v[112:115], v[44:47], v[32:35], v[112:115]
    ds_read_b128 v[68:71], v2 offset:6400
    v_mfma_f32_16x16x32_bf16 v[108:111], v[44:47], v[28:31], v[108:111]
    ds_read_b64_tr_b16 v[76:77], v4 offset:8192
    v_mfma_f32_16x16x32_bf16 v[104:107], v[44:47], v[24:27], v[104:107]
    ds_read_b64_tr_b16 v[78:79], v4 offset:10240
    s_waitcnt lgkmcnt(10)
    v_mfma_f32_16x16x32_bf16 v[120:123], v[48:51], v[24:27], v[120:123]
    ds_read_b64_tr_b16 v[80:81], v3 offset:8448
    v_mfma_f32_16x16x32_bf16 v[124:127], v[48:51], v[28:31], v[124:127]
    ds_read_b64_tr_b16 v[82:83], v3 offset:10496
    v_mfma_f32_16x16x32_bf16 v[128:131], v[48:51], v[32:35], v[128:131]
    ds_read_b64_tr_b16 v[84:85], v4 offset:8448
    v_mfma_f32_16x16x32_bf16 v[132:135], v[48:51], v[36:39], v[132:135]
    ds_read_b64_tr_b16 v[86:87], v4 offset:10496
    s_waitcnt lgkmcnt(12)
    v_mfma_f32_16x16x32_bf16 v[148:151], v[52:55], v[36:39], v[148:151]
    v_lshlrev_b32 v6, 12, v11
    v_mfma_f32_16x16x32_bf16 v[144:147], v[52:55], v[32:35], v[144:147]
    v_lshl_add_u32 v6, v12, 4, v6
    v_mfma_f32_16x16x32_bf16 v[140:143], v[52:55], v[28:31], v[140:143]
    s_bfe_u32 s46, s10, 0x80008
    v_mfma_f32_16x16x32_bf16 v[136:139], v[52:55], v[24:27], v[136:139]
    s_waitcnt lgkmcnt(6)
    s_barrier
    v_mfma_f32_16x16x32_bf16 v[88:91], v[72:75], v[56:59], v[88:91]
    ds_read_b64_tr_b16 v[40:41], v3 offset:16384
    v_mfma_f32_16x16x32_bf16 v[92:95], v[72:75], v[60:63], v[92:95]
    ds_read_b64_tr_b16 v[42:43], v3 offset:18432
    v_mfma_f32_16x16x32_bf16 v[96:99], v[72:75], v[64:67], v[96:99]
    ds_read_b128 v[24:27], v2 offset:16384
    v_mfma_f32_16x16x32_bf16 v[100:103], v[72:75], v[68:71], v[100:103]
    ds_read_b128 v[28:31], v2 offset:16640
    s_waitcnt lgkmcnt(8)
    v_mfma_f32_16x16x32_bf16 v[116:119], v[76:79], v[68:71], v[116:119]
    ds_read_b128 v[32:35], v2 offset:20480
    v_mfma_f32_16x16x32_bf16 v[112:115], v[76:79], v[64:67], v[112:115]
    ds_read_b128 v[36:39], v2 offset:20736
    v_mfma_f32_16x16x32_bf16 v[108:111], v[76:79], v[60:63], v[108:111]
    ds_read_b64_tr_b16 v[44:45], v4 offset:16384
    v_mfma_f32_16x16x32_bf16 v[104:107], v[76:79], v[56:59], v[104:107]
    ds_read_b64_tr_b16 v[46:47], v4 offset:18432
    s_waitcnt lgkmcnt(10)
    v_mfma_f32_16x16x32_bf16 v[120:123], v[80:83], v[56:59], v[120:123]
    ds_read_b64_tr_b16 v[48:49], v3 offset:16640
    v_mfma_f32_16x16x32_bf16 v[124:127], v[80:83], v[60:63], v[124:127]
    ds_read_b64_tr_b16 v[50:51], v3 offset:18688
    v_mfma_f32_16x16x32_bf16 v[128:131], v[80:83], v[64:67], v[128:131]
    ds_read_b64_tr_b16 v[52:53], v4 offset:16640
    v_mfma_f32_16x16x32_bf16 v[132:135], v[80:83], v[68:71], v[132:135]
    ds_read_b64_tr_b16 v[54:55], v4 offset:18688
    s_waitcnt lgkmcnt(12)
    v_mfma_f32_16x16x32_bf16 v[148:151], v[84:87], v[68:71], v[148:151]
    v_mfma_f32_16x16x32_bf16 v[144:147], v[84:87], v[64:67], v[144:147]
    v_mfma_f32_16x16x32_bf16 v[140:143], v[84:87], v[60:63], v[140:143]
    v_mfma_f32_16x16x32_bf16 v[136:139], v[84:87], v[56:59], v[136:139]
    s_waitcnt lgkmcnt(6)
    v_mfma_f32_16x16x32_bf16 v[88:91], v[40:43], v[24:27], v[88:91]
    ds_read_b64_tr_b16 v[72:73], v3 offset:24576
    v_mfma_f32_16x16x32_bf16 v[92:95], v[40:43], v[28:31], v[92:95]
    ds_read_b64_tr_b16 v[74:75], v3 offset:26624
    v_mfma_f32_16x16x32_bf16 v[96:99], v[40:43], v[32:35], v[96:99]
    ds_read_b128 v[56:59], v2 offset:18432
    v_mfma_f32_16x16x32_bf16 v[100:103], v[40:43], v[36:39], v[100:103]
    ds_read_b128 v[60:63], v2 offset:18688
    s_waitcnt lgkmcnt(8)
    v_mfma_f32_16x16x32_bf16 v[116:119], v[44:47], v[36:39], v[116:119]
    ds_read_b128 v[64:67], v2 offset:22528
    v_mfma_f32_16x16x32_bf16 v[112:115], v[44:47], v[32:35], v[112:115]
    ds_read_b128 v[68:71], v2 offset:22784
    v_mfma_f32_16x16x32_bf16 v[108:111], v[44:47], v[28:31], v[108:111]
    ds_read_b64_tr_b16 v[76:77], v4 offset:24576
    v_mfma_f32_16x16x32_bf16 v[104:107], v[44:47], v[24:27], v[104:107]
    ds_read_b64_tr_b16 v[78:79], v4 offset:26624
    s_waitcnt lgkmcnt(10)
    v_mfma_f32_16x16x32_bf16 v[120:123], v[48:51], v[24:27], v[120:123]
    ds_read_b64_tr_b16 v[80:81], v3 offset:24832
    v_mfma_f32_16x16x32_bf16 v[124:127], v[48:51], v[28:31], v[124:127]
    ds_read_b64_tr_b16 v[82:83], v3 offset:26880
    v_mfma_f32_16x16x32_bf16 v[128:131], v[48:51], v[32:35], v[128:131]
    ds_read_b64_tr_b16 v[84:85], v4 offset:24832
    v_mfma_f32_16x16x32_bf16 v[132:135], v[48:51], v[36:39], v[132:135]
    ds_read_b64_tr_b16 v[86:87], v4 offset:26880
    s_waitcnt lgkmcnt(12)
    v_mfma_f32_16x16x32_bf16 v[148:151], v[52:55], v[36:39], v[148:151]
    s_lshl_b32 s46, s46, 7
    v_mfma_f32_16x16x32_bf16 v[144:147], v[52:55], v[32:35], v[144:147]
    s_lshl_b32 s5, s3, 6
    v_mfma_f32_16x16x32_bf16 v[140:143], v[52:55], v[28:31], v[140:143]
    s_add_u32 s46, s46, s5
    v_mfma_f32_16x16x32_bf16 v[136:139], v[52:55], v[24:27], v[136:139]
    s_waitcnt lgkmcnt(6)
    s_barrier
    v_mfma_f32_16x16x32_bf16 v[88:91], v[72:75], v[56:59], v[88:91]
    ds_read_b64_tr_b16 v[40:41], v3 offset:32768
    v_mfma_f32_16x16x32_bf16 v[92:95], v[72:75], v[60:63], v[92:95]
    ds_read_b64_tr_b16 v[42:43], v3 offset:34816
    v_mfma_f32_16x16x32_bf16 v[96:99], v[72:75], v[64:67], v[96:99]
    ds_read_b128 v[24:27], v2 offset:32768
    v_mfma_f32_16x16x32_bf16 v[100:103], v[72:75], v[68:71], v[100:103]
    ds_read_b128 v[28:31], v2 offset:33024
    s_waitcnt lgkmcnt(8)
    v_mfma_f32_16x16x32_bf16 v[116:119], v[76:79], v[68:71], v[116:119]
    ds_read_b128 v[32:35], v2 offset:36864
    v_mfma_f32_16x16x32_bf16 v[112:115], v[76:79], v[64:67], v[112:115]
    ds_read_b128 v[36:39], v2 offset:37120
    v_mfma_f32_16x16x32_bf16 v[108:111], v[76:79], v[60:63], v[108:111]
    ds_read_b64_tr_b16 v[44:45], v4 offset:32768
    v_mfma_f32_16x16x32_bf16 v[104:107], v[76:79], v[56:59], v[104:107]
    ds_read_b64_tr_b16 v[46:47], v4 offset:34816
    s_waitcnt lgkmcnt(10)
    v_mfma_f32_16x16x32_bf16 v[120:123], v[80:83], v[56:59], v[120:123]
    ds_read_b64_tr_b16 v[48:49], v3 offset:33024
    v_mfma_f32_16x16x32_bf16 v[124:127], v[80:83], v[60:63], v[124:127]
    ds_read_b64_tr_b16 v[50:51], v3 offset:35072
    v_mfma_f32_16x16x32_bf16 v[128:131], v[80:83], v[64:67], v[128:131]
    ds_read_b64_tr_b16 v[52:53], v4 offset:33024
    v_mfma_f32_16x16x32_bf16 v[132:135], v[80:83], v[68:71], v[132:135]
    ds_read_b64_tr_b16 v[54:55], v4 offset:35072
    s_waitcnt lgkmcnt(12)
    v_mfma_f32_16x16x32_bf16 v[148:151], v[84:87], v[68:71], v[148:151]
    v_mfma_f32_16x16x32_bf16 v[144:147], v[84:87], v[64:67], v[144:147]
    v_mfma_f32_16x16x32_bf16 v[140:143], v[84:87], v[60:63], v[140:143]
    v_mfma_f32_16x16x32_bf16 v[136:139], v[84:87], v[56:59], v[136:139]
    s_waitcnt lgkmcnt(6)
    v_mfma_f32_16x16x32_bf16 v[88:91], v[40:43], v[24:27], v[88:91]
    ds_read_b64_tr_b16 v[72:73], v3 offset:40960
    v_mfma_f32_16x16x32_bf16 v[92:95], v[40:43], v[28:31], v[92:95]
    ds_read_b64_tr_b16 v[74:75], v3 offset:43008
    v_mfma_f32_16x16x32_bf16 v[96:99], v[40:43], v[32:35], v[96:99]
    ds_read_b128 v[56:59], v2 offset:34816
    v_mfma_f32_16x16x32_bf16 v[100:103], v[40:43], v[36:39], v[100:103]
    ds_read_b128 v[60:63], v2 offset:35072
    s_waitcnt lgkmcnt(8)
    v_mfma_f32_16x16x32_bf16 v[116:119], v[44:47], v[36:39], v[116:119]
    ds_read_b128 v[64:67], v2 offset:38912
    v_mfma_f32_16x16x32_bf16 v[112:115], v[44:47], v[32:35], v[112:115]
    ds_read_b128 v[68:71], v2 offset:39168
    v_mfma_f32_16x16x32_bf16 v[108:111], v[44:47], v[28:31], v[108:111]
    ds_read_b64_tr_b16 v[76:77], v4 offset:40960
    v_mfma_f32_16x16x32_bf16 v[104:107], v[44:47], v[24:27], v[104:107]
    ds_read_b64_tr_b16 v[78:79], v4 offset:43008
    s_waitcnt lgkmcnt(10)
    v_mfma_f32_16x16x32_bf16 v[120:123], v[48:51], v[24:27], v[120:123]
    ds_read_b64_tr_b16 v[80:81], v3 offset:41216
    v_mfma_f32_16x16x32_bf16 v[124:127], v[48:51], v[28:31], v[124:127]
    ds_read_b64_tr_b16 v[82:83], v3 offset:43264
    v_mfma_f32_16x16x32_bf16 v[128:131], v[48:51], v[32:35], v[128:131]
    ds_read_b64_tr_b16 v[84:85], v4 offset:41216
    v_mfma_f32_16x16x32_bf16 v[132:135], v[48:51], v[36:39], v[132:135]
    ds_read_b64_tr_b16 v[86:87], v4 offset:43264
    s_waitcnt lgkmcnt(12)
    v_mfma_f32_16x16x32_bf16 v[148:151], v[52:55], v[36:39], v[148:151]
    s_lshl_b32 s46, s46, 12
    v_mfma_f32_16x16x32_bf16 v[144:147], v[52:55], v[32:35], v[144:147]
    s_lshr_b32 s5, s10, 16
    v_mfma_f32_16x16x32_bf16 v[140:143], v[52:55], v[28:31], v[140:143]
    s_lshl_b32 s5, s5, 11
    v_mfma_f32_16x16x32_bf16 v[136:139], v[52:55], v[24:27], v[136:139]
    s_waitcnt lgkmcnt(6)
    s_barrier
    v_mfma_f32_16x16x32_bf16 v[88:91], v[72:75], v[56:59], v[88:91]
    ds_read_b64_tr_b16 v[40:41], v3 offset:49152
    v_mfma_f32_16x16x32_bf16 v[92:95], v[72:75], v[60:63], v[92:95]
    ds_read_b64_tr_b16 v[42:43], v3 offset:51200
    v_mfma_f32_16x16x32_bf16 v[96:99], v[72:75], v[64:67], v[96:99]
    ds_read_b128 v[24:27], v2 offset:49152
    v_mfma_f32_16x16x32_bf16 v[100:103], v[72:75], v[68:71], v[100:103]
    ds_read_b128 v[28:31], v2 offset:49408
    s_waitcnt lgkmcnt(8)
    v_mfma_f32_16x16x32_bf16 v[116:119], v[76:79], v[68:71], v[116:119]
    ds_read_b128 v[32:35], v2 offset:53248
    v_mfma_f32_16x16x32_bf16 v[112:115], v[76:79], v[64:67], v[112:115]
    ds_read_b128 v[36:39], v2 offset:53504
    v_mfma_f32_16x16x32_bf16 v[108:111], v[76:79], v[60:63], v[108:111]
    ds_read_b64_tr_b16 v[44:45], v4 offset:49152
    v_mfma_f32_16x16x32_bf16 v[104:107], v[76:79], v[56:59], v[104:107]
    ds_read_b64_tr_b16 v[46:47], v4 offset:51200
    s_waitcnt lgkmcnt(10)
    v_mfma_f32_16x16x32_bf16 v[120:123], v[80:83], v[56:59], v[120:123]
    ds_read_b64_tr_b16 v[48:49], v3 offset:49408
    v_mfma_f32_16x16x32_bf16 v[124:127], v[80:83], v[60:63], v[124:127]
    ds_read_b64_tr_b16 v[50:51], v3 offset:51456
    v_mfma_f32_16x16x32_bf16 v[128:131], v[80:83], v[64:67], v[128:131]
    ds_read_b64_tr_b16 v[52:53], v4 offset:49408
    v_mfma_f32_16x16x32_bf16 v[132:135], v[80:83], v[68:71], v[132:135]
    ds_read_b64_tr_b16 v[54:55], v4 offset:51456
    s_waitcnt lgkmcnt(12)
    v_mfma_f32_16x16x32_bf16 v[148:151], v[84:87], v[68:71], v[148:151]
    v_mfma_f32_16x16x32_bf16 v[144:147], v[84:87], v[64:67], v[144:147]
    v_mfma_f32_16x16x32_bf16 v[140:143], v[84:87], v[60:63], v[140:143]
    v_mfma_f32_16x16x32_bf16 v[136:139], v[84:87], v[56:59], v[136:139]
    s_waitcnt lgkmcnt(6)
    v_mfma_f32_16x16x32_bf16 v[88:91], v[40:43], v[24:27], v[88:91]
    ds_read_b64_tr_b16 v[72:73], v3 offset:57344
    v_mfma_f32_16x16x32_bf16 v[92:95], v[40:43], v[28:31], v[92:95]
    ds_read_b64_tr_b16 v[74:75], v3 offset:59392
    v_mfma_f32_16x16x32_bf16 v[96:99], v[40:43], v[32:35], v[96:99]
    ds_read_b128 v[56:59], v2 offset:51200
    v_mfma_f32_16x16x32_bf16 v[100:103], v[40:43], v[36:39], v[100:103]
    ds_read_b128 v[60:63], v2 offset:51456
    s_waitcnt lgkmcnt(8)
    v_mfma_f32_16x16x32_bf16 v[116:119], v[44:47], v[36:39], v[116:119]
    ds_read_b128 v[64:67], v2 offset:55296
    v_mfma_f32_16x16x32_bf16 v[112:115], v[44:47], v[32:35], v[112:115]
    ds_read_b128 v[68:71], v2 offset:55552
    v_mfma_f32_16x16x32_bf16 v[108:111], v[44:47], v[28:31], v[108:111]
    ds_read_b64_tr_b16 v[76:77], v4 offset:57344
    v_mfma_f32_16x16x32_bf16 v[104:107], v[44:47], v[24:27], v[104:107]
    ds_read_b64_tr_b16 v[78:79], v4 offset:59392
    s_waitcnt lgkmcnt(10)
    v_mfma_f32_16x16x32_bf16 v[120:123], v[48:51], v[24:27], v[120:123]
    ds_read_b64_tr_b16 v[80:81], v3 offset:57600
    v_mfma_f32_16x16x32_bf16 v[124:127], v[48:51], v[28:31], v[124:127]
    ds_read_b64_tr_b16 v[82:83], v3 offset:59648
    v_mfma_f32_16x16x32_bf16 v[128:131], v[48:51], v[32:35], v[128:131]
    ds_read_b64_tr_b16 v[84:85], v4 offset:57600
    v_mfma_f32_16x16x32_bf16 v[132:135], v[48:51], v[36:39], v[132:135]
    ds_read_b64_tr_b16 v[86:87], v4 offset:59648
    s_waitcnt lgkmcnt(12)
    v_mfma_f32_16x16x32_bf16 v[148:151], v[52:55], v[36:39], v[148:151]
    s_add_u32 s46, s46, s5
    v_mfma_f32_16x16x32_bf16 v[144:147], v[52:55], v[32:35], v[144:147]
    s_and_b32 s5, s10, 255
    v_mfma_f32_16x16x32_bf16 v[140:143], v[52:55], v[28:31], v[140:143]
    s_lshl_b32 s5, s5, 8
    v_mfma_f32_16x16x32_bf16 v[136:139], v[52:55], v[24:27], v[136:139]
    s_waitcnt lgkmcnt(6)
    s_barrier
    v_mfma_f32_16x16x32_bf16 v[88:91], v[72:75], v[56:59], v[88:91]
    ds_read_b64_tr_b16 v[40:41], v3 offset:0
    v_mfma_f32_16x16x32_bf16 v[92:95], v[72:75], v[60:63], v[92:95]
    ds_read_b64_tr_b16 v[42:43], v3 offset:2048
    v_mfma_f32_16x16x32_bf16 v[96:99], v[72:75], v[64:67], v[96:99]
    ds_read_b128 v[24:27], v2 offset:0
    v_mfma_f32_16x16x32_bf16 v[100:103], v[72:75], v[68:71], v[100:103]
    ds_read_b128 v[28:31], v2 offset:256
    s_waitcnt lgkmcnt(8)
    v_mfma_f32_16x16x32_bf16 v[116:119], v[76:79], v[68:71], v[116:119]
    ds_read_b128 v[32:35], v2 offset:4096
    v_mfma_f32_16x16x32_bf16 v[112:115], v[76:79], v[64:67], v[112:115]
    ds_read_b128 v[36:39], v2 offset:4352
    v_mfma_f32_16x16x32_bf16 v[108:111], v[76:79], v[60:63], v[108:111]
    ds_read_b64_tr_b16 v[44:45], v4 offset:0
    v_mfma_f32_16x16x32_bf16 v[104:107], v[76:79], v[56:59], v[104:107]
    ds_read_b64_tr_b16 v[46:47], v4 offset:2048
    s_waitcnt lgkmcnt(10)
    v_mfma_f32_16x16x32_bf16 v[120:123], v[80:83], v[56:59], v[120:123]
    ds_read_b64_tr_b16 v[48:49], v3 offset:256
    v_mfma_f32_16x16x32_bf16 v[124:127], v[80:83], v[60:63], v[124:127]
    ds_read_b64_tr_b16 v[50:51], v3 offset:2304
    v_mfma_f32_16x16x32_bf16 v[128:131], v[80:83], v[64:67], v[128:131]
    ds_read_b64_tr_b16 v[52:53], v4 offset:256
    v_mfma_f32_16x16x32_bf16 v[132:135], v[80:83], v[68:71], v[132:135]
    ds_read_b64_tr_b16 v[54:55], v4 offset:2304
    s_waitcnt lgkmcnt(12)
    v_mfma_f32_16x16x32_bf16 v[148:151], v[84:87], v[68:71], v[148:151]
    v_mfma_f32_16x16x32_bf16 v[144:147], v[84:87], v[64:67], v[144:147]
    v_mfma_f32_16x16x32_bf16 v[140:143], v[84:87], v[60:63], v[140:143]
    v_mfma_f32_16x16x32_bf16 v[136:139], v[84:87], v[56:59], v[136:139]
    s_waitcnt lgkmcnt(6)
    v_mfma_f32_16x16x32_bf16 v[88:91], v[40:43], v[24:27], v[88:91]
    ds_read_b64_tr_b16 v[72:73], v3 offset:8192
    v_mfma_f32_16x16x32_bf16 v[92:95], v[40:43], v[28:31], v[92:95]
    ds_read_b64_tr_b16 v[74:75], v3 offset:10240
    v_mfma_f32_16x16x32_bf16 v[96:99], v[40:43], v[32:35], v[96:99]
    ds_read_b128 v[56:59], v2 offset:2048
    v_mfma_f32_16x16x32_bf16 v[100:103], v[40:43], v[36:39], v[100:103]
    ds_read_b128 v[60:63], v2 offset:2304
    s_waitcnt lgkmcnt(8)
    v_mfma_f32_16x16x32_bf16 v[116:119], v[44:47], v[36:39], v[116:119]
    ds_read_b128 v[64:67], v2 offset:6144
    v_mfma_f32_16x16x32_bf16 v[112:115], v[44:47], v[32:35], v[112:115]
    ds_read_b128 v[68:71], v2 offset:6400
    v_mfma_f32_16x16x32_bf16 v[108:111], v[44:47], v[28:31], v[108:111]
    ds_read_b64_tr_b16 v[76:77], v4 offset:8192
    v_mfma_f32_16x16x32_bf16 v[104:107], v[44:47], v[24:27], v[104:107]
    ds_read_b64_tr_b16 v[78:79], v4 offset:10240
    s_waitcnt lgkmcnt(10)
    v_mfma_f32_16x16x32_bf16 v[120:123], v[48:51], v[24:27], v[120:123]
    ds_read_b64_tr_b16 v[80:81], v3 offset:8448
    v_mfma_f32_16x16x32_bf16 v[124:127], v[48:51], v[28:31], v[124:127]
    ds_read_b64_tr_b16 v[82:83], v3 offset:10496
    v_mfma_f32_16x16x32_bf16 v[128:131], v[48:51], v[32:35], v[128:131]
    ds_read_b64_tr_b16 v[84:85], v4 offset:8448
    v_mfma_f32_16x16x32_bf16 v[132:135], v[48:51], v[36:39], v[132:135]
    ds_read_b64_tr_b16 v[86:87], v4 offset:10496
    s_waitcnt lgkmcnt(12)
    v_mfma_f32_16x16x32_bf16 v[148:151], v[52:55], v[36:39], v[148:151]
    s_add_u32 s46, s46, s5
    v_mfma_f32_16x16x32_bf16 v[144:147], v[52:55], v[32:35], v[144:147]
    s_lshl_b32 s5, s4, 7
    v_mfma_f32_16x16x32_bf16 v[140:143], v[52:55], v[28:31], v[140:143]
    s_add_u32 s46, s46, s5
    v_mfma_f32_16x16x32_bf16 v[136:139], v[52:55], v[24:27], v[136:139]
    s_waitcnt lgkmcnt(6)
    s_barrier
    v_mfma_f32_16x16x32_bf16 v[88:91], v[72:75], v[56:59], v[88:91]
    ds_read_b64_tr_b16 v[40:41], v3 offset:16384
    v_mfma_f32_16x16x32_bf16 v[92:95], v[72:75], v[60:63], v[92:95]
    ds_read_b64_tr_b16 v[42:43], v3 offset:18432
    v_mfma_f32_16x16x32_bf16 v[96:99], v[72:75], v[64:67], v[96:99]
    ds_read_b128 v[24:27], v2 offset:16384
    v_mfma_f32_16x16x32_bf16 v[100:103], v[72:75], v[68:71], v[100:103]
    ds_read_b128 v[28:31], v2 offset:16640
    s_waitcnt lgkmcnt(8)
    v_mfma_f32_16x16x32_bf16 v[116:119], v[76:79], v[68:71], v[116:119]
    ds_read_b128 v[32:35], v2 offset:20480
    v_mfma_f32_16x16x32_bf16 v[112:115], v[76:79], v[64:67], v[112:115]
    ds_read_b128 v[36:39], v2 offset:20736
    v_mfma_f32_16x16x32_bf16 v[108:111], v[76:79], v[60:63], v[108:111]
    ds_read_b64_tr_b16 v[44:45], v4 offset:16384
    v_mfma_f32_16x16x32_bf16 v[104:107], v[76:79], v[56:59], v[104:107]
    ds_read_b64_tr_b16 v[46:47], v4 offset:18432
    s_waitcnt lgkmcnt(10)
    v_mfma_f32_16x16x32_bf16 v[120:123], v[80:83], v[56:59], v[120:123]
    ds_read_b64_tr_b16 v[48:49], v3 offset:16640
    v_mfma_f32_16x16x32_bf16 v[124:127], v[80:83], v[60:63], v[124:127]
    ds_read_b64_tr_b16 v[50:51], v3 offset:18688
    v_mfma_f32_16x16x32_bf16 v[128:131], v[80:83], v[64:67], v[128:131]
    ds_read_b64_tr_b16 v[52:53], v4 offset:16640
    v_mfma_f32_16x16x32_bf16 v[132:135], v[80:83], v[68:71], v[132:135]
    ds_read_b64_tr_b16 v[54:55], v4 offset:18688
    s_waitcnt lgkmcnt(12)
    v_mfma_f32_16x16x32_bf16 v[148:151], v[84:87], v[68:71], v[148:151]
    v_mfma_f32_16x16x32_bf16 v[144:147], v[84:87], v[64:67], v[144:147]
    v_mfma_f32_16x16x32_bf16 v[140:143], v[84:87], v[60:63], v[140:143]
    v_mfma_f32_16x16x32_bf16 v[136:139], v[84:87], v[56:59], v[136:139]
    s_waitcnt lgkmcnt(6)
    v_mfma_f32_16x16x32_bf16 v[88:91], v[40:43], v[24:27], v[88:91]
    ds_read_b64_tr_b16 v[72:73], v3 offset:24576
    v_mfma_f32_16x16x32_bf16 v[92:95], v[40:43], v[28:31], v[92:95]
    ds_read_b64_tr_b16 v[74:75], v3 offset:26624
    v_mfma_f32_16x16x32_bf16 v[96:99], v[40:43], v[32:35], v[96:99]
    ds_read_b128 v[56:59], v2 offset:18432
    v_mfma_f32_16x16x32_bf16 v[100:103], v[40:43], v[36:39], v[100:103]
    ds_read_b128 v[60:63], v2 offset:18688
    s_waitcnt lgkmcnt(8)
    v_mfma_f32_16x16x32_bf16 v[116:119], v[44:47], v[36:39], v[116:119]
    ds_read_b128 v[64:67], v2 offset:22528
    v_mfma_f32_16x16x32_bf16 v[112:115], v[44:47], v[32:35], v[112:115]
    ds_read_b128 v[68:71], v2 offset:22784
    v_mfma_f32_16x16x32_bf16 v[108:111], v[44:47], v[28:31], v[108:111]
    ds_read_b64_tr_b16 v[76:77], v4 offset:24576
    v_mfma_f32_16x16x32_bf16 v[104:107], v[44:47], v[24:27], v[104:107]
    ds_read_b64_tr_b16 v[78:79], v4 offset:26624
    s_waitcnt lgkmcnt(10)
    v_mfma_f32_16x16x32_bf16 v[120:123], v[48:51], v[24:27], v[120:123]
    ds_read_b64_tr_b16 v[80:81], v3 offset:24832
    v_mfma_f32_16x16x32_bf16 v[124:127], v[48:51], v[28:31], v[124:127]
    ds_read_b64_tr_b16 v[82:83], v3 offset:26880
    v_mfma_f32_16x16x32_bf16 v[128:131], v[48:51], v[32:35], v[128:131]
    ds_read_b64_tr_b16 v[84:85], v4 offset:24832
    v_mfma_f32_16x16x32_bf16 v[132:135], v[48:51], v[36:39], v[132:135]
    ds_read_b64_tr_b16 v[86:87], v4 offset:26880
    s_waitcnt lgkmcnt(12)
    v_mfma_f32_16x16x32_bf16 v[148:151], v[52:55], v[36:39], v[148:151]
    s_mov_b32 s8, s100
    v_mfma_f32_16x16x32_bf16 v[144:147], v[52:55], v[32:35], v[144:147]
    s_mov_b32 s9, s101
    v_mfma_f32_16x16x32_bf16 v[140:143], v[52:55], v[28:31], v[140:143]
    s_mov_b32 s10, 0x800000
    v_mfma_f32_16x16x32_bf16 v[136:139], v[52:55], v[24:27], v[136:139]
    s_waitcnt lgkmcnt(6)
    s_barrier
    v_mfma_f32_16x16x32_bf16 v[88:91], v[72:75], v[56:59], v[88:91]
    ds_read_b64_tr_b16 v[40:41], v3 offset:32768
    v_mfma_f32_16x16x32_bf16 v[92:95], v[72:75], v[60:63], v[92:95]
    ds_read_b64_tr_b16 v[42:43], v3 offset:34816
    v_mfma_f32_16x16x32_bf16 v[96:99], v[72:75], v[64:67], v[96:99]
    ds_read_b128 v[24:27], v2 offset:32768
    v_mfma_f32_16x16x32_bf16 v[100:103], v[72:75], v[68:71], v[100:103]
    ds_read_b128 v[28:31], v2 offset:33024
    s_waitcnt lgkmcnt(8)
    v_mfma_f32_16x16x32_bf16 v[116:119], v[76:79], v[68:71], v[116:119]
    ds_read_b128 v[32:35], v2 offset:36864
    v_mfma_f32_16x16x32_bf16 v[112:115], v[76:79], v[64:67], v[112:115]
    ds_read_b128 v[36:39], v2 offset:37120
    v_mfma_f32_16x16x32_bf16 v[108:111], v[76:79], v[60:63], v[108:111]
    ds_read_b64_tr_b16 v[44:45], v4 offset:32768
    v_mfma_f32_16x16x32_bf16 v[104:107], v[76:79], v[56:59], v[104:107]
    ds_read_b64_tr_b16 v[46:47], v4 offset:34816
    s_waitcnt lgkmcnt(10)
    v_mfma_f32_16x16x32_bf16 v[120:123], v[80:83], v[56:59], v[120:123]
    ds_read_b64_tr_b16 v[48:49], v3 offset:33024
    v_mfma_f32_16x16x32_bf16 v[124:127], v[80:83], v[60:63], v[124:127]
    ds_read_b64_tr_b16 v[50:51], v3 offset:35072
    v_mfma_f32_16x16x32_bf16 v[128:131], v[80:83], v[64:67], v[128:131]
    ds_read_b64_tr_b16 v[52:53], v4 offset:33024
    v_mfma_f32_16x16x32_bf16 v[132:135], v[80:83], v[68:71], v[132:135]
    ds_read_b64_tr_b16 v[54:55], v4 offset:35072
    s_waitcnt lgkmcnt(12)
    v_mfma_f32_16x16x32_bf16 v[148:151], v[84:87], v[68:71], v[148:151]
    v_mfma_f32_16x16x32_bf16 v[144:147], v[84:87], v[64:67], v[144:147]
    v_mfma_f32_16x16x32_bf16 v[140:143], v[84:87], v[60:63], v[140:143]
    v_mfma_f32_16x16x32_bf16 v[136:139], v[84:87], v[56:59], v[136:139]
    s_waitcnt lgkmcnt(6)
    v_mfma_f32_16x16x32_bf16 v[88:91], v[40:43], v[24:27], v[88:91]
    ds_read_b64_tr_b16 v[72:73], v3 offset:40960
    v_mfma_f32_16x16x32_bf16 v[92:95], v[40:43], v[28:31], v[92:95]
    ds_read_b64_tr_b16 v[74:75], v3 offset:43008
    v_mfma_f32_16x16x32_bf16 v[96:99], v[40:43], v[32:35], v[96:99]
    ds_read_b128 v[56:59], v2 offset:34816
    v_mfma_f32_16x16x32_bf16 v[100:103], v[40:43], v[36:39], v[100:103]
    ds_read_b128 v[60:63], v2 offset:35072
    s_waitcnt lgkmcnt(8)
    v_mfma_f32_16x16x32_bf16 v[116:119], v[44:47], v[36:39], v[116:119]
    ds_read_b128 v[64:67], v2 offset:38912
    v_mfma_f32_16x16x32_bf16 v[112:115], v[44:47], v[32:35], v[112:115]
    ds_read_b128 v[68:71], v2 offset:39168
    v_mfma_f32_16x16x32_bf16 v[108:111], v[44:47], v[28:31], v[108:111]
    ds_read_b64_tr_b16 v[76:77], v4 offset:40960
    v_mfma_f32_16x16x32_bf16 v[104:107], v[44:47], v[24:27], v[104:107]
    ds_read_b64_tr_b16 v[78:79], v4 offset:43008
    s_waitcnt lgkmcnt(10)
    v_mfma_f32_16x16x32_bf16 v[120:123], v[48:51], v[24:27], v[120:123]
    ds_read_b64_tr_b16 v[80:81], v3 offset:41216
    v_mfma_f32_16x16x32_bf16 v[124:127], v[48:51], v[28:31], v[124:127]
    ds_read_b64_tr_b16 v[82:83], v3 offset:43264
    v_mfma_f32_16x16x32_bf16 v[128:131], v[48:51], v[32:35], v[128:131]
    ds_read_b64_tr_b16 v[84:85], v4 offset:41216
    v_mfma_f32_16x16x32_bf16 v[132:135], v[48:51], v[36:39], v[132:135]
    ds_read_b64_tr_b16 v[86:87], v4 offset:43264
    s_waitcnt lgkmcnt(12)
    v_mfma_f32_16x16x32_bf16 v[148:151], v[52:55], v[36:39], v[148:151]
    s_mov_b32 s11, 0x20000
    v_mfma_f32_16x16x32_bf16 v[144:147], v[52:55], v[32:35], v[144:147]
    v_mfma_f32_16x16x32_bf16 v[140:143], v[52:55], v[28:31], v[140:143]
    v_mfma_f32_16x16x32_bf16 v[136:139], v[52:55], v[24:27], v[136:139]
    s_waitcnt lgkmcnt(6)
    s_barrier
    v_mfma_f32_16x16x32_bf16 v[88:91], v[72:75], v[56:59], v[88:91]
    ds_read_b64_tr_b16 v[40:41], v3 offset:49152
    v_mfma_f32_16x16x32_bf16 v[92:95], v[72:75], v[60:63], v[92:95]
    ds_read_b64_tr_b16 v[42:43], v3 offset:51200
    v_mfma_f32_16x16x32_bf16 v[96:99], v[72:75], v[64:67], v[96:99]
    ds_read_b128 v[24:27], v2 offset:49152
    v_mfma_f32_16x16x32_bf16 v[100:103], v[72:75], v[68:71], v[100:103]
    ds_read_b128 v[28:31], v2 offset:49408
    s_waitcnt lgkmcnt(8)
    v_mfma_f32_16x16x32_bf16 v[116:119], v[76:79], v[68:71], v[116:119]
    ds_read_b128 v[32:35], v2 offset:53248
    v_mfma_f32_16x16x32_bf16 v[112:115], v[76:79], v[64:67], v[112:115]
    ds_read_b128 v[36:39], v2 offset:53504
    v_mfma_f32_16x16x32_bf16 v[108:111], v[76:79], v[60:63], v[108:111]
    ds_read_b64_tr_b16 v[44:45], v4 offset:49152
    v_mfma_f32_16x16x32_bf16 v[104:107], v[76:79], v[56:59], v[104:107]
    ds_read_b64_tr_b16 v[46:47], v4 offset:51200
    s_waitcnt lgkmcnt(10)
    v_mfma_f32_16x16x32_bf16 v[120:123], v[80:83], v[56:59], v[120:123]
    ds_read_b64_tr_b16 v[48:49], v3 offset:49408
    v_mfma_f32_16x16x32_bf16 v[124:127], v[80:83], v[60:63], v[124:127]
    ds_read_b64_tr_b16 v[50:51], v3 offset:51456
    v_mfma_f32_16x16x32_bf16 v[128:131], v[80:83], v[64:67], v[128:131]
    ds_read_b64_tr_b16 v[52:53], v4 offset:49408
    v_mfma_f32_16x16x32_bf16 v[132:135], v[80:83], v[68:71], v[132:135]
    ds_read_b64_tr_b16 v[54:55], v4 offset:51456
    s_waitcnt lgkmcnt(12)
    v_mfma_f32_16x16x32_bf16 v[148:151], v[84:87], v[68:71], v[148:151]
    v_mfma_f32_16x16x32_bf16 v[144:147], v[84:87], v[64:67], v[144:147]
    v_mfma_f32_16x16x32_bf16 v[140:143], v[84:87], v[60:63], v[140:143]
    v_mfma_f32_16x16x32_bf16 v[136:139], v[84:87], v[56:59], v[136:139]
    s_waitcnt lgkmcnt(6)
    v_mfma_f32_16x16x32_bf16 v[88:91], v[40:43], v[24:27], v[88:91]
    ds_read_b64_tr_b16 v[72:73], v3 offset:57344
    v_mfma_f32_16x16x32_bf16 v[92:95], v[40:43], v[28:31], v[92:95]
    ds_read_b64_tr_b16 v[74:75], v3 offset:59392
    v_mfma_f32_16x16x32_bf16 v[96:99], v[40:43], v[32:35], v[96:99]
    ds_read_b128 v[56:59], v2 offset:51200
    v_mfma_f32_16x16x32_bf16 v[100:103], v[40:43], v[36:39], v[100:103]
    ds_read_b128 v[60:63], v2 offset:51456
    s_waitcnt lgkmcnt(8)
    v_mfma_f32_16x16x32_bf16 v[116:119], v[44:47], v[36:39], v[116:119]
    ds_read_b128 v[64:67], v2 offset:55296
    v_mfma_f32_16x16x32_bf16 v[112:115], v[44:47], v[32:35], v[112:115]
    ds_read_b128 v[68:71], v2 offset:55552
    v_mfma_f32_16x16x32_bf16 v[108:111], v[44:47], v[28:31], v[108:111]
    ds_read_b64_tr_b16 v[76:77], v4 offset:57344
    v_mfma_f32_16x16x32_bf16 v[104:107], v[44:47], v[24:27], v[104:107]
    ds_read_b64_tr_b16 v[78:79], v4 offset:59392
    s_waitcnt lgkmcnt(10)
    v_mfma_f32_16x16x32_bf16 v[120:123], v[48:51], v[24:27], v[120:123]
    ds_read_b64_tr_b16 v[80:81], v3 offset:57600
    v_mfma_f32_16x16x32_bf16 v[124:127], v[48:51], v[28:31], v[124:127]
    ds_read_b64_tr_b16 v[82:83], v3 offset:59648
    v_mfma_f32_16x16x32_bf16 v[128:131], v[48:51], v[32:35], v[128:131]
    ds_read_b64_tr_b16 v[84:85], v4 offset:57600
    v_mfma_f32_16x16x32_bf16 v[132:135], v[48:51], v[36:39], v[132:135]
    ds_read_b64_tr_b16 v[86:87], v4 offset:59648
    s_waitcnt lgkmcnt(12)
    v_mfma_f32_16x16x32_bf16 v[148:151], v[52:55], v[36:39], v[148:151]
    v_mfma_f32_16x16x32_bf16 v[144:147], v[52:55], v[32:35], v[144:147]
    v_mfma_f32_16x16x32_bf16 v[140:143], v[52:55], v[28:31], v[140:143]
    v_mfma_f32_16x16x32_bf16 v[136:139], v[52:55], v[24:27], v[136:139]
    s_waitcnt lgkmcnt(0)
    v_mfma_f32_16x16x32_bf16 v[88:91], v[72:75], v[56:59], v[88:91]
    v_mfma_f32_16x16x32_bf16 v[104:107], v[76:79], v[56:59], v[104:107]
    v_mfma_f32_16x16x32_bf16 v[120:123], v[80:83], v[56:59], v[120:123]
    v_mfma_f32_16x16x32_bf16 v[136:139], v[84:87], v[56:59], v[136:139]
    v_mfma_f32_16x16x32_bf16 v[92:95], v[72:75], v[60:63], v[92:95]
    v_mfma_f32_16x16x32_bf16 v[108:111], v[76:79], v[60:63], v[108:111]
    v_mfma_f32_16x16x32_bf16 v[124:127], v[80:83], v[60:63], v[124:127]
    v_mfma_f32_16x16x32_bf16 v[140:143], v[84:87], v[60:63], v[140:143]
    v_mfma_f32_16x16x32_bf16 v[96:99], v[72:75], v[64:67], v[96:99]
    v_cvt_pk_bf16_f32 v24, v88, v89
    v_cvt_pk_bf16_f32 v25, v90, v91
    ds_write_b64 v20, v[24:25] offset:0
    v_mfma_f32_16x16x32_bf16 v[112:115], v[76:79], v[64:67], v[112:115]
    v_cvt_pk_bf16_f32 v26, v104, v105
    v_cvt_pk_bf16_f32 v27, v106, v107
    ds_write_b64 v21, v[26:27] offset:0
    v_mfma_f32_16x16x32_bf16 v[128:131], v[80:83], v[64:67], v[128:131]
    v_cvt_pk_bf16_f32 v28, v120, v121
    v_cvt_pk_bf16_f32 v29, v122, v123
    ds_write_b64 v22, v[28:29] offset:0
    v_mfma_f32_16x16x32_bf16 v[144:147], v[84:87], v[64:67], v[144:147]
    v_cvt_pk_bf16_f32 v30, v136, v137
    v_cvt_pk_bf16_f32 v31, v138, v139
    ds_write_b64 v23, v[30:31] offset:0
    ds_read_b128 v[152:155], v5 offset:0
    ds_read_b128 v[156:159], v5 offset:1024
    v_mfma_f32_16x16x32_bf16 v[100:103], v[72:75], v[68:71], v[100:103]
    v_cvt_pk_bf16_f32 v32, v92, v93
    v_cvt_pk_bf16_f32 v33, v94, v95
    ds_write_b64 v20, v[32:33] offset:2048
    v_mfma_f32_16x16x32_bf16 v[116:119], v[76:79], v[68:71], v[116:119]
    v_cvt_pk_bf16_f32 v34, v108, v109
    v_cvt_pk_bf16_f32 v35, v110, v111
    ds_write_b64 v21, v[34:35] offset:2048
    v_mfma_f32_16x16x32_bf16 v[132:135], v[80:83], v[68:71], v[132:135]
    v_cvt_pk_bf16_f32 v36, v124, v125
    v_cvt_pk_bf16_f32 v37, v126, v127
    ds_write_b64 v22, v[36:37] offset:2048
    v_mfma_f32_16x16x32_bf16 v[148:151], v[84:87], v[68:71], v[148:151]
    v_cvt_pk_bf16_f32 v38, v140, v141
    v_cvt_pk_bf16_f32 v39, v142, v143
    ds_write_b64 v23, v[38:39] offset:2048
    ds_read_b128 v[160:163], v5 offset:2048
    ds_read_b128 v[164:167], v5 offset:3072
    s_waitcnt lgkmcnt(7)
    buffer_store_dwordx4 v[152:155], v6, s[8:11], s46 offen sc1
    s_add_u32 s46, s46, 32768
    s_waitcnt lgkmcnt(6)
    buffer_store_dwordx4 v[156:159], v6, s[8:11], s46 offen sc1
    s_add_u32 s46, s46, 32768
    v_cvt_pk_bf16_f32 v40, v96, v97
    v_cvt_pk_bf16_f32 v41, v98, v99
    ds_write_b64 v20, v[40:41] offset:4096
    v_cvt_pk_bf16_f32 v42, v112, v113
    v_cvt_pk_bf16_f32 v43, v114, v115
    ds_write_b64 v21, v[42:43] offset:4096
    v_cvt_pk_bf16_f32 v44, v128, v129
    v_cvt_pk_bf16_f32 v45, v130, v131
    ds_write_b64 v22, v[44:45] offset:4096
    v_cvt_pk_bf16_f32 v46, v144, v145
    v_cvt_pk_bf16_f32 v47, v146, v147
    ds_write_b64 v23, v[46:47] offset:4096
    ds_read_b128 v[168:171], v5 offset:4096
    ds_read_b128 v[172:175], v5 offset:5120
    s_waitcnt lgkmcnt(7)
    buffer_store_dwordx4 v[160:163], v6, s[8:11], s46 offen sc1
    s_add_u32 s46, s46, 32768
    s_waitcnt lgkmcnt(6)
    buffer_store_dwordx4 v[164:167], v6, s[8:11], s46 offen sc1
    s_add_u32 s46, s46, 32768
    v_cvt_pk_bf16_f32 v48, v100, v101
    v_cvt_pk_bf16_f32 v49, v102, v103
    ds_write_b64 v20, v[48:49] offset:6144
    v_cvt_pk_bf16_f32 v50, v116, v117
    v_cvt_pk_bf16_f32 v51, v118, v119
    ds_write_b64 v21, v[50:51] offset:6144
    v_cvt_pk_bf16_f32 v52, v132, v133
    v_cvt_pk_bf16_f32 v53, v134, v135
    ds_write_b64 v22, v[52:53] offset:6144
    v_cvt_pk_bf16_f32 v54, v148, v149
    v_cvt_pk_bf16_f32 v55, v150, v151
    ds_write_b64 v23, v[54:55] offset:6144
    ds_read_b128 v[176:179], v5 offset:6144
    ds_read_b128 v[180:183], v5 offset:7168
    s_waitcnt lgkmcnt(7)
    buffer_store_dwordx4 v[168:171], v6, s[8:11], s46 offen sc1
    s_add_u32 s46, s46, 32768
    s_waitcnt lgkmcnt(6)
    buffer_store_dwordx4 v[172:175], v6, s[8:11], s46 offen sc1
    s_add_u32 s46, s46, 32768
    s_waitcnt lgkmcnt(1)
    buffer_store_dwordx4 v[176:179], v6, s[8:11], s46 offen sc1
    s_add_u32 s46, s46, 32768
    s_waitcnt lgkmcnt(0)
    buffer_store_dwordx4 v[180:183], v6, s[8:11], s46 offen sc1
    s_add_u32 s46, s46, 32768
mega_kernel_finish:
mega_kernel_end:
    s_endpgm
mega_kernel_a_ssetup:
    s_and_b32 s3, s2, 7
    s_lshr_b32 s6, s2, 3
    s_lshr_b32 s7, s3, 2
    s_mul_i32 s4, s7, 24
    s_add_u32 s4, s4, 16
    s_load_dwordx2 s[12:13], s[0:1], s4
    s_load_dwordx2 s[100:101], s[0:1], 48
    s_mov_b32 s14, 0x200000
    s_mov_b32 s15, 0x20000
    s_lshl_b32 s21, s3, 2
    s_and_b32 s5, s6, 3
    s_add_u32 s21, s21, s5
    s_lshr_b32 s22, s6, 2
    s_and_b32 s4, s21, 15
    s_lshl_b32 s10, s7, 8
    s_add_u32 s10, s10, s4
    s_lshl_b32 s10, s10, 8
    s_add_u32 s10, s10, s22
    s_lshl_b32 s47, s6, 3
    s_add_u32 s47, s47, s20
    s_lshl_b32 s47, s47, 13
    s_lshl_b32 s29, s7, 6
    s_lshl_b32 s4, s4, 2
    s_add_u32 s29, s29, s4
    s_and_b32 s4, s20, 3
    s_add_u32 s29, s29, s4
    s_lshl_b32 s29, s29, 7
    s_add_u32 s29, s29, 33587200
    s_xor_b32 s7, s7, 1
    s_lshl_b32 s37, s7, 20
    s_lshr_b32 s4, s20, 2
    s_mul_i32 s7, s22, 0
    s_add_u32 s4, s4, s7
    s_and_b32 s4, s4, 7
    s_lshl_b32 s4, s4, 17
    s_add_u32 s37, s37, s4
    s_and_b32 s4, s20, 3
    s_lshl_b32 s4, s4, 15
    s_add_u32 s37, s37, s4
    s_lshl_b32 s4, s22, 8
    s_add_u32 s37, s37, s4
    s_lshl_b32 s23, s22, 3
    s_add_u32 s23, s23, s20
    s_lshl_b32 s42, s20, 12
    s_lshl_b32 s3, s21, 18
    s_add_u32 s24, s3, 16777216
    s_lshl_b32 s46, s21, 17
    s_lshl_b32 s5, s23, 11
    s_add_u32 s46, s46, s5
    s_mov_b32 s33, s24
    s_add_u32 s3, s3, 8388608
    s_lshl_b32 s5, s22, 15
    s_add_u32 s26, s3, s5
    s_sub_u32 s25, s26, 32768
    s_cmp_eq_u32 s22, 0
    s_cselect_b32 s25, s26, s25
    s_cselect_b32 s45, s20, 8
    s_mov_b32 s43, 1199570944
    s_mov_b32 s44, 0xff800000
    s_lshl_b32 s32, s23, 16
    s_lshl_b32 s3, s21, 11
    s_add_u32 s32, s32, s3
    s_add_u32 s32, s32, 29360128
    s_lshl_b32 s3, s23, 5
    s_add_u32 s3, s3, s21
    s_lshl_b32 s3, s3, 2
    s_add_u32 s3, s3, 33587200
    s_add_u32 s4, s3, 8192
    s_mov_b32 s5, 0x7f000000
    s_cmp_ge_u32 s21, 16
    s_cselect_b32 s28, 7, 99
    s_cselect_b32 s34, s5, s4
    s_cselect_b32 s35, s3, s5
    s_cselect_b32 s36, 1024, 0
    s_lshl_b32 s3, s22, 7
    s_add_u32 s36, s36, s3
    s_lshl_b32 s3, s21, 2
    s_add_u32 s36, s36, s3
    s_add_u32 s36, s36, 33603584
    s_cmp_ge_u32 s20, 4
    s_cselect_b32 s29, s29, s5
    s_cselect_b32 s3, 1, 2
    s_cmp_eq_u32 s28, 7
    s_cselect_b32 s39, s3, 0
    s_cselect_b32 s27, 0, s3
    s_add_u32 s38, s42, 0
    s_lshl_b32 s30, s21, 8
    s_add_u32 s30, s30, 33554432
    s_lshl_b32 s11, 3, s22
    s_lshr_b32 s11, s11, 1
    s_mul_i32 s11, s11, 0x10101
    s_cmp_eq_u32 s20, 0
    s_cselect_b32 s31, 33554432, s5
    s_cselect_b32 s30, s30, s5
    s_cselect_b32 s11, s11, 0
    s_waitcnt lgkmcnt(0)
    s_setpc_b64 s[40:41]
mega_kernel_a_t0a:
    s_nop 1
    v_cndmask_b32 v188, v15, v188, s[48:49]
    v_cndmask_b32 v189, v15, v189, s[50:51]
    v_cndmask_b32 v190, v15, v190, s[52:53]
    v_cndmask_b32 v191, v15, v191, s[54:55]
    v_cndmask_b32 v192, v15, v192, s[56:57]
    v_cndmask_b32 v193, v15, v193, s[58:59]
    v_cndmask_b32 v194, v15, v194, s[60:61]
    v_cndmask_b32 v195, v15, v195, s[62:63]
    v_cndmask_b32 v196, v15, v196, s[64:65]
    v_cndmask_b32 v197, v15, v197, s[66:67]
    v_cndmask_b32 v198, v15, v198, s[68:69]
    v_cndmask_b32 v199, v15, v199, s[70:71]
    v_cndmask_b32 v200, v15, v200, s[72:73]
    v_cndmask_b32 v201, v15, v201, s[74:75]
    v_cndmask_b32 v202, v15, v202, s[76:77]
    v_cndmask_b32 v203, v15, v203, s[78:79]
    s_branch mega_kernel_a_t0a_ret
mega_kernel_a_t0b:
    v_mov_b32 v188, s44
    v_mov_b32 v189, s44
    v_mov_b32 v190, s44
    v_mov_b32 v191, s44
    v_mov_b32 v192, s44
    v_mov_b32 v193, s44
    v_mov_b32 v194, s44
    v_mov_b32 v195, s44
    v_mov_b32 v196, s44
    v_mov_b32 v197, s44
    v_mov_b32 v198, s44
    v_mov_b32 v199, s44
    v_mov_b32 v200, s44
    v_mov_b32 v201, s44
    v_mov_b32 v202, s44
    v_mov_b32 v203, s44
    s_branch mega_kernel_a_t0b_ret
mega_kernel_sk_41n:
    s_call_b64 s[40:41], mega_kernel_setneg
    s_branch mega_kernel_sk_41
mega_kernel_sk_42n:
    s_call_b64 s[40:41], mega_kernel_setneg
    s_branch mega_kernel_sk_42
mega_kernel_sk_45n:
    s_call_b64 s[40:41], mega_kernel_setneg
    s_branch mega_kernel_sk_45
mega_kernel_sk_46n:
    s_call_b64 s[40:41], mega_kernel_setneg
    s_branch mega_kernel_sk_46
mega_kernel_sk_47n:
    s_call_b64 s[40:41], mega_kernel_setneg
    s_branch mega_kernel_sk_47
mega_kernel_sk_48n:
    s_call_b64 s[40:41], mega_kernel_setneg
    s_branch mega_kernel_sk_48
mega_kernel_sk_49n:
    s_call_b64 s[40:41], mega_kernel_setneg
    s_branch mega_kernel_sk_49
mega_kernel_fin_35s:
    s_call_b64 s[40:41], mega_kernel_slow_a
    s_branch mega_kernel_fin_35
mega_kernel_fin_40s:
    s_call_b64 s[40:41], mega_kernel_slow_b
    s_branch mega_kernel_fin_40
mega_kernel_fin_50s:
    s_call_b64 s[40:41], mega_kernel_slow_a
    s_branch mega_kernel_fin_50
mega_kernel_fin_51s:
    s_call_b64 s[40:41], mega_kernel_slow_b
    s_branch mega_kernel_fin_51
mega_kernel_setneg:
    v_mov_b32 v156, s44
    v_mov_b32 v157, s44
    v_mov_b32 v158, s44
    v_mov_b32 v159, s44
    v_mov_b32 v160, s44
    v_mov_b32 v161, s44
    v_mov_b32 v162, s44
    v_mov_b32 v163, s44
    v_mov_b32 v164, s44
    v_mov_b32 v165, s44
    v_mov_b32 v166, s44
    v_mov_b32 v167, s44
    v_mov_b32 v168, s44
    v_mov_b32 v169, s44
    v_mov_b32 v170, s44
    v_mov_b32 v171, s44
    s_setpc_b64 s[40:41]
mega_kernel_pre3:
    s_waitcnt vmcnt(0)
    s_barrier
    s_cmp_lt_u32 s20, 4
    s_cbranch_scc1 mega_kernel_pre3_ret
    s_lshr_b32 s5, s10, 16
    s_xor_b32 s25, s5, 1
    s_lshl_b32 s25, s25, 3
    s_lshl_b32 s6, 255, s25
    s_mul_i32 s7, s22, 0
    s_and_b32 s7, s7, 7
    s_add_u32 s25, s25, s7
    s_mov_b32 s7, 0
    s_and_b32 s3, s20, 3
    s_lshl_b32 s30, s3, 12
    s_add_u32 s30, s30, 65536
    s_bfe_u32 s24, s10, 0x80008
    s_lshl_b32 s24, s24, 2
    s_add_u32 s24, s24, s3
    s_lshl_b32 s24, s24, 16
    s_lshl_b32 s5, s5, 22
    s_add_u32 s24, s24, s5
    s_add_u32 s24, s24, 25165824
    s_lshl_b32 s37, s3, 15
    s_and_b32 s3, s10, 255
    s_lshl_b32 s3, s3, 8
    s_add_u32 s37, s37, s3
    s_mov_b32 s26, 0
    s_mov_b32 s4, 0
mega_kernel_pre3_sp:
    s_waitcnt vmcnt(0)
    v_and_b32 v250, v254, v255
    v_cmp_eq_u32 vcc, 1, v250
    s_and_b64 vcc, vcc, s[6:7]
    s_cmp_eq_u64 vcc, s[6:7]
    s_cbranch_scc1 mega_kernel_pre3_go
    s_add_u32 s4, s4, 1
    s_cmp_gt_u32 s4, 1048576
    s_cbranch_scc1 mega_kernel_pre3_go
    s_sleep 8
    buffer_load_dwordx2 v[254:255], v249, s[16:19], s29 offen sc1
    s_branch mega_kernel_pre3_sp
mega_kernel_pre3_go:
    s_add_u32 m0, s26, s30
    s_lshl_b32 s3, s25, 12
    s_add_u32 s3, s3, s24
    buffer_load_dwordx4 v1, s[16:19], s3 offen offset:0 sc1 lds
    buffer_load_dwordx4 v1, s[16:19], s3 offen offset:1024 sc1 lds
    buffer_load_dwordx4 v1, s[16:19], s3 offen offset:2048 sc1 lds
    buffer_load_dwordx4 v1, s[16:19], s3 offen offset:3072 sc1 lds
    s_add_u32 s3, s25, 1
    s_and_b32 s3, s3, 7
    s_and_b32 s25, s25, 8
    s_or_b32 s25, s25, s3
    s_add_u32 s26, s26, 16384
    s_and_b32 s26, s26, 65535
    s_add_u32 m0, s26, s30
    s_lshl_b32 s3, s25, 12
    s_add_u32 s3, s3, s24
    buffer_load_dwordx4 v1, s[16:19], s3 offen offset:0 sc1 lds
    buffer_load_dwordx4 v1, s[16:19], s3 offen offset:1024 sc1 lds
    buffer_load_dwordx4 v1, s[16:19], s3 offen offset:2048 sc1 lds
    buffer_load_dwordx4 v1, s[16:19], s3 offen offset:3072 sc1 lds
    s_add_u32 s3, s25, 1
    s_and_b32 s3, s3, 7
    s_and_b32 s25, s25, 8
    s_or_b32 s25, s25, s3
    s_add_u32 s26, s26, 16384
    s_and_b32 s26, s26, 65535
mega_kernel_pre3_ret:
    s_setpc_b64 s[40:41]
mega_kernel_p_e6:
    s_lshr_b32 s5, s10, 16
    s_lshl_b32 s29, s5, 10
    s_bfe_u32 s3, s10, 0x70009
    s_lshl_b32 s3, s3, 7
    s_add_u32 s29, s29, s3
    s_add_u32 s29, s29, 33603584
    s_lshl_b32 s5, s5, 3
    s_lshl_b32 s6, 255, s5
    s_mov_b32 s7, 0
    buffer_load_dwordx2 v[254:255], v249, s[16:19], s29 offen sc1
    s_branch mega_kernel_p_eret
mega_kernel_p_e8:
    s_xor_b32 s25, s25, 8
    v_and_b32 v250, v254, v255
    v_cmp_eq_u32 vcc, 1, v250
    s_and_b64 vcc, vcc, s[6:7]
    s_cmp_eq_u64 vcc, s[6:7]
    s_cbranch_scc1 mega_kernel_p_eret
    s_mov_b32 s4, 0
mega_kernel_p_sp8:
    s_waitcnt vmcnt(0)
    v_and_b32 v250, v254, v255
    v_cmp_eq_u32 vcc, 1, v250
    s_and_b64 vcc, vcc, s[6:7]
    s_cmp_eq_u64 vcc, s[6:7]
    s_cbranch_scc1 mega_kernel_p_eret
    s_add_u32 s4, s4, 1
    s_cmp_gt_u32 s4, 1048576
    s_cbranch_scc1 mega_kernel_p_eret
    s_sleep 8
    buffer_load_dwordx2 v[254:255], v249, s[16:19], s29 offen sc1
    s_branch mega_kernel_p_sp8
mega_kernel_q_evta:
    s_waitcnt vmcnt(0)
    s_mov_b64 exec, 1
    global_atomic_add v248, v251, s[70:71] sc1
    s_mov_b64 exec, -1
    s_mov_b32 s57, 16
    s_branch mega_kernel_q_cloop
mega_kernel_q_lev:
    s_cmp_eq_u32 s38, 30
    s_cbranch_scc1 mega_kernel_q_lev30
    s_mov_b32 s66, 29
    global_load_dword v250, v248, s[28:29] sc1
    s_branch mega_kernel_q_pf_ret
mega_kernel_q_lev30:
    s_and_b32 s5, s2, 7
    s_lshl_b32 s5, s5, 2
    s_bfe_u32 s6, s2, 0x20003
    s_add_u32 s5, s5, s6
    s_lshl_b32 s5, s5, 8
    s_add_u32 s74, s5, 33562624
    v_cmp_gt_u32 vcc, 256, v250
    s_cbranch_vccz mega_kernel_q_lev30b
    s_mov_b32 s4, 0
mega_kernel_q_sp28:
    s_waitcnt vmcnt(0)
    v_cmp_gt_u32 vcc, 256, v250
    s_cmp_eq_u64 vcc, 0
    s_cbranch_scc1 mega_kernel_q_lev30b
    s_add_u32 s4, s4, 1
    s_cmp_gt_u32 s4, 1048576
    s_cbranch_scc1 mega_kernel_q_lev30b
    s_sleep 8
    global_load_dword v250, v248, s[28:29] sc1
    s_branch mega_kernel_q_sp28
mega_kernel_q_lev30b:
    buffer_load_dwordx2 v[254:255], v249, s[16:19], s74 offen sc1
    s_branch mega_kernel_q_pf_ret
mega_kernel_q_lchk:
    s_mov_b32 s6, 0xffffff
    s_mov_b32 s7, 0
    s_mov_b32 s4, 0
mega_kernel_q_sp30:
    s_waitcnt vmcnt(0)
    v_and_b32 v250, v254, v255
    v_cmp_eq_u32 vcc, 1, v250
    s_and_b64 vcc, vcc, s[6:7]
    s_cmp_eq_u64 vcc, s[6:7]
    s_cbranch_scc1 mega_kernel_q_lchk_ret
    s_add_u32 s4, s4, 1
    s_cmp_gt_u32 s4, 1048576
    s_cbranch_scc1 mega_kernel_q_lchk_ret
    s_sleep 8
    buffer_load_dwordx2 v[254:255], v249, s[16:19], s74 offen sc1
    s_branch mega_kernel_q_sp30
mega_kernel_a_fsp:
    s_mov_b32 s4, 0
mega_kernel_a_sp4:
    s_waitcnt vmcnt(0)
    v_and_b32 v250, v254, v255
    v_cmp_eq_u32 vcc, 1, v250
    s_and_b64 vcc, vcc, s[6:7]
    s_cmp_eq_u64 vcc, s[6:7]
    s_cbranch_scc1 mega_kernel_a_fsp_ret
    s_add_u32 s4, s4, 1
    s_cmp_gt_u32 s4, 1048576
    s_cbranch_scc1 mega_kernel_a_fsp_ret
    s_sleep 8
    buffer_load_dwordx2 v[254:255], v249, s[16:19], s30 offen sc1
    s_branch mega_kernel_a_sp4
mega_kernel_rr_13c:
    s_call_b64 s[40:41], mega_kernel_rare
    s_branch mega_kernel_rr_13
mega_kernel_rr_17c:
    s_call_b64 s[40:41], mega_kernel_rare
    s_branch mega_kernel_rr_17
mega_kernel_rr_21c:
    s_call_b64 s[40:41], mega_kernel_rare
    s_branch mega_kernel_rr_21
mega_kernel_rr_26c:
    s_call_b64 s[40:41], mega_kernel_rare
    s_branch mega_kernel_rr_26
mega_kernel_rr_29c:
    s_call_b64 s[40:41], mega_kernel_rare
    s_branch mega_kernel_rr_29
mega_kernel_rr_32c:
    s_call_b64 s[40:41], mega_kernel_rare
    s_branch mega_kernel_rr_32
mega_kernel_rare:
    s_nop 9
    v_add_f32 v5, v52, v53
    v_frexp_exp_i32_f32 v5, v5
    v_add_u32 v5, 80, v5
    v_sub_u32 v7, 0, v5
    v_cvt_f32_i32 v6, v7
    v_add_f32 v88, v88, v6
    v_add_f32 v89, v89, v6
    v_add_f32 v90, v90, v6
    v_add_f32 v91, v91, v6
    v_add_f32 v92, v92, v6
    v_add_f32 v93, v93, v6
    v_add_f32 v94, v94, v6
    v_add_f32 v95, v95, v6
    v_add_f32 v96, v96, v6
    v_add_f32 v97, v97, v6
    v_add_f32 v98, v98, v6
    v_add_f32 v99, v99, v6
    v_add_f32 v100, v100, v6
    v_add_f32 v101, v101, v6
    v_add_f32 v102, v102, v6
    v_add_f32 v103, v103, v6
    v_add_f32 v56, v56, v6
    v_add_f32 v57, v57, v6
    v_add_f32 v58, v58, v6
    v_add_f32 v59, v59, v6
    v_add_f32 v60, v60, v6
    v_add_f32 v61, v61, v6
    v_add_f32 v62, v62, v6
    v_add_f32 v63, v63, v6
    v_add_f32 v64, v64, v6
    v_add_f32 v65, v65, v6
    v_add_f32 v66, v66, v6
    v_add_f32 v67, v67, v6
    v_add_f32 v68, v68, v6
    v_add_f32 v69, v69, v6
    v_add_f32 v70, v70, v6
    v_add_f32 v71, v71, v6
    v_ldexp_f32 v52, v52, v7
    v_ldexp_f32 v53, v53, v7
    v_ldexp_f32 v72, v72, v7
    v_ldexp_f32 v73, v73, v7
    v_ldexp_f32 v74, v74, v7
    v_ldexp_f32 v75, v75, v7
    v_ldexp_f32 v76, v76, v7
    v_ldexp_f32 v77, v77, v7
    v_ldexp_f32 v78, v78, v7
    v_ldexp_f32 v79, v79, v7
    v_ldexp_f32 v80, v80, v7
    v_ldexp_f32 v81, v81, v7
    v_ldexp_f32 v82, v82, v7
    v_ldexp_f32 v83, v83, v7
    v_ldexp_f32 v84, v84, v7
    v_ldexp_f32 v85, v85, v7
    v_ldexp_f32 v86, v86, v7
    v_ldexp_f32 v87, v87, v7
    s_setpc_b64 s[40:41]
mega_kernel_slow_b:
    v_mov_b32 v72, 0
    v_mov_b32 v73, 0
    v_mov_b32 v74, 0
    v_mov_b32 v75, 0
    v_mov_b32 v76, 0
    v_mov_b32 v77, 0
    v_mov_b32 v78, 0
    v_mov_b32 v79, 0
    v_mov_b32 v80, 0
    v_mov_b32 v81, 0
    v_mov_b32 v82, 0
    v_mov_b32 v83, 0
    v_mov_b32 v84, 0
    v_mov_b32 v85, 0
    v_mov_b32 v86, 0
    v_mov_b32 v87, 0
    v_mov_b32 v52, 0
    v_mov_b32 v53, 0
    v_mov_b32 v54, 0
    v_mov_b32 v55, 0
    v_mov_b32 v8, 0xfe967699
    v_mov_b32 v6, s44
    s_mov_b32 s6, 0
mega_kernel_slow_loop_b:
    s_lshl_b32 s3, s6, 12
    s_add_u32 s3, s3, s33
    s_sub_u32 s3, s3, 0
    buffer_load_dwordx4 v[20:23], v1, s[16:19], s3 offen sc1
    buffer_load_dwordx4 v[24:27], v1, s[16:19], s3 offen offset:1024 sc1
    buffer_load_dwordx4 v[28:31], v1, s[16:19], s3 offen offset:2048 sc1
    buffer_load_dwordx4 v[32:35], v1, s[16:19], s3 offen offset:3072 sc1
    s_sub_u32 s3, s23, s6
    s_lshl_b32 s3, s3, 5
    s_waitcnt vmcnt(0)
    v_mfma_f32_32x32x16_bf16 v[88:103], v[20:23], v[232:235], 0
    v_mfma_f32_32x32x16_bf16 v[88:103], v[24:27], v[236:239], v[88:103]
    s_nop 7
    s_nop 7
    v_max3_f32 v5, v88, v89, v90
    v_max3_f32 v5, v5, v91, v92
    v_max3_f32 v5, v5, v93, v94
    v_max3_f32 v5, v5, v95, v96
    v_max3_f32 v5, v5, v97, v98
    v_max3_f32 v5, v5, v99, v100
    v_max3_f32 v5, v5, v101, v102
    v_max_f32 v5, v5, v103
    v_mov_b32 v9, v5
    s_nop 1
    v_permlane32_swap_b32 v5, v9
    s_nop 1
    v_max_f32 v5, v5, v9
    v_max_f32 v5, v5, v8
    v_sub_f32 v7, v8, v5
    v_exp_f32 v7, v7
    v_mov_b32 v8, v5
    v_mul_f32 v72, v72, v7
    v_mul_f32 v73, v73, v7
    v_mul_f32 v74, v74, v7
    v_mul_f32 v75, v75, v7
    v_mul_f32 v76, v76, v7
    v_mul_f32 v77, v77, v7
    v_mul_f32 v78, v78, v7
    v_mul_f32 v79, v79, v7
    v_mul_f32 v80, v80, v7
    v_mul_f32 v81, v81, v7
    v_mul_f32 v82, v82, v7
    v_mul_f32 v83, v83, v7
    v_mul_f32 v84, v84, v7
    v_mul_f32 v85, v85, v7
    v_mul_f32 v86, v86, v7
    v_mul_f32 v87, v87, v7
    v_mul_f32 v52, v52, v7
    v_mul_f32 v53, v53, v7
    v_mul_f32 v54, v54, v7
    v_mul_f32 v55, v55, v7
    v_sub_f32 v88, v88, v8
    v_sub_f32 v89, v89, v8
    v_sub_f32 v90, v90, v8
    v_sub_f32 v91, v91, v8
    v_sub_f32 v92, v92, v8
    v_sub_f32 v93, v93, v8
    v_sub_f32 v94, v94, v8
    v_sub_f32 v95, v95, v8
    v_sub_f32 v96, v96, v8
    v_sub_f32 v97, v97, v8
    v_sub_f32 v98, v98, v8
    v_sub_f32 v99, v99, v8
    v_sub_f32 v100, v100, v8
    v_sub_f32 v101, v101, v8
    v_sub_f32 v102, v102, v8
    v_sub_f32 v103, v103, v8
    v_exp_f32 v88, v88
    v_exp_f32 v89, v89
    v_exp_f32 v90, v90
    v_exp_f32 v91, v91
    v_exp_f32 v92, v92
    v_exp_f32 v93, v93
    v_exp_f32 v94, v94
    v_exp_f32 v95, v95
    v_exp_f32 v96, v96
    v_exp_f32 v97, v97
    v_exp_f32 v98, v98
    v_exp_f32 v99, v99
    v_exp_f32 v100, v100
    v_exp_f32 v101, v101
    v_exp_f32 v102, v102
    v_exp_f32 v103, v103
    s_nop 0
    v_cvt_pk_bf16_f32 v36, v88, v89
    v_cvt_pk_bf16_f32 v37, v90, v91
    v_cvt_pk_bf16_f32 v38, v92, v93
    v_cvt_pk_bf16_f32 v39, v94, v95
    v_cvt_pk_bf16_f32 v40, v96, v97
    v_cvt_pk_bf16_f32 v41, v98, v99
    v_cvt_pk_bf16_f32 v42, v100, v101
    v_cvt_pk_bf16_f32 v43, v102, v103
    s_nop 1
    v_mfma_f32_32x32x16_bf16 v[72:87], v[28:31], v[36:39], v[72:87]
    v_mfma_f32_32x32x16_bf16 v[72:87], v[32:35], v[40:43], v[72:87]
    v_smfmac_f32_16x16x64_bf16 v[52:55], v[10:13], v[36:43], v14
    s_add_u32 s6, s6, 1
    s_cmp_lt_u32 s6, 64
    s_nop 7
    s_nop 7
    s_cbranch_scc1 mega_kernel_slow_loop_b
    v_add_f32 v7, v52, v53
    s_setpc_b64 s[40:41]
mega_kernel_slow_a:
    v_mov_b32 v172, 0
    v_mov_b32 v173, 0
    v_mov_b32 v174, 0
    v_mov_b32 v175, 0
    v_mov_b32 v176, 0
    v_mov_b32 v177, 0
    v_mov_b32 v178, 0
    v_mov_b32 v179, 0
    v_mov_b32 v180, 0
    v_mov_b32 v181, 0
    v_mov_b32 v182, 0
    v_mov_b32 v183, 0
    v_mov_b32 v184, 0
    v_mov_b32 v185, 0
    v_mov_b32 v186, 0
    v_mov_b32 v187, 0
    v_mov_b32 v152, 0
    v_mov_b32 v153, 0
    v_mov_b32 v154, 0
    v_mov_b32 v155, 0
    v_mov_b32 v8, 0xfe967699
    v_mov_b32 v6, s44
    s_sub_u32 s6, s23, s45
    v_and_b32 v15, 31, v0
    v_lshrrev_b32 v7, 5, v0
    v_lshlrev_b32 v7, 2, v7
    v_sub_u32 v15, v15, v7
mega_kernel_slow_loop_a:
    s_lshl_b32 s3, s6, 12
    s_add_u32 s3, s3, s33
    s_sub_u32 s3, s3, 8388608
    buffer_load_dwordx4 v[120:123], v1, s[16:19], s3 offen sc1
    buffer_load_dwordx4 v[124:127], v1, s[16:19], s3 offen offset:1024 sc1
    buffer_load_dwordx4 v[128:131], v1, s[16:19], s3 offen offset:2048 sc1
    buffer_load_dwordx4 v[132:135], v1, s[16:19], s3 offen offset:3072 sc1
    s_sub_u32 s3, s23, s6
    s_lshl_b32 s3, s3, 5
    v_add_u32 v7, s3, v15
    s_waitcnt vmcnt(0)
    v_mfma_f32_32x32x16_bf16 v[188:203], v[120:123], v[240:243], 0
    v_mfma_f32_32x32x16_bf16 v[188:203], v[124:127], v[244:247], v[188:203]
    s_nop 7
    s_nop 7
    v_subrev_u32 v5, 0, v7
    v_cmp_gt_u32 vcc, 256, v5
    s_nop 1
    v_cndmask_b32 v188, v6, v188, vcc
    v_subrev_u32 v5, 1, v7
    v_cmp_gt_u32 vcc, 256, v5
    s_nop 1
    v_cndmask_b32 v189, v6, v189, vcc
    v_subrev_u32 v5, 2, v7
    v_cmp_gt_u32 vcc, 256, v5
    s_nop 1
    v_cndmask_b32 v190, v6, v190, vcc
    v_subrev_u32 v5, 3, v7
    v_cmp_gt_u32 vcc, 256, v5
    s_nop 1
    v_cndmask_b32 v191, v6, v191, vcc
    v_subrev_u32 v5, 8, v7
    v_cmp_gt_u32 vcc, 256, v5
    s_nop 1
    v_cndmask_b32 v192, v6, v192, vcc
    v_subrev_u32 v5, 9, v7
    v_cmp_gt_u32 vcc, 256, v5
    s_nop 1
    v_cndmask_b32 v193, v6, v193, vcc
    v_subrev_u32 v5, 10, v7
    v_cmp_gt_u32 vcc, 256, v5
    s_nop 1
    v_cndmask_b32 v194, v6, v194, vcc
    v_subrev_u32 v5, 11, v7
    v_cmp_gt_u32 vcc, 256, v5
    s_nop 1
    v_cndmask_b32 v195, v6, v195, vcc
    v_subrev_u32 v5, 16, v7
    v_cmp_gt_u32 vcc, 256, v5
    s_nop 1
    v_cndmask_b32 v196, v6, v196, vcc
    v_subrev_u32 v5, 17, v7
    v_cmp_gt_u32 vcc, 256, v5
    s_nop 1
    v_cndmask_b32 v197, v6, v197, vcc
    v_subrev_u32 v5, 18, v7
    v_cmp_gt_u32 vcc, 256, v5
    s_nop 1
    v_cndmask_b32 v198, v6, v198, vcc
    v_subrev_u32 v5, 19, v7
    v_cmp_gt_u32 vcc, 256, v5
    s_nop 1
    v_cndmask_b32 v199, v6, v199, vcc
    v_subrev_u32 v5, 24, v7
    v_cmp_gt_u32 vcc, 256, v5
    s_nop 1
    v_cndmask_b32 v200, v6, v200, vcc
    v_subrev_u32 v5, 25, v7
    v_cmp_gt_u32 vcc, 256, v5
    s_nop 1
    v_cndmask_b32 v201, v6, v201, vcc
    v_subrev_u32 v5, 26, v7
    v_cmp_gt_u32 vcc, 256, v5
    s_nop 1
    v_cndmask_b32 v202, v6, v202, vcc
    v_subrev_u32 v5, 27, v7
    v_cmp_gt_u32 vcc, 256, v5
    s_nop 1
    v_cndmask_b32 v203, v6, v203, vcc
    v_max3_f32 v5, v188, v189, v190
    v_max3_f32 v5, v5, v191, v192
    v_max3_f32 v5, v5, v193, v194
    v_max3_f32 v5, v5, v195, v196
    v_max3_f32 v5, v5, v197, v198
    v_max3_f32 v5, v5, v199, v200
    v_max3_f32 v5, v5, v201, v202
    v_max_f32 v5, v5, v203
    v_mov_b32 v9, v5
    s_nop 1
    v_permlane32_swap_b32 v5, v9
    s_nop 1
    v_max_f32 v5, v5, v9
    v_max_f32 v5, v5, v8
    v_sub_f32 v7, v8, v5
    v_exp_f32 v7, v7
    v_mov_b32 v8, v5
    v_mul_f32 v172, v172, v7
    v_mul_f32 v173, v173, v7
    v_mul_f32 v174, v174, v7
    v_mul_f32 v175, v175, v7
    v_mul_f32 v176, v176, v7
    v_mul_f32 v177, v177, v7
    v_mul_f32 v178, v178, v7
    v_mul_f32 v179, v179, v7
    v_mul_f32 v180, v180, v7
    v_mul_f32 v181, v181, v7
    v_mul_f32 v182, v182, v7
    v_mul_f32 v183, v183, v7
    v_mul_f32 v184, v184, v7
    v_mul_f32 v185, v185, v7
    v_mul_f32 v186, v186, v7
    v_mul_f32 v187, v187, v7
    v_mul_f32 v152, v152, v7
    v_mul_f32 v153, v153, v7
    v_mul_f32 v154, v154, v7
    v_mul_f32 v155, v155, v7
    v_sub_f32 v188, v188, v8
    v_sub_f32 v189, v189, v8
    v_sub_f32 v190, v190, v8
    v_sub_f32 v191, v191, v8
    v_sub_f32 v192, v192, v8
    v_sub_f32 v193, v193, v8
    v_sub_f32 v194, v194, v8
    v_sub_f32 v195, v195, v8
    v_sub_f32 v196, v196, v8
    v_sub_f32 v197, v197, v8
    v_sub_f32 v198, v198, v8
    v_sub_f32 v199, v199, v8
    v_sub_f32 v200, v200, v8
    v_sub_f32 v201, v201, v8
    v_sub_f32 v202, v202, v8
    v_sub_f32 v203, v203, v8
    v_exp_f32 v188, v188
    v_exp_f32 v189, v189
    v_exp_f32 v190, v190
    v_exp_f32 v191, v191
    v_exp_f32 v192, v192
    v_exp_f32 v193, v193
    v_exp_f32 v194, v194
    v_exp_f32 v195, v195
    v_exp_f32 v196, v196
    v_exp_f32 v197, v197
    v_exp_f32 v198, v198
    v_exp_f32 v199, v199
    v_exp_f32 v200, v200
    v_exp_f32 v201, v201
    v_exp_f32 v202, v202
    v_exp_f32 v203, v203
    s_nop 0
    v_cvt_pk_bf16_f32 v136, v188, v189
    v_cvt_pk_bf16_f32 v137, v190, v191
    v_cvt_pk_bf16_f32 v138, v192, v193
    v_cvt_pk_bf16_f32 v139, v194, v195
    v_cvt_pk_bf16_f32 v140, v196, v197
    v_cvt_pk_bf16_f32 v141, v198, v199
    v_cvt_pk_bf16_f32 v142, v200, v201
    v_cvt_pk_bf16_f32 v143, v202, v203
    s_nop 1
    v_mfma_f32_32x32x16_bf16 v[172:187], v[128:131], v[136:139], v[172:187]
    v_mfma_f32_32x32x16_bf16 v[172:187], v[132:135], v[140:143], v[172:187]
    v_smfmac_f32_16x16x64_bf16 v[152:155], v[10:13], v[136:143], v14
    s_add_u32 s6, s6, 1
    s_cmp_le_u32 s6, s23
    s_nop 7
    s_nop 7
    s_cbranch_scc1 mega_kernel_slow_loop_a
    v_add_f32 v7, v152, v153
    s_setpc_b64 s[40:41]
mega_kernel_codeend:
.section .rodata,"a"
.p2align 6
.amdhsa_kernel mega_kernel
  .amdhsa_next_free_vgpr 256
  .amdhsa_next_free_sgpr 102
  .amdhsa_accum_offset 256
  .amdhsa_group_segment_fixed_size 0
  .amdhsa_kernarg_size 72
  .amdhsa_user_sgpr_count 2
  .amdhsa_user_sgpr_kernarg_segment_ptr 1
  .amdhsa_system_sgpr_workgroup_id_x 1
.end_amdhsa_kernel
```
